```python
import torch

def _softmax(x, axis=-1):
    return torch.softmax(x, dim=axis)
def _gelu(x):
    return torch.nn.functional.gelu(x, approximate="tanh")
def _silu(x):
    return torch.nn.functional.silu(x)
def _sigmoid(x):
    return torch.sigmoid(x)
def _layernorm(x, axis=-1, eps=1e-5):
    m = x.mean(dim=axis, keepdim=True)
    v = x.var(dim=axis, keepdim=True, unbiased=False)
    return (x - m) / torch.sqrt(v + eps)
def _scatter_add(tgt, idx, src, axis=0):
    return tgt.clone().index_add_(axis, idx, src)
def _segment_sum(src, seg, n):
    out = torch.zeros((n,) + src.shape[1:], dtype=src.dtype)
    return out.index_add_(0, seg, src)
def _pad(x, pw):
    flat = tuple(v for pair in reversed(pw) for v in pair)
    return torch.nn.functional.pad(x, flat)

kernel_name = 'concat_heads__mha_block_cached__mha_block_cached__near_ridge'

def setup_inputs():

    _w = (lambda a: (lambda t: t.to(torch.bfloat16) if t.is_floating_point() else t)(torch.as_tensor(a)))
    def _A_setup():
        B, Sq, D = 16, 80, 640
        H, Sk, Dh = 32, 512, 192
        return {
            "x": _w((lambda *s: torch.randn(*s, dtype=torch.bfloat16) * 0.8)(B, Sq, D)),
            "k_cache": _w((lambda *s: torch.randn(*s, dtype=torch.bfloat16) * 0.8)(B, H, Sk, Dh)),
            "v_cache": _w((lambda *s: torch.randn(*s, dtype=torch.bfloat16) * 0.05)(B, H, Sk, Dh)),
            "wq": _w((lambda *s: torch.randn(*s, dtype=torch.bfloat16) * 0.8)(D, H * Dh) * (D ** -0.5)),
            "wo": _w((lambda *s: torch.randn(*s, dtype=torch.bfloat16) * 0.05)(H * Dh, D) * ((H * Dh) ** -0.5)),
        }
    _A_in = _A_setup()

    def _B_setup():
        B, Sq, D = 16, 80, 640
        H, Sk, Dh = 32, 512, 192
        return {
            "x": _w((lambda *s: torch.randn(*s, dtype=torch.bfloat16) * 0.8)(B, Sq, D)),
            "k_cache": _w((lambda *s: torch.randn(*s, dtype=torch.bfloat16) * 0.8)(B, H, Sk, Dh)),
            "v_cache": _w((lambda *s: torch.randn(*s, dtype=torch.bfloat16) * 0.05)(B, H, Sk, Dh)),
            "wq": _w((lambda *s: torch.randn(*s, dtype=torch.bfloat16) * 0.8)(D, H * Dh) * (D ** -0.5)),
            "wo": _w((lambda *s: torch.randn(*s, dtype=torch.bfloat16) * 0.05)(H * Dh, D) * ((H * Dh) ** -0.5)),
        }
    _B_in = _B_setup()

    return {
        "A_x": _A_in["x"],
        "A_k_cache": _A_in["k_cache"],
        "A_v_cache": _A_in["v_cache"],
        "A_wq": _A_in["wq"],
        "A_wo": _A_in["wo"],
        "B_x": _B_in["x"],
        "B_k_cache": _B_in["k_cache"],
        "B_v_cache": _B_in["v_cache"],
        "B_wq": _B_in["wq"],
        "B_wo": _B_in["wo"],
    }

def reference(A_x, A_k_cache, A_v_cache, A_wq, A_wo, B_x, B_k_cache, B_v_cache, B_wq, B_wo):
    def _A_ref(x, k_cache, v_cache, wq, wo):
        B, Sq, D = x.shape
        H, Dh = 32, 192
        q = (lambda x, *d: x.permute(*d))((x @ wq).reshape(B, Sq, H, Dh), 0, 2, 1, 3)
        scores = torch.einsum("bhqd,bhkd->bhqk", q, k_cache) * (Dh ** -0.5)
        p = _softmax(scores, axis=-1)
        o = torch.einsum("bhqk,bhkd->bhqd", p, v_cache)
        return (lambda x, *d: x.permute(*d))(o, 0, 2, 1, 3).reshape(B, Sq, H * Dh) @ wo

    def _B_ref(x, k_cache, v_cache, wq, wo):
        B, Sq, D = x.shape
        H, Dh = 32, 192
        q = (lambda x, *d: x.permute(*d))((x @ wq).reshape(B, Sq, H, Dh), 0, 2, 1, 3)
        scores = torch.einsum("bhqd,bhkd->bhqk", q, k_cache) * (Dh ** -0.5)
        p = _softmax(scores, axis=-1)
        o = torch.einsum("bhqk,bhkd->bhqd", p, v_cache)
        return (lambda x, *d: x.permute(*d))(o, 0, 2, 1, 3).reshape(B, Sq, H * Dh) @ wo

    a = _A_ref(A_x, A_k_cache, A_v_cache, A_wq, A_wo)
    b = _B_ref(B_x, B_k_cache, B_v_cache, B_wq, B_wo)
    return torch.concatenate([a, b], axis=-1)
```

```asm
; @launch grid=(256,1,1) block=(512,1,1) lds=163840
.amdgcn_target "amdgcn-amd-amdhsa--gfx950"
.text
.globl concat_heads__mha_block_cached__mha_block_cached__near_ridge_kernel
.p2align 8
.type concat_heads__mha_block_cached__mha_block_cached__near_ridge_kernel,@function
concat_heads__mha_block_cached__mha_block_cached__near_ridge_kernel:
s_cmp_ge_u32 s2, 256
s_cbranch_scc1 L_exit
s_load_dwordx16 s[48:63], s[0:1], 0
s_load_dwordx4 s[64:67], s[0:1], 64
s_load_dwordx2 s[68:69], s[0:1], 96
v_lshrrev_b32 v1, 6, v0
v_and_b32 v0, 63, v0
v_readfirstlane_b32 s34, v1
s_and_b32 s73, s2, 7
s_lshr_b32 s74, s2, 3
s_lshr_b32 s70, s73, 2
s_and_b32 s71, s74, 15
s_and_b32 s72, s73, 3
s_lshl_b32 s72, s72, 1
s_lshr_b32 s74, s74, 4
s_add_u32 s72, s72, s74
s_lshl_b32 s73, s71, 3
s_add_u32 s73, s73, s72
s_mul_i32 s28, s73, 786432
s_mul_i32 s29, s72, 1536
s_mul_i32 s30, s72, 983040
s_mul_i32 s31, s71, 102400
s_lshl_b32 s74, s70, 7
s_add_u32 s73, s73, s74
s_mul_i32 s37, s73, 102400
s_mul_i32 s74, s71, 15360
s_add_u32 s38, s30, s74
s_and_b32 s74, s72, 1
s_mul_i32 s74, s74, 51200
s_add_u32 s39, s31, s74
s_mov_b32 s35, 0x3dd53b95
s_mov_b32 s36, 0xffff0000
v_min_u32 v13, 14, v0
v_mul_u32_u24 v5, 86, v13
v_lshrrev_b32 v5, 8, v5
v_mul_u32_u24 v6, 3, v5
v_sub_u32 v6, v13, v6
v_lshlrev_b32 v6, 7, v6
s_lshl_b32 s78, s71, 3
s_add_u32 s78, s78, s34
s_mul_i32 s78, s78, 5
v_add_u32 v5, s78, v5
v_mul_u32_u24 v5, 12288, v5
v_add_u32 v14, v5, v6
v_min_u32 v5, 49, v0
v_lshlrev_b32 v5, 7, v5
s_mul_i32 s78, s34, 6400
v_add_u32 v15, s78, v5
s_waitcnt lgkmcnt(0)
s_cmp_eq_u32 s70, 0
s_cbranch_scc1 L_brA
s_mov_b32 s48, s58
s_mov_b32 s49, s59
s_mov_b32 s50, s60
s_mov_b32 s51, s61
s_mov_b32 s52, s62
s_mov_b32 s53, s63
s_mov_b32 s54, s64
s_mov_b32 s55, s65
s_mov_b32 s56, s66
s_mov_b32 s57, s67
L_brA:
s_mov_b32 s12, s54
s_mov_b32 s13, s55
s_mov_b32 s14, 0x780000
s_mov_b32 s15, 0x00020000
s_mov_b32 s20, s48
s_mov_b32 s21, s49
s_mov_b32 s22, 0x190000
s_mov_b32 s23, 0x00020000
buffer_load_dword v245, v14, s[12:15], s29 offen
buffer_load_dword v245, v15, s[20:23], s39 offen
s_mov_b32 s4, s50
s_mov_b32 s5, s51
s_mov_b32 s6, 0x6000000
s_mov_b32 s7, 0x00020000
s_mov_b32 s8, s52
s_mov_b32 s9, s53
s_mov_b32 s10, 0x6000000
s_mov_b32 s11, 0x00020000
s_mov_b32 s16, s56
s_mov_b32 s17, s57
s_mov_b32 s18, 0x780000
s_mov_b32 s19, 0x00020000
s_mov_b32 s24, s68
s_mov_b32 s25, s69
s_mov_b32 s26, 0x1910000
s_mov_b32 s27, 0x00020000
s_and_b32 s75, s34, 3
v_lshrrev_b32 v2, 4, v0
v_and_b32 v3, 15, v0
s_lshl_b32 s76, s71, 2
s_add_u32 s76, s76, s75
s_mul_i32 s43, s76, 122880
s_mul_i32 s44, s76, 3840
v_lshrrev_b32 v5, 2, v0
v_and_b32 v5, 7, v5
v_lshrrev_b32 v6, 1, v5
v_xor_b32 v6, s75, v6
v_lshlrev_b32 v6, 5, v6
v_lshlrev_b32 v5, 7, v5
v_add_u32 v4, v5, v6
v_lshrrev_b32 v5, 5, v0
v_lshlrev_b32 v5, 10, v5
v_add_u32 v4, v4, v5
v_and_b32 v5, 3, v0
v_lshlrev_b32 v5, 3, v5
v_add_u32 v4, v4, v5
v_lshlrev_b32 v7, 4, v0
v_add_u32 v7, 131072, v7
s_cmp_ge_u32 s34, 4
s_cbranch_scc1 L_loader
v_mov_b32 v246, v4
v_subrev_u32 v248, 30720, v7
v_lshrrev_b32 v5, 1, v3
v_xor_b32 v5, v5, v2
v_lshlrev_b32 v5, 4, v5
v_lshlrev_b32 v6, 7, v3
v_add_u32 v5, v5, v6
v_add_u32 v251, 110592, v5
v_xor_b32 v252, 64, v251
s_lshl_b32 s76, s75, 11
v_add_u32 v247, s76, v5
v_xor_b32 v254, 64, v247
v_add_u32 v253, 49152, v4
s_mul_i32 s76, s75, 5120
v_add_u32 v255, s76, v7
s_lshr_b32 s76, s75, 1
s_mul_i32 s76, s76, 5120
s_and_b32 s77, s75, 1
s_lshl_b32 s77, s77, 9
s_add_u32 s76, s76, s77
s_add_u32 s76, s76, 100352
v_lshrrev_b32 v5, 1, v2
v_lshlrev_b32 v5, 8, v5
v_lshlrev_b32 v6, 4, v3
v_add_u32 v5, v5, v6
v_and_b32 v8, 1, v2
v_lshlrev_b32 v8, 3, v8
v_add_u32 v5, v5, v8
v_add_u32 v249, s76, v5
s_lshl_b32 s76, s75, 2
s_add_u32 s76, s76, 161792
v_add_u32 v250, s76, v6
s_waitcnt lgkmcnt(0)
s_barrier
ds_read_b64_tr_b16 v[220:221], v253 offset:0
ds_read_b64_tr_b16 v[222:223], v253 offset:2048
ds_read_b128 v[200:203], v251 offset:0
ds_read_b64_tr_b16 v[224:225], v253 offset:4096
ds_read_b64_tr_b16 v[226:227], v253 offset:6144
ds_read_b64_tr_b16 v[228:229], v253 offset:8192
ds_read_b64_tr_b16 v[230:231], v253 offset:10240
ds_read_b128 v[204:207], v251 offset:2048
ds_read_b128 v[208:211], v251 offset:4096
ds_read_b128 v[212:215], v251 offset:6144
ds_read_b128 v[216:219], v251 offset:8192
s_waitcnt lgkmcnt(8)
v_mfma_f32_16x16x32_bf16 v[60:63], v[220:223], v[200:203], 0
ds_read_b64_tr_b16 v[120:121], v253 offset:12288
ds_read_b64_tr_b16 v[122:123], v253 offset:14336
s_waitcnt lgkmcnt(8)
v_mfma_f32_16x16x32_bf16 v[80:83], v[224:227], v[200:203], 0
ds_read_b128 v[132:135], v252 offset:0
s_waitcnt lgkmcnt(7)
v_mfma_f32_16x16x32_bf16 v[100:103], v[228:231], v[200:203], 0
s_waitcnt lgkmcnt(6)
v_mfma_f32_16x16x32_bf16 v[64:67], v[220:223], v[204:207], 0
ds_read_b64_tr_b16 v[124:125], v253 offset:16384
ds_read_b64_tr_b16 v[126:127], v253 offset:18432
v_mfma_f32_16x16x32_bf16 v[84:87], v[224:227], v[204:207], 0
ds_read_b128 v[136:139], v252 offset:2048
v_mfma_f32_16x16x32_bf16 v[104:107], v[228:231], v[204:207], 0
s_waitcnt lgkmcnt(8)
v_mfma_f32_16x16x32_bf16 v[68:71], v[220:223], v[208:211], 0
ds_read_b64_tr_b16 v[128:129], v253 offset:20480
ds_read_b64_tr_b16 v[130:131], v253 offset:22528
v_mfma_f32_16x16x32_bf16 v[88:91], v[224:227], v[208:211], 0
ds_read_b128 v[200:203], v252 offset:4096
v_mfma_f32_16x16x32_bf16 v[108:111], v[228:231], v[208:211], 0
s_waitcnt lgkmcnt(10)
v_mfma_f32_16x16x32_bf16 v[72:75], v[220:223], v[212:215], 0
v_mfma_f32_16x16x32_bf16 v[92:95], v[224:227], v[212:215], 0
ds_read_b128 v[204:207], v252 offset:6144
v_mfma_f32_16x16x32_bf16 v[112:115], v[228:231], v[212:215], 0
s_waitcnt lgkmcnt(10)
v_mfma_f32_16x16x32_bf16 v[76:79], v[220:223], v[216:219], 0
v_mfma_f32_16x16x32_bf16 v[96:99], v[224:227], v[216:219], 0
ds_read_b128 v[208:211], v252 offset:8192
v_mfma_f32_16x16x32_bf16 v[116:119], v[228:231], v[216:219], 0
s_waitcnt lgkmcnt(2)
v_mfma_f32_16x16x32_bf16 v[60:63], v[120:123], v[132:135], v[60:63]
v_mfma_f32_16x16x32_bf16 v[80:83], v[124:127], v[132:135], v[80:83]
v_mfma_f32_16x16x32_bf16 v[100:103], v[128:131], v[132:135], v[100:103]
v_mfma_f32_16x16x32_bf16 v[64:67], v[120:123], v[136:139], v[64:67]
v_mfma_f32_16x16x32_bf16 v[84:87], v[124:127], v[136:139], v[84:87]
v_mfma_f32_16x16x32_bf16 v[104:107], v[128:131], v[136:139], v[104:107]
v_mfma_f32_16x16x32_bf16 v[68:71], v[120:123], v[200:203], v[68:71]
v_mfma_f32_16x16x32_bf16 v[88:91], v[124:127], v[200:203], v[88:91]
v_mfma_f32_16x16x32_bf16 v[108:111], v[128:131], v[200:203], v[108:111]
s_waitcnt lgkmcnt(0)
v_mfma_f32_16x16x32_bf16 v[72:75], v[120:123], v[204:207], v[72:75]
v_mfma_f32_16x16x32_bf16 v[92:95], v[124:127], v[204:207], v[92:95]
v_mfma_f32_16x16x32_bf16 v[112:115], v[128:131], v[204:207], v[112:115]
v_mfma_f32_16x16x32_bf16 v[76:79], v[120:123], v[208:211], v[76:79]
v_mfma_f32_16x16x32_bf16 v[96:99], v[124:127], v[208:211], v[96:99]
v_mfma_f32_16x16x32_bf16 v[116:119], v[128:131], v[208:211], v[116:119]
s_barrier
ds_read_b64_tr_b16 v[220:221], v253 offset:24576
ds_read_b64_tr_b16 v[222:223], v253 offset:26624
ds_read_b128 v[212:215], v251 offset:10240
ds_read_b64_tr_b16 v[224:225], v253 offset:28672
ds_read_b64_tr_b16 v[226:227], v253 offset:30720
ds_read_b64_tr_b16 v[228:229], v253 offset:32768
ds_read_b64_tr_b16 v[230:231], v253 offset:34816
ds_read_b128 v[216:219], v251 offset:12288
ds_read_b128 v[132:135], v251 offset:14336
ds_read_b128 v[136:139], v251 offset:16384
ds_read_b128 v[200:203], v251 offset:18432
s_waitcnt lgkmcnt(8)
v_mfma_f32_16x16x32_bf16 v[60:63], v[220:223], v[212:215], v[60:63]
ds_read_b64_tr_b16 v[120:121], v253 offset:36864
ds_read_b64_tr_b16 v[122:123], v253 offset:38912
s_waitcnt lgkmcnt(8)
v_mfma_f32_16x16x32_bf16 v[80:83], v[224:227], v[212:215], v[80:83]
ds_read_b128 v[204:207], v252 offset:10240
s_waitcnt lgkmcnt(7)
v_mfma_f32_16x16x32_bf16 v[100:103], v[228:231], v[212:215], v[100:103]
s_waitcnt lgkmcnt(6)
v_mfma_f32_16x16x32_bf16 v[64:67], v[220:223], v[216:219], v[64:67]
ds_read_b64_tr_b16 v[124:125], v253 offset:40960
ds_read_b64_tr_b16 v[126:127], v253 offset:43008
v_mfma_f32_16x16x32_bf16 v[84:87], v[224:227], v[216:219], v[84:87]
ds_read_b128 v[208:211], v252 offset:12288
v_mfma_f32_16x16x32_bf16 v[104:107], v[228:231], v[216:219], v[104:107]
s_waitcnt lgkmcnt(8)
v_mfma_f32_16x16x32_bf16 v[68:71], v[220:223], v[132:135], v[68:71]
ds_read_b64_tr_b16 v[128:129], v253 offset:45056
ds_read_b64_tr_b16 v[130:131], v253 offset:47104
v_mfma_f32_16x16x32_bf16 v[88:91], v[224:227], v[132:135], v[88:91]
ds_read_b128 v[212:215], v252 offset:14336
v_mfma_f32_16x16x32_bf16 v[108:111], v[228:231], v[132:135], v[108:111]
s_waitcnt lgkmcnt(10)
v_mfma_f32_16x16x32_bf16 v[72:75], v[220:223], v[136:139], v[72:75]
v_mfma_f32_16x16x32_bf16 v[92:95], v[224:227], v[136:139], v[92:95]
ds_read_b128 v[216:219], v252 offset:16384
v_mfma_f32_16x16x32_bf16 v[112:115], v[228:231], v[136:139], v[112:115]
s_waitcnt lgkmcnt(10)
v_mfma_f32_16x16x32_bf16 v[76:79], v[220:223], v[200:203], v[76:79]
v_mfma_f32_16x16x32_bf16 v[96:99], v[224:227], v[200:203], v[96:99]
ds_read_b128 v[132:135], v252 offset:18432
v_mfma_f32_16x16x32_bf16 v[116:119], v[228:231], v[200:203], v[116:119]
s_waitcnt lgkmcnt(2)
v_mfma_f32_16x16x32_bf16 v[60:63], v[120:123], v[204:207], v[60:63]
v_mfma_f32_16x16x32_bf16 v[80:83], v[124:127], v[204:207], v[80:83]
v_mfma_f32_16x16x32_bf16 v[100:103], v[128:131], v[204:207], v[100:103]
v_mfma_f32_16x16x32_bf16 v[64:67], v[120:123], v[208:211], v[64:67]
v_mfma_f32_16x16x32_bf16 v[84:87], v[124:127], v[208:211], v[84:87]
v_mfma_f32_16x16x32_bf16 v[104:107], v[128:131], v[208:211], v[104:107]
v_mfma_f32_16x16x32_bf16 v[68:71], v[120:123], v[212:215], v[68:71]
v_mfma_f32_16x16x32_bf16 v[88:91], v[124:127], v[212:215], v[88:91]
v_mfma_f32_16x16x32_bf16 v[108:111], v[128:131], v[212:215], v[108:111]
s_waitcnt lgkmcnt(0)
v_mfma_f32_16x16x32_bf16 v[72:75], v[120:123], v[216:219], v[72:75]
v_mfma_f32_16x16x32_bf16 v[92:95], v[124:127], v[216:219], v[92:95]
v_mfma_f32_16x16x32_bf16 v[112:115], v[128:131], v[216:219], v[112:115]
v_mfma_f32_16x16x32_bf16 v[76:79], v[120:123], v[132:135], v[76:79]
v_mfma_f32_16x16x32_bf16 v[96:99], v[124:127], v[132:135], v[96:99]
v_mfma_f32_16x16x32_bf16 v[116:119], v[128:131], v[132:135], v[116:119]
s_barrier
ds_read_b64_tr_b16 v[220:221], v253 offset:49152
ds_read_b64_tr_b16 v[222:223], v253 offset:51200
ds_read_b128 v[136:139], v251 offset:40960
ds_read_b64_tr_b16 v[224:225], v253 offset:53248
ds_read_b64_tr_b16 v[226:227], v253 offset:55296
ds_read_b64_tr_b16 v[228:229], v253 offset:57344
ds_read_b64_tr_b16 v[230:231], v253 offset:59392
ds_read_b128 v[200:203], v251 offset:43008
ds_read_b128 v[204:207], v251 offset:45056
ds_read_b128 v[208:211], v251 offset:47104
ds_read_b128 v[212:215], v251 offset:49152
s_waitcnt lgkmcnt(8)
v_mfma_f32_16x16x32_bf16 v[60:63], v[220:223], v[136:139], v[60:63]
ds_read_b64_tr_b16 v[120:121], v253 offset:0
ds_read_b64_tr_b16 v[122:123], v253 offset:2048
s_waitcnt lgkmcnt(8)
v_mfma_f32_16x16x32_bf16 v[80:83], v[224:227], v[136:139], v[80:83]
ds_read_b128 v[216:219], v252 offset:40960
s_waitcnt lgkmcnt(7)
v_mfma_f32_16x16x32_bf16 v[100:103], v[228:231], v[136:139], v[100:103]
s_waitcnt lgkmcnt(6)
v_mfma_f32_16x16x32_bf16 v[64:67], v[220:223], v[200:203], v[64:67]
ds_read_b64_tr_b16 v[124:125], v253 offset:4096
ds_read_b64_tr_b16 v[126:127], v253 offset:6144
v_mfma_f32_16x16x32_bf16 v[84:87], v[224:227], v[200:203], v[84:87]
ds_read_b128 v[132:135], v252 offset:43008
v_mfma_f32_16x16x32_bf16 v[104:107], v[228:231], v[200:203], v[104:107]
s_waitcnt lgkmcnt(8)
v_mfma_f32_16x16x32_bf16 v[68:71], v[220:223], v[204:207], v[68:71]
ds_read_b64_tr_b16 v[128:129], v253 offset:8192
ds_read_b64_tr_b16 v[130:131], v253 offset:10240
v_mfma_f32_16x16x32_bf16 v[88:91], v[224:227], v[204:207], v[88:91]
ds_read_b128 v[136:139], v252 offset:45056
v_mfma_f32_16x16x32_bf16 v[108:111], v[228:231], v[204:207], v[108:111]
s_waitcnt lgkmcnt(10)
v_mfma_f32_16x16x32_bf16 v[72:75], v[220:223], v[208:211], v[72:75]
v_mfma_f32_16x16x32_bf16 v[92:95], v[224:227], v[208:211], v[92:95]
ds_read_b128 v[200:203], v252 offset:47104
v_mfma_f32_16x16x32_bf16 v[112:115], v[228:231], v[208:211], v[112:115]
s_waitcnt lgkmcnt(10)
v_mfma_f32_16x16x32_bf16 v[76:79], v[220:223], v[212:215], v[76:79]
v_mfma_f32_16x16x32_bf16 v[96:99], v[224:227], v[212:215], v[96:99]
ds_read_b128 v[204:207], v252 offset:49152
v_mfma_f32_16x16x32_bf16 v[116:119], v[228:231], v[212:215], v[116:119]
s_waitcnt lgkmcnt(2)
v_mfma_f32_16x16x32_bf16 v[60:63], v[120:123], v[216:219], v[60:63]
v_mfma_f32_16x16x32_bf16 v[80:83], v[124:127], v[216:219], v[80:83]
v_mfma_f32_16x16x32_bf16 v[100:103], v[128:131], v[216:219], v[100:103]
v_mfma_f32_16x16x32_bf16 v[64:67], v[120:123], v[132:135], v[64:67]
v_mfma_f32_16x16x32_bf16 v[84:87], v[124:127], v[132:135], v[84:87]
v_mfma_f32_16x16x32_bf16 v[104:107], v[128:131], v[132:135], v[104:107]
v_mfma_f32_16x16x32_bf16 v[68:71], v[120:123], v[136:139], v[68:71]
v_mfma_f32_16x16x32_bf16 v[88:91], v[124:127], v[136:139], v[88:91]
v_mfma_f32_16x16x32_bf16 v[108:111], v[128:131], v[136:139], v[108:111]
s_waitcnt lgkmcnt(0)
v_mfma_f32_16x16x32_bf16 v[72:75], v[120:123], v[200:203], v[72:75]
v_mfma_f32_16x16x32_bf16 v[92:95], v[124:127], v[200:203], v[92:95]
v_mfma_f32_16x16x32_bf16 v[112:115], v[128:131], v[200:203], v[112:115]
v_mfma_f32_16x16x32_bf16 v[76:79], v[120:123], v[204:207], v[76:79]
v_mfma_f32_16x16x32_bf16 v[96:99], v[124:127], v[204:207], v[96:99]
v_mfma_f32_16x16x32_bf16 v[116:119], v[128:131], v[204:207], v[116:119]
s_barrier
ds_read_b64_tr_b16 v[220:221], v253 offset:12288
ds_read_b64_tr_b16 v[222:223], v253 offset:14336
ds_read_b128 v[208:211], v251 offset:0
ds_read_b64_tr_b16 v[224:225], v253 offset:16384
ds_read_b64_tr_b16 v[226:227], v253 offset:18432
ds_read_b64_tr_b16 v[228:229], v253 offset:20480
ds_read_b64_tr_b16 v[230:231], v253 offset:22528
ds_read_b128 v[212:215], v251 offset:2048
ds_read_b128 v[216:219], v251 offset:4096
ds_read_b128 v[132:135], v251 offset:6144
ds_read_b128 v[136:139], v251 offset:8192
s_waitcnt lgkmcnt(8)
v_mfma_f32_16x16x32_bf16 v[60:63], v[220:223], v[208:211], v[60:63]
ds_read_b64_tr_b16 v[120:121], v253 offset:24576
ds_read_b64_tr_b16 v[122:123], v253 offset:26624
s_waitcnt lgkmcnt(8)
v_mfma_f32_16x16x32_bf16 v[80:83], v[224:227], v[208:211], v[80:83]
ds_read_b128 v[200:203], v252 offset:0
s_waitcnt lgkmcnt(7)
v_mfma_f32_16x16x32_bf16 v[100:103], v[228:231], v[208:211], v[100:103]
s_waitcnt lgkmcnt(6)
v_mfma_f32_16x16x32_bf16 v[64:67], v[220:223], v[212:215], v[64:67]
ds_read_b64_tr_b16 v[124:125], v253 offset:28672
ds_read_b64_tr_b16 v[126:127], v253 offset:30720
v_mfma_f32_16x16x32_bf16 v[84:87], v[224:227], v[212:215], v[84:87]
ds_read_b128 v[204:207], v252 offset:2048
v_mfma_f32_16x16x32_bf16 v[104:107], v[228:231], v[212:215], v[104:107]
s_waitcnt lgkmcnt(8)
v_mfma_f32_16x16x32_bf16 v[68:71], v[220:223], v[216:219], v[68:71]
ds_read_b64_tr_b16 v[128:129], v253 offset:32768
ds_read_b64_tr_b16 v[130:131], v253 offset:34816
v_mfma_f32_16x16x32_bf16 v[88:91], v[224:227], v[216:219], v[88:91]
ds_read_b128 v[208:211], v252 offset:4096
v_mfma_f32_16x16x32_bf16 v[108:111], v[228:231], v[216:219], v[108:111]
s_waitcnt lgkmcnt(10)
v_mfma_f32_16x16x32_bf16 v[72:75], v[220:223], v[132:135], v[72:75]
v_mfma_f32_16x16x32_bf16 v[92:95], v[224:227], v[132:135], v[92:95]
ds_read_b128 v[212:215], v252 offset:6144
v_mfma_f32_16x16x32_bf16 v[112:115], v[228:231], v[132:135], v[112:115]
s_waitcnt lgkmcnt(10)
v_mfma_f32_16x16x32_bf16 v[76:79], v[220:223], v[136:139], v[76:79]
v_mfma_f32_16x16x32_bf16 v[96:99], v[224:227], v[136:139], v[96:99]
ds_read_b128 v[216:219], v252 offset:8192
v_mfma_f32_16x16x32_bf16 v[116:119], v[228:231], v[136:139], v[116:119]
s_waitcnt lgkmcnt(2)
v_mfma_f32_16x16x32_bf16 v[60:63], v[120:123], v[200:203], v[60:63]
v_mfma_f32_16x16x32_bf16 v[80:83], v[124:127], v[200:203], v[80:83]
v_mfma_f32_16x16x32_bf16 v[100:103], v[128:131], v[200:203], v[100:103]
v_mfma_f32_16x16x32_bf16 v[64:67], v[120:123], v[204:207], v[64:67]
v_mfma_f32_16x16x32_bf16 v[84:87], v[124:127], v[204:207], v[84:87]
v_mfma_f32_16x16x32_bf16 v[104:107], v[128:131], v[204:207], v[104:107]
v_mfma_f32_16x16x32_bf16 v[68:71], v[120:123], v[208:211], v[68:71]
v_mfma_f32_16x16x32_bf16 v[88:91], v[124:127], v[208:211], v[88:91]
v_mfma_f32_16x16x32_bf16 v[108:111], v[128:131], v[208:211], v[108:111]
s_waitcnt lgkmcnt(0)
v_mfma_f32_16x16x32_bf16 v[72:75], v[120:123], v[212:215], v[72:75]
v_mfma_f32_16x16x32_bf16 v[92:95], v[124:127], v[212:215], v[92:95]
v_mfma_f32_16x16x32_bf16 v[112:115], v[128:131], v[212:215], v[112:115]
v_mfma_f32_16x16x32_bf16 v[76:79], v[120:123], v[216:219], v[76:79]
v_mfma_f32_16x16x32_bf16 v[96:99], v[124:127], v[216:219], v[96:99]
v_mfma_f32_16x16x32_bf16 v[116:119], v[128:131], v[216:219], v[116:119]
s_barrier
ds_read_b64_tr_b16 v[220:221], v253 offset:36864
ds_read_b64_tr_b16 v[222:223], v253 offset:38912
ds_read_b128 v[132:135], v251 offset:10240
ds_read_b64_tr_b16 v[224:225], v253 offset:40960
ds_read_b64_tr_b16 v[226:227], v253 offset:43008
ds_read_b64_tr_b16 v[228:229], v253 offset:45056
ds_read_b64_tr_b16 v[230:231], v253 offset:47104
ds_read_b128 v[136:139], v251 offset:12288
ds_read_b128 v[200:203], v251 offset:14336
ds_read_b128 v[204:207], v251 offset:16384
ds_read_b128 v[208:211], v251 offset:18432
s_waitcnt lgkmcnt(8)
v_mfma_f32_16x16x32_bf16 v[60:63], v[220:223], v[132:135], v[60:63]
ds_read_b64_tr_b16 v[120:121], v253 offset:49152
ds_read_b64_tr_b16 v[122:123], v253 offset:51200
s_waitcnt lgkmcnt(8)
v_mfma_f32_16x16x32_bf16 v[80:83], v[224:227], v[132:135], v[80:83]
ds_read_b128 v[212:215], v252 offset:10240
s_waitcnt lgkmcnt(7)
v_mfma_f32_16x16x32_bf16 v[100:103], v[228:231], v[132:135], v[100:103]
s_waitcnt lgkmcnt(6)
v_mfma_f32_16x16x32_bf16 v[64:67], v[220:223], v[136:139], v[64:67]
ds_read_b64_tr_b16 v[124:125], v253 offset:53248
ds_read_b64_tr_b16 v[126:127], v253 offset:55296
v_mfma_f32_16x16x32_bf16 v[84:87], v[224:227], v[136:139], v[84:87]
ds_read_b128 v[216:219], v252 offset:12288
v_mfma_f32_16x16x32_bf16 v[104:107], v[228:231], v[136:139], v[104:107]
s_waitcnt lgkmcnt(8)
v_mfma_f32_16x16x32_bf16 v[68:71], v[220:223], v[200:203], v[68:71]
ds_read_b64_tr_b16 v[128:129], v253 offset:57344
ds_read_b64_tr_b16 v[130:131], v253 offset:59392
v_mfma_f32_16x16x32_bf16 v[88:91], v[224:227], v[200:203], v[88:91]
ds_read_b128 v[132:135], v252 offset:14336
v_mfma_f32_16x16x32_bf16 v[108:111], v[228:231], v[200:203], v[108:111]
s_waitcnt lgkmcnt(10)
v_mfma_f32_16x16x32_bf16 v[72:75], v[220:223], v[204:207], v[72:75]
v_mfma_f32_16x16x32_bf16 v[92:95], v[224:227], v[204:207], v[92:95]
ds_read_b128 v[136:139], v252 offset:16384
v_mfma_f32_16x16x32_bf16 v[112:115], v[228:231], v[204:207], v[112:115]
s_waitcnt lgkmcnt(10)
v_mfma_f32_16x16x32_bf16 v[76:79], v[220:223], v[208:211], v[76:79]
v_mfma_f32_16x16x32_bf16 v[96:99], v[224:227], v[208:211], v[96:99]
ds_read_b128 v[200:203], v252 offset:18432
v_mfma_f32_16x16x32_bf16 v[116:119], v[228:231], v[208:211], v[116:119]
s_waitcnt lgkmcnt(2)
v_mfma_f32_16x16x32_bf16 v[60:63], v[120:123], v[212:215], v[60:63]
v_mfma_f32_16x16x32_bf16 v[80:83], v[124:127], v[212:215], v[80:83]
v_mfma_f32_16x16x32_bf16 v[100:103], v[128:131], v[212:215], v[100:103]
v_mfma_f32_16x16x32_bf16 v[64:67], v[120:123], v[216:219], v[64:67]
v_mfma_f32_16x16x32_bf16 v[84:87], v[124:127], v[216:219], v[84:87]
v_mfma_f32_16x16x32_bf16 v[104:107], v[128:131], v[216:219], v[104:107]
v_mfma_f32_16x16x32_bf16 v[68:71], v[120:123], v[132:135], v[68:71]
v_mfma_f32_16x16x32_bf16 v[88:91], v[124:127], v[132:135], v[88:91]
v_mfma_f32_16x16x32_bf16 v[108:111], v[128:131], v[132:135], v[108:111]
s_waitcnt lgkmcnt(0)
v_mfma_f32_16x16x32_bf16 v[72:75], v[120:123], v[136:139], v[72:75]
v_mfma_f32_16x16x32_bf16 v[92:95], v[124:127], v[136:139], v[92:95]
v_mfma_f32_16x16x32_bf16 v[112:115], v[128:131], v[136:139], v[112:115]
v_mfma_f32_16x16x32_bf16 v[76:79], v[120:123], v[200:203], v[76:79]
v_mfma_f32_16x16x32_bf16 v[96:99], v[124:127], v[200:203], v[96:99]
v_mfma_f32_16x16x32_bf16 v[116:119], v[128:131], v[200:203], v[116:119]
s_barrier
ds_read_b64_tr_b16 v[220:221], v253 offset:0
ds_read_b64_tr_b16 v[222:223], v253 offset:2048
ds_read_b128 v[204:207], v251 offset:40960
ds_read_b64_tr_b16 v[224:225], v253 offset:4096
ds_read_b64_tr_b16 v[226:227], v253 offset:6144
ds_read_b64_tr_b16 v[228:229], v253 offset:8192
ds_read_b64_tr_b16 v[230:231], v253 offset:10240
ds_read_b128 v[208:211], v251 offset:43008
ds_read_b128 v[212:215], v251 offset:45056
ds_read_b128 v[216:219], v251 offset:47104
ds_read_b128 v[132:135], v251 offset:49152
s_waitcnt lgkmcnt(8)
v_mfma_f32_16x16x32_bf16 v[60:63], v[220:223], v[204:207], v[60:63]
ds_read_b64_tr_b16 v[120:121], v253 offset:12288
ds_read_b64_tr_b16 v[122:123], v253 offset:14336
s_waitcnt lgkmcnt(8)
v_mfma_f32_16x16x32_bf16 v[80:83], v[224:227], v[204:207], v[80:83]
ds_read_b128 v[136:139], v252 offset:40960
s_waitcnt lgkmcnt(7)
v_mfma_f32_16x16x32_bf16 v[100:103], v[228:231], v[204:207], v[100:103]
s_waitcnt lgkmcnt(6)
v_mfma_f32_16x16x32_bf16 v[64:67], v[220:223], v[208:211], v[64:67]
ds_read_b64_tr_b16 v[124:125], v253 offset:16384
ds_read_b64_tr_b16 v[126:127], v253 offset:18432
v_mfma_f32_16x16x32_bf16 v[84:87], v[224:227], v[208:211], v[84:87]
ds_read_b128 v[200:203], v252 offset:43008
v_mfma_f32_16x16x32_bf16 v[104:107], v[228:231], v[208:211], v[104:107]
s_waitcnt lgkmcnt(8)
v_mfma_f32_16x16x32_bf16 v[68:71], v[220:223], v[212:215], v[68:71]
ds_read_b64_tr_b16 v[128:129], v253 offset:20480
ds_read_b64_tr_b16 v[130:131], v253 offset:22528
v_mfma_f32_16x16x32_bf16 v[88:91], v[224:227], v[212:215], v[88:91]
ds_read_b128 v[204:207], v252 offset:45056
v_mfma_f32_16x16x32_bf16 v[108:111], v[228:231], v[212:215], v[108:111]
s_waitcnt lgkmcnt(10)
v_mfma_f32_16x16x32_bf16 v[72:75], v[220:223], v[216:219], v[72:75]
v_mfma_f32_16x16x32_bf16 v[92:95], v[224:227], v[216:219], v[92:95]
ds_read_b128 v[208:211], v252 offset:47104
v_mfma_f32_16x16x32_bf16 v[112:115], v[228:231], v[216:219], v[112:115]
s_waitcnt lgkmcnt(10)
v_mfma_f32_16x16x32_bf16 v[76:79], v[220:223], v[132:135], v[76:79]
v_mfma_f32_16x16x32_bf16 v[96:99], v[224:227], v[132:135], v[96:99]
ds_read_b128 v[212:215], v252 offset:49152
v_mfma_f32_16x16x32_bf16 v[116:119], v[228:231], v[132:135], v[116:119]
s_waitcnt lgkmcnt(2)
v_mfma_f32_16x16x32_bf16 v[60:63], v[120:123], v[136:139], v[60:63]
v_mfma_f32_16x16x32_bf16 v[80:83], v[124:127], v[136:139], v[80:83]
v_mfma_f32_16x16x32_bf16 v[100:103], v[128:131], v[136:139], v[100:103]
v_mfma_f32_16x16x32_bf16 v[64:67], v[120:123], v[200:203], v[64:67]
v_mfma_f32_16x16x32_bf16 v[84:87], v[124:127], v[200:203], v[84:87]
v_mfma_f32_16x16x32_bf16 v[104:107], v[128:131], v[200:203], v[104:107]
v_mfma_f32_16x16x32_bf16 v[68:71], v[120:123], v[204:207], v[68:71]
v_mfma_f32_16x16x32_bf16 v[88:91], v[124:127], v[204:207], v[88:91]
v_mfma_f32_16x16x32_bf16 v[108:111], v[128:131], v[204:207], v[108:111]
s_waitcnt lgkmcnt(0)
v_mfma_f32_16x16x32_bf16 v[72:75], v[120:123], v[208:211], v[72:75]
v_mfma_f32_16x16x32_bf16 v[92:95], v[124:127], v[208:211], v[92:95]
v_mfma_f32_16x16x32_bf16 v[112:115], v[128:131], v[208:211], v[112:115]
v_mfma_f32_16x16x32_bf16 v[76:79], v[120:123], v[212:215], v[76:79]
v_mfma_f32_16x16x32_bf16 v[96:99], v[124:127], v[212:215], v[96:99]
v_mfma_f32_16x16x32_bf16 v[116:119], v[128:131], v[212:215], v[116:119]
s_barrier
ds_read_b64_tr_b16 v[220:221], v253 offset:24576
ds_read_b64_tr_b16 v[222:223], v253 offset:26624
ds_read_b128 v[216:219], v251 offset:0
ds_read_b64_tr_b16 v[224:225], v253 offset:28672
ds_read_b64_tr_b16 v[226:227], v253 offset:30720
ds_read_b64_tr_b16 v[228:229], v253 offset:32768
ds_read_b64_tr_b16 v[230:231], v253 offset:34816
ds_read_b128 v[132:135], v251 offset:2048
ds_read_b128 v[136:139], v251 offset:4096
ds_read_b128 v[200:203], v251 offset:6144
ds_read_b128 v[204:207], v251 offset:8192
s_waitcnt lgkmcnt(8)
v_mfma_f32_16x16x32_bf16 v[60:63], v[220:223], v[216:219], v[60:63]
ds_read_b64_tr_b16 v[120:121], v253 offset:36864
ds_read_b64_tr_b16 v[122:123], v253 offset:38912
s_waitcnt lgkmcnt(8)
v_mfma_f32_16x16x32_bf16 v[80:83], v[224:227], v[216:219], v[80:83]
ds_read_b128 v[208:211], v252 offset:0
s_waitcnt lgkmcnt(7)
v_mfma_f32_16x16x32_bf16 v[100:103], v[228:231], v[216:219], v[100:103]
s_waitcnt lgkmcnt(6)
v_mfma_f32_16x16x32_bf16 v[64:67], v[220:223], v[132:135], v[64:67]
ds_read_b64_tr_b16 v[124:125], v253 offset:40960
ds_read_b64_tr_b16 v[126:127], v253 offset:43008
v_mfma_f32_16x16x32_bf16 v[84:87], v[224:227], v[132:135], v[84:87]
ds_read_b128 v[212:215], v252 offset:2048
v_mfma_f32_16x16x32_bf16 v[104:107], v[228:231], v[132:135], v[104:107]
s_waitcnt lgkmcnt(8)
v_mfma_f32_16x16x32_bf16 v[68:71], v[220:223], v[136:139], v[68:71]
ds_read_b64_tr_b16 v[128:129], v253 offset:45056
ds_read_b64_tr_b16 v[130:131], v253 offset:47104
v_mfma_f32_16x16x32_bf16 v[88:91], v[224:227], v[136:139], v[88:91]
ds_read_b128 v[216:219], v252 offset:4096
v_mfma_f32_16x16x32_bf16 v[108:111], v[228:231], v[136:139], v[108:111]
s_waitcnt lgkmcnt(10)
v_mfma_f32_16x16x32_bf16 v[72:75], v[220:223], v[200:203], v[72:75]
v_mfma_f32_16x16x32_bf16 v[92:95], v[224:227], v[200:203], v[92:95]
ds_read_b128 v[132:135], v252 offset:6144
v_mfma_f32_16x16x32_bf16 v[112:115], v[228:231], v[200:203], v[112:115]
s_waitcnt lgkmcnt(10)
v_mfma_f32_16x16x32_bf16 v[76:79], v[220:223], v[204:207], v[76:79]
v_mfma_f32_16x16x32_bf16 v[96:99], v[224:227], v[204:207], v[96:99]
ds_read_b128 v[136:139], v252 offset:8192
v_mfma_f32_16x16x32_bf16 v[116:119], v[228:231], v[204:207], v[116:119]
s_waitcnt lgkmcnt(2)
v_mfma_f32_16x16x32_bf16 v[60:63], v[120:123], v[208:211], v[60:63]
v_mfma_f32_16x16x32_bf16 v[80:83], v[124:127], v[208:211], v[80:83]
v_mfma_f32_16x16x32_bf16 v[100:103], v[128:131], v[208:211], v[100:103]
v_mfma_f32_16x16x32_bf16 v[64:67], v[120:123], v[212:215], v[64:67]
v_mfma_f32_16x16x32_bf16 v[84:87], v[124:127], v[212:215], v[84:87]
v_mfma_f32_16x16x32_bf16 v[104:107], v[128:131], v[212:215], v[104:107]
v_mfma_f32_16x16x32_bf16 v[68:71], v[120:123], v[216:219], v[68:71]
v_mfma_f32_16x16x32_bf16 v[88:91], v[124:127], v[216:219], v[88:91]
v_mfma_f32_16x16x32_bf16 v[108:111], v[128:131], v[216:219], v[108:111]
s_waitcnt lgkmcnt(0)
v_mfma_f32_16x16x32_bf16 v[72:75], v[120:123], v[132:135], v[72:75]
v_mfma_f32_16x16x32_bf16 v[92:95], v[124:127], v[132:135], v[92:95]
v_mfma_f32_16x16x32_bf16 v[112:115], v[128:131], v[132:135], v[112:115]
v_mfma_f32_16x16x32_bf16 v[76:79], v[120:123], v[136:139], v[76:79]
v_mfma_f32_16x16x32_bf16 v[96:99], v[124:127], v[136:139], v[96:99]
v_mfma_f32_16x16x32_bf16 v[116:119], v[128:131], v[136:139], v[116:119]
s_barrier
ds_read_b64_tr_b16 v[220:221], v253 offset:49152
ds_read_b64_tr_b16 v[222:223], v253 offset:51200
ds_read_b128 v[200:203], v251 offset:10240
ds_read_b64_tr_b16 v[224:225], v253 offset:53248
ds_read_b64_tr_b16 v[226:227], v253 offset:55296
ds_read_b64_tr_b16 v[228:229], v253 offset:57344
ds_read_b64_tr_b16 v[230:231], v253 offset:59392
ds_read_b128 v[204:207], v251 offset:12288
ds_read_b128 v[208:211], v251 offset:14336
ds_read_b128 v[212:215], v251 offset:16384
ds_read_b128 v[216:219], v251 offset:18432
s_waitcnt lgkmcnt(8)
v_mfma_f32_16x16x32_bf16 v[60:63], v[220:223], v[200:203], v[60:63]
ds_read_b64_tr_b16 v[120:121], v253 offset:0
ds_read_b64_tr_b16 v[122:123], v253 offset:2048
s_waitcnt lgkmcnt(8)
v_mfma_f32_16x16x32_bf16 v[80:83], v[224:227], v[200:203], v[80:83]
ds_read_b128 v[132:135], v252 offset:10240
s_waitcnt lgkmcnt(7)
v_mfma_f32_16x16x32_bf16 v[100:103], v[228:231], v[200:203], v[100:103]
s_waitcnt lgkmcnt(6)
v_mfma_f32_16x16x32_bf16 v[64:67], v[220:223], v[204:207], v[64:67]
ds_read_b64_tr_b16 v[124:125], v253 offset:4096
ds_read_b64_tr_b16 v[126:127], v253 offset:6144
v_mfma_f32_16x16x32_bf16 v[84:87], v[224:227], v[204:207], v[84:87]
ds_read_b128 v[136:139], v252 offset:12288
v_mfma_f32_16x16x32_bf16 v[104:107], v[228:231], v[204:207], v[104:107]
s_waitcnt lgkmcnt(8)
v_mfma_f32_16x16x32_bf16 v[68:71], v[220:223], v[208:211], v[68:71]
ds_read_b64_tr_b16 v[128:129], v253 offset:8192
ds_read_b64_tr_b16 v[130:131], v253 offset:10240
v_mfma_f32_16x16x32_bf16 v[88:91], v[224:227], v[208:211], v[88:91]
ds_read_b128 v[200:203], v252 offset:14336
v_mfma_f32_16x16x32_bf16 v[108:111], v[228:231], v[208:211], v[108:111]
s_waitcnt lgkmcnt(10)
v_mfma_f32_16x16x32_bf16 v[72:75], v[220:223], v[212:215], v[72:75]
v_mfma_f32_16x16x32_bf16 v[92:95], v[224:227], v[212:215], v[92:95]
ds_read_b128 v[204:207], v252 offset:16384
v_mfma_f32_16x16x32_bf16 v[112:115], v[228:231], v[212:215], v[112:115]
s_waitcnt lgkmcnt(10)
v_mfma_f32_16x16x32_bf16 v[76:79], v[220:223], v[216:219], v[76:79]
v_mfma_f32_16x16x32_bf16 v[96:99], v[224:227], v[216:219], v[96:99]
ds_read_b128 v[208:211], v252 offset:18432
v_mfma_f32_16x16x32_bf16 v[116:119], v[228:231], v[216:219], v[116:119]
s_waitcnt lgkmcnt(2)
v_mfma_f32_16x16x32_bf16 v[60:63], v[120:123], v[132:135], v[60:63]
v_mfma_f32_16x16x32_bf16 v[80:83], v[124:127], v[132:135], v[80:83]
v_mfma_f32_16x16x32_bf16 v[100:103], v[128:131], v[132:135], v[100:103]
v_mfma_f32_16x16x32_bf16 v[64:67], v[120:123], v[136:139], v[64:67]
v_mfma_f32_16x16x32_bf16 v[84:87], v[124:127], v[136:139], v[84:87]
v_mfma_f32_16x16x32_bf16 v[104:107], v[128:131], v[136:139], v[104:107]
v_mfma_f32_16x16x32_bf16 v[68:71], v[120:123], v[200:203], v[68:71]
v_mfma_f32_16x16x32_bf16 v[88:91], v[124:127], v[200:203], v[88:91]
v_mfma_f32_16x16x32_bf16 v[108:111], v[128:131], v[200:203], v[108:111]
s_waitcnt lgkmcnt(0)
v_mfma_f32_16x16x32_bf16 v[72:75], v[120:123], v[204:207], v[72:75]
v_mfma_f32_16x16x32_bf16 v[92:95], v[124:127], v[204:207], v[92:95]
v_mfma_f32_16x16x32_bf16 v[112:115], v[128:131], v[204:207], v[112:115]
v_mfma_f32_16x16x32_bf16 v[76:79], v[120:123], v[208:211], v[76:79]
v_mfma_f32_16x16x32_bf16 v[96:99], v[124:127], v[208:211], v[96:99]
v_mfma_f32_16x16x32_bf16 v[116:119], v[128:131], v[208:211], v[116:119]
s_barrier
ds_read_b64_tr_b16 v[220:221], v253 offset:12288
ds_read_b64_tr_b16 v[222:223], v253 offset:14336
ds_read_b128 v[212:215], v251 offset:40960
ds_read_b64_tr_b16 v[224:225], v253 offset:16384
ds_read_b64_tr_b16 v[226:227], v253 offset:18432
ds_read_b64_tr_b16 v[228:229], v253 offset:20480
ds_read_b64_tr_b16 v[230:231], v253 offset:22528
ds_read_b128 v[216:219], v251 offset:43008
ds_read_b128 v[132:135], v251 offset:45056
ds_read_b128 v[136:139], v251 offset:47104
ds_read_b128 v[200:203], v251 offset:49152
s_waitcnt lgkmcnt(8)
v_mfma_f32_16x16x32_bf16 v[60:63], v[220:223], v[212:215], v[60:63]
ds_read_b64_tr_b16 v[120:121], v253 offset:24576
ds_read_b64_tr_b16 v[122:123], v253 offset:26624
s_waitcnt lgkmcnt(8)
v_mfma_f32_16x16x32_bf16 v[80:83], v[224:227], v[212:215], v[80:83]
ds_read_b128 v[204:207], v252 offset:40960
s_waitcnt lgkmcnt(7)
v_mfma_f32_16x16x32_bf16 v[100:103], v[228:231], v[212:215], v[100:103]
s_waitcnt lgkmcnt(6)
v_mfma_f32_16x16x32_bf16 v[64:67], v[220:223], v[216:219], v[64:67]
ds_read_b64_tr_b16 v[124:125], v253 offset:28672
ds_read_b64_tr_b16 v[126:127], v253 offset:30720
v_mfma_f32_16x16x32_bf16 v[84:87], v[224:227], v[216:219], v[84:87]
ds_read_b128 v[208:211], v252 offset:43008
v_mfma_f32_16x16x32_bf16 v[104:107], v[228:231], v[216:219], v[104:107]
s_waitcnt lgkmcnt(8)
v_mfma_f32_16x16x32_bf16 v[68:71], v[220:223], v[132:135], v[68:71]
ds_read_b64_tr_b16 v[128:129], v253 offset:32768
ds_read_b64_tr_b16 v[130:131], v253 offset:34816
v_mfma_f32_16x16x32_bf16 v[88:91], v[224:227], v[132:135], v[88:91]
ds_read_b128 v[212:215], v252 offset:45056
v_mfma_f32_16x16x32_bf16 v[108:111], v[228:231], v[132:135], v[108:111]
s_waitcnt lgkmcnt(10)
v_mfma_f32_16x16x32_bf16 v[72:75], v[220:223], v[136:139], v[72:75]
v_mfma_f32_16x16x32_bf16 v[92:95], v[224:227], v[136:139], v[92:95]
ds_read_b128 v[216:219], v252 offset:47104
v_mfma_f32_16x16x32_bf16 v[112:115], v[228:231], v[136:139], v[112:115]
s_waitcnt lgkmcnt(10)
v_mfma_f32_16x16x32_bf16 v[76:79], v[220:223], v[200:203], v[76:79]
v_mfma_f32_16x16x32_bf16 v[96:99], v[224:227], v[200:203], v[96:99]
ds_read_b128 v[132:135], v252 offset:49152
v_mfma_f32_16x16x32_bf16 v[116:119], v[228:231], v[200:203], v[116:119]
s_waitcnt lgkmcnt(2)
v_mfma_f32_16x16x32_bf16 v[60:63], v[120:123], v[204:207], v[60:63]
v_mfma_f32_16x16x32_bf16 v[80:83], v[124:127], v[204:207], v[80:83]
v_mfma_f32_16x16x32_bf16 v[100:103], v[128:131], v[204:207], v[100:103]
v_mfma_f32_16x16x32_bf16 v[64:67], v[120:123], v[208:211], v[64:67]
v_mfma_f32_16x16x32_bf16 v[84:87], v[124:127], v[208:211], v[84:87]
v_mfma_f32_16x16x32_bf16 v[104:107], v[128:131], v[208:211], v[104:107]
v_mfma_f32_16x16x32_bf16 v[68:71], v[120:123], v[212:215], v[68:71]
v_mfma_f32_16x16x32_bf16 v[88:91], v[124:127], v[212:215], v[88:91]
v_mfma_f32_16x16x32_bf16 v[108:111], v[128:131], v[212:215], v[108:111]
s_waitcnt lgkmcnt(0)
v_mfma_f32_16x16x32_bf16 v[72:75], v[120:123], v[216:219], v[72:75]
v_mfma_f32_16x16x32_bf16 v[92:95], v[124:127], v[216:219], v[92:95]
v_mfma_f32_16x16x32_bf16 v[112:115], v[128:131], v[216:219], v[112:115]
v_mfma_f32_16x16x32_bf16 v[76:79], v[120:123], v[132:135], v[76:79]
v_mfma_f32_16x16x32_bf16 v[96:99], v[124:127], v[132:135], v[96:99]
v_mfma_f32_16x16x32_bf16 v[116:119], v[128:131], v[132:135], v[116:119]
s_barrier
ds_read_b64_tr_b16 v[220:221], v253 offset:36864
ds_read_b64_tr_b16 v[222:223], v253 offset:38912
ds_read_b128 v[136:139], v251 offset:0
ds_read_b64_tr_b16 v[224:225], v253 offset:40960
ds_read_b64_tr_b16 v[226:227], v253 offset:43008
ds_read_b64_tr_b16 v[228:229], v253 offset:45056
ds_read_b64_tr_b16 v[230:231], v253 offset:47104
ds_read_b128 v[200:203], v251 offset:2048
ds_read_b128 v[204:207], v251 offset:4096
ds_read_b128 v[208:211], v251 offset:6144
ds_read_b128 v[212:215], v251 offset:8192
s_waitcnt lgkmcnt(8)
v_mfma_f32_16x16x32_bf16 v[60:63], v[220:223], v[136:139], v[60:63]
ds_read_b64_tr_b16 v[120:121], v253 offset:49152
ds_read_b64_tr_b16 v[122:123], v253 offset:51200
s_waitcnt lgkmcnt(8)
v_mfma_f32_16x16x32_bf16 v[80:83], v[224:227], v[136:139], v[80:83]
ds_read_b128 v[216:219], v252 offset:0
s_waitcnt lgkmcnt(7)
v_mfma_f32_16x16x32_bf16 v[100:103], v[228:231], v[136:139], v[100:103]
s_waitcnt lgkmcnt(6)
v_mfma_f32_16x16x32_bf16 v[64:67], v[220:223], v[200:203], v[64:67]
ds_read_b64_tr_b16 v[124:125], v253 offset:53248
ds_read_b64_tr_b16 v[126:127], v253 offset:55296
v_mfma_f32_16x16x32_bf16 v[84:87], v[224:227], v[200:203], v[84:87]
ds_read_b128 v[132:135], v252 offset:2048
v_mfma_f32_16x16x32_bf16 v[104:107], v[228:231], v[200:203], v[104:107]
s_waitcnt lgkmcnt(8)
v_mfma_f32_16x16x32_bf16 v[68:71], v[220:223], v[204:207], v[68:71]
ds_read_b64_tr_b16 v[128:129], v253 offset:57344
ds_read_b64_tr_b16 v[130:131], v253 offset:59392
v_mfma_f32_16x16x32_bf16 v[88:91], v[224:227], v[204:207], v[88:91]
ds_read_b128 v[136:139], v252 offset:4096
v_mfma_f32_16x16x32_bf16 v[108:111], v[228:231], v[204:207], v[108:111]
s_waitcnt lgkmcnt(10)
v_mfma_f32_16x16x32_bf16 v[72:75], v[220:223], v[208:211], v[72:75]
v_mfma_f32_16x16x32_bf16 v[92:95], v[224:227], v[208:211], v[92:95]
ds_read_b128 v[200:203], v252 offset:6144
v_mfma_f32_16x16x32_bf16 v[112:115], v[228:231], v[208:211], v[112:115]
s_waitcnt lgkmcnt(10)
v_mfma_f32_16x16x32_bf16 v[76:79], v[220:223], v[212:215], v[76:79]
v_mfma_f32_16x16x32_bf16 v[96:99], v[224:227], v[212:215], v[96:99]
ds_read_b128 v[204:207], v252 offset:8192
v_mfma_f32_16x16x32_bf16 v[116:119], v[228:231], v[212:215], v[116:119]
s_waitcnt lgkmcnt(0)
s_barrier
v_mfma_f32_16x16x32_bf16 v[60:63], v[120:123], v[216:219], v[60:63]
v_mfma_f32_16x16x32_bf16 v[80:83], v[124:127], v[216:219], v[80:83]
v_mfma_f32_16x16x32_bf16 v[100:103], v[128:131], v[216:219], v[100:103]
v_mfma_f32_16x16x32_bf16 v[64:67], v[120:123], v[132:135], v[64:67]
v_mfma_f32_16x16x32_bf16 v[84:87], v[124:127], v[132:135], v[84:87]
v_mfma_f32_16x16x32_bf16 v[104:107], v[128:131], v[132:135], v[104:107]
v_mfma_f32_16x16x32_bf16 v[68:71], v[120:123], v[136:139], v[68:71]
v_mfma_f32_16x16x32_bf16 v[88:91], v[124:127], v[136:139], v[88:91]
v_mfma_f32_16x16x32_bf16 v[108:111], v[128:131], v[136:139], v[108:111]
v_mfma_f32_16x16x32_bf16 v[72:75], v[120:123], v[200:203], v[72:75]
v_mfma_f32_16x16x32_bf16 v[92:95], v[124:127], v[200:203], v[92:95]
v_mfma_f32_16x16x32_bf16 v[112:115], v[128:131], v[200:203], v[112:115]
v_cvt_pk_bf16_f32 v140, v60, v61
v_cvt_pk_bf16_f32 v141, v62, v63
ds_write_b64 v249, v[140:141] offset:0
v_cvt_pk_bf16_f32 v150, v80, v81
v_cvt_pk_bf16_f32 v151, v82, v83
ds_write_b64 v249, v[150:151] offset:10240
v_cvt_pk_bf16_f32 v160, v100, v101
v_cvt_pk_bf16_f32 v161, v102, v103
ds_write_b64 v249, v[160:161] offset:20480
v_mfma_f32_16x16x32_bf16 v[76:79], v[120:123], v[204:207], v[76:79]
v_mfma_f32_16x16x32_bf16 v[96:99], v[124:127], v[204:207], v[96:99]
v_mfma_f32_16x16x32_bf16 v[116:119], v[128:131], v[204:207], v[116:119]
v_cvt_pk_bf16_f32 v142, v64, v65
v_cvt_pk_bf16_f32 v143, v66, v67
ds_write_b64 v249, v[142:143] offset:1024
v_cvt_pk_bf16_f32 v152, v84, v85
v_cvt_pk_bf16_f32 v153, v86, v87
ds_write_b64 v249, v[152:153] offset:11264
v_cvt_pk_bf16_f32 v162, v104, v105
v_cvt_pk_bf16_f32 v163, v106, v107
ds_write_b64 v249, v[162:163] offset:21504
v_cvt_pk_bf16_f32 v144, v68, v69
v_cvt_pk_bf16_f32 v145, v70, v71
ds_write_b64 v249, v[144:145] offset:2048
v_cvt_pk_bf16_f32 v154, v88, v89
v_cvt_pk_bf16_f32 v155, v90, v91
ds_write_b64 v249, v[154:155] offset:12288
v_cvt_pk_bf16_f32 v164, v108, v109
v_cvt_pk_bf16_f32 v165, v110, v111
ds_write_b64 v249, v[164:165] offset:22528
v_cvt_pk_bf16_f32 v146, v72, v73
v_cvt_pk_bf16_f32 v147, v74, v75
ds_write_b64 v249, v[146:147] offset:3072
v_cvt_pk_bf16_f32 v156, v92, v93
v_cvt_pk_bf16_f32 v157, v94, v95
ds_write_b64 v249, v[156:157] offset:13312
v_cvt_pk_bf16_f32 v166, v112, v113
v_cvt_pk_bf16_f32 v167, v114, v115
ds_write_b64 v249, v[166:167] offset:23552
v_cvt_pk_bf16_f32 v148, v76, v77
v_cvt_pk_bf16_f32 v149, v78, v79
ds_write_b64 v249, v[148:149] offset:4096
v_cvt_pk_bf16_f32 v158, v96, v97
v_cvt_pk_bf16_f32 v159, v98, v99
ds_write_b64 v249, v[158:159] offset:14336
v_cvt_pk_bf16_f32 v168, v116, v117
v_cvt_pk_bf16_f32 v169, v118, v119
ds_write_b64 v249, v[168:169] offset:24576
s_waitcnt vmcnt(0)
s_waitcnt lgkmcnt(0)
s_barrier
ds_read_b128 v[220:223], v247 offset:0
ds_read_b128 v[0:3], v248 offset:0
ds_read_b128 v[4:7], v248 offset:1024
ds_read_b128 v[8:11], v248 offset:2048
ds_read_b128 v[12:15], v248 offset:3072
ds_read_b128 v[16:19], v248 offset:4096
ds_read_b128 v[224:227], v254 offset:0
ds_read_b128 v[20:23], v248 offset:5120
ds_read_b128 v[24:27], v248 offset:6144
ds_read_b128 v[28:31], v248 offset:7168
ds_read_b128 v[32:35], v248 offset:8192
ds_read_b128 v[36:39], v248 offset:9216
ds_read_b128 v[228:231], v247 offset:8192
ds_read_b128 v[242:245], v254 offset:8192
v_mov_b32 v232, 0xff800000
v_mov_b32 v233, 0xff800000
v_mov_b32 v234, 0xff800000
v_mov_b32 v235, 0xff800000
v_mov_b32 v236, 0xff800000
s_waitcnt lgkmcnt(12)
v_mfma_f32_16x16x32_bf16 v[200:203], v[220:223], v[0:3], 0
s_waitcnt lgkmcnt(11)
v_mfma_f32_16x16x32_bf16 v[204:207], v[220:223], v[4:7], 0
s_waitcnt lgkmcnt(10)
v_mfma_f32_16x16x32_bf16 v[208:211], v[220:223], v[8:11], 0
s_waitcnt lgkmcnt(9)
v_mfma_f32_16x16x32_bf16 v[212:215], v[220:223], v[12:15], 0
s_waitcnt lgkmcnt(8)
v_mfma_f32_16x16x32_bf16 v[216:219], v[220:223], v[16:19], 0
ds_read_b128 v[220:223], v247 offset:16384
ds_read_b128 v[40:43], v248 offset:10240
ds_read_b128 v[44:47], v248 offset:11264
ds_read_b128 v[48:51], v248 offset:12288
ds_read_b128 v[52:55], v248 offset:13312
ds_read_b128 v[56:59], v248 offset:14336
s_waitcnt lgkmcnt(12)
v_mfma_f32_16x16x32_bf16 v[200:203], v[224:227], v[20:23], v[200:203]
s_waitcnt lgkmcnt(11)
v_mfma_f32_16x16x32_bf16 v[204:207], v[224:227], v[24:27], v[204:207]
s_waitcnt lgkmcnt(10)
v_mfma_f32_16x16x32_bf16 v[208:211], v[224:227], v[28:31], v[208:211]
s_waitcnt lgkmcnt(9)
v_mfma_f32_16x16x32_bf16 v[212:215], v[224:227], v[32:35], v[212:215]
s_waitcnt lgkmcnt(8)
v_mfma_f32_16x16x32_bf16 v[216:219], v[224:227], v[36:39], v[216:219]
ds_read_b128 v[224:227], v254 offset:16384
ds_read_b128 v[60:63], v248 offset:15360
ds_read_b128 v[64:67], v248 offset:16384
ds_read_b128 v[68:71], v248 offset:17408
ds_read_b128 v[72:75], v248 offset:18432
ds_read_b128 v[76:79], v248 offset:19456
s_waitcnt lgkmcnt(10)
v_mfma_f32_16x16x32_bf16 v[200:203], v[228:231], v[40:43], v[200:203]
s_waitcnt lgkmcnt(9)
v_mfma_f32_16x16x32_bf16 v[204:207], v[228:231], v[44:47], v[204:207]
s_waitcnt lgkmcnt(8)
v_mfma_f32_16x16x32_bf16 v[208:211], v[228:231], v[48:51], v[208:211]
s_waitcnt lgkmcnt(7)
v_mfma_f32_16x16x32_bf16 v[212:215], v[228:231], v[52:55], v[212:215]
s_waitcnt lgkmcnt(6)
v_mfma_f32_16x16x32_bf16 v[216:219], v[228:231], v[56:59], v[216:219]
ds_read_b128 v[80:83], v248 offset:20480
ds_read_b128 v[84:87], v248 offset:21504
ds_read_b128 v[88:91], v248 offset:22528
ds_read_b128 v[92:95], v248 offset:23552
ds_read_b128 v[96:99], v248 offset:24576
s_waitcnt lgkmcnt(9)
v_mfma_f32_16x16x32_bf16 v[200:203], v[242:245], v[60:63], v[200:203]
s_waitcnt lgkmcnt(8)
v_mfma_f32_16x16x32_bf16 v[204:207], v[242:245], v[64:67], v[204:207]
s_waitcnt lgkmcnt(7)
v_mfma_f32_16x16x32_bf16 v[208:211], v[242:245], v[68:71], v[208:211]
s_waitcnt lgkmcnt(6)
v_mfma_f32_16x16x32_bf16 v[212:215], v[242:245], v[72:75], v[212:215]
s_waitcnt lgkmcnt(5)
v_mfma_f32_16x16x32_bf16 v[216:219], v[242:245], v[76:79], v[216:219]
ds_read_b128 v[100:103], v248 offset:25600
ds_read_b128 v[104:107], v248 offset:26624
ds_read_b128 v[108:111], v248 offset:27648
ds_read_b128 v[112:115], v248 offset:28672
ds_read_b128 v[116:119], v248 offset:29696
s_waitcnt lgkmcnt(0)
s_barrier
v_mfma_f32_16x16x32_bf16 v[200:203], v[220:223], v[80:83], v[200:203]
v_mfma_f32_16x16x32_bf16 v[204:207], v[220:223], v[84:87], v[204:207]
v_mfma_f32_16x16x32_bf16 v[208:211], v[220:223], v[88:91], v[208:211]
v_mfma_f32_16x16x32_bf16 v[212:215], v[220:223], v[92:95], v[212:215]
v_mfma_f32_16x16x32_bf16 v[216:219], v[220:223], v[96:99], v[216:219]
v_mfma_f32_16x16x32_bf16 v[200:203], v[224:227], v[100:103], v[200:203]
v_mfma_f32_16x16x32_bf16 v[204:207], v[224:227], v[104:107], v[204:207]
v_mfma_f32_16x16x32_bf16 v[208:211], v[224:227], v[108:111], v[208:211]
v_mfma_f32_16x16x32_bf16 v[212:215], v[224:227], v[112:115], v[212:215]
v_mfma_f32_16x16x32_bf16 v[216:219], v[224:227], v[116:119], v[216:219]
s_nop 4
v_max3_f32 v232, v232, v200, v201
v_cvt_pk_bf16_f32 v120, v200, v201
v_max3_f32 v232, v232, v202, v203
v_cvt_pk_bf16_f32 v121, v202, v203
v_max3_f32 v233, v233, v204, v205
v_cvt_pk_bf16_f32 v124, v204, v205
v_max3_f32 v233, v233, v206, v207
v_cvt_pk_bf16_f32 v125, v206, v207
v_max3_f32 v234, v234, v208, v209
v_cvt_pk_bf16_f32 v128, v208, v209
v_max3_f32 v234, v234, v210, v211
v_cvt_pk_bf16_f32 v129, v210, v211
v_max3_f32 v235, v235, v212, v213
v_cvt_pk_bf16_f32 v132, v212, v213
v_max3_f32 v235, v235, v214, v215
v_cvt_pk_bf16_f32 v133, v214, v215
v_max3_f32 v236, v236, v216, v217
v_cvt_pk_bf16_f32 v136, v216, v217
v_max3_f32 v236, v236, v218, v219
v_cvt_pk_bf16_f32 v137, v218, v219
ds_read_b128 v[220:223], v247 offset:24576
ds_read_b128 v[224:227], v254 offset:24576
ds_read_b128 v[228:231], v247 offset:32768
ds_read_b128 v[242:245], v254 offset:32768
s_waitcnt lgkmcnt(3)
v_mfma_f32_16x16x32_bf16 v[200:203], v[220:223], v[0:3], 0
v_mfma_f32_16x16x32_bf16 v[204:207], v[220:223], v[4:7], 0
v_mfma_f32_16x16x32_bf16 v[208:211], v[220:223], v[8:11], 0
v_mfma_f32_16x16x32_bf16 v[212:215], v[220:223], v[12:15], 0
v_mfma_f32_16x16x32_bf16 v[216:219], v[220:223], v[16:19], 0
ds_read_b128 v[220:223], v247 offset:40960
s_waitcnt lgkmcnt(3)
v_mfma_f32_16x16x32_bf16 v[200:203], v[224:227], v[20:23], v[200:203]
v_mfma_f32_16x16x32_bf16 v[204:207], v[224:227], v[24:27], v[204:207]
v_mfma_f32_16x16x32_bf16 v[208:211], v[224:227], v[28:31], v[208:211]
v_mfma_f32_16x16x32_bf16 v[212:215], v[224:227], v[32:35], v[212:215]
v_mfma_f32_16x16x32_bf16 v[216:219], v[224:227], v[36:39], v[216:219]
ds_read_b128 v[224:227], v254 offset:40960
s_waitcnt lgkmcnt(3)
v_mfma_f32_16x16x32_bf16 v[200:203], v[228:231], v[40:43], v[200:203]
v_mfma_f32_16x16x32_bf16 v[204:207], v[228:231], v[44:47], v[204:207]
v_mfma_f32_16x16x32_bf16 v[208:211], v[228:231], v[48:51], v[208:211]
v_mfma_f32_16x16x32_bf16 v[212:215], v[228:231], v[52:55], v[212:215]
v_mfma_f32_16x16x32_bf16 v[216:219], v[228:231], v[56:59], v[216:219]
s_waitcnt lgkmcnt(0)
s_barrier
v_mfma_f32_16x16x32_bf16 v[200:203], v[242:245], v[60:63], v[200:203]
v_mfma_f32_16x16x32_bf16 v[204:207], v[242:245], v[64:67], v[204:207]
v_mfma_f32_16x16x32_bf16 v[208:211], v[242:245], v[68:71], v[208:211]
v_mfma_f32_16x16x32_bf16 v[212:215], v[242:245], v[72:75], v[212:215]
v_mfma_f32_16x16x32_bf16 v[216:219], v[242:245], v[76:79], v[216:219]
v_mfma_f32_16x16x32_bf16 v[200:203], v[220:223], v[80:83], v[200:203]
v_mfma_f32_16x16x32_bf16 v[204:207], v[220:223], v[84:87], v[204:207]
v_mfma_f32_16x16x32_bf16 v[208:211], v[220:223], v[88:91], v[208:211]
v_mfma_f32_16x16x32_bf16 v[212:215], v[220:223], v[92:95], v[212:215]
v_mfma_f32_16x16x32_bf16 v[216:219], v[220:223], v[96:99], v[216:219]
v_mfma_f32_16x16x32_bf16 v[200:203], v[224:227], v[100:103], v[200:203]
v_mfma_f32_16x16x32_bf16 v[204:207], v[224:227], v[104:107], v[204:207]
v_mfma_f32_16x16x32_bf16 v[208:211], v[224:227], v[108:111], v[208:211]
v_mfma_f32_16x16x32_bf16 v[212:215], v[224:227], v[112:115], v[212:215]
v_mfma_f32_16x16x32_bf16 v[216:219], v[224:227], v[116:119], v[216:219]
s_nop 4
v_max3_f32 v232, v232, v200, v201
v_cvt_pk_bf16_f32 v122, v200, v201
v_max3_f32 v232, v232, v202, v203
v_cvt_pk_bf16_f32 v123, v202, v203
v_max3_f32 v233, v233, v204, v205
v_cvt_pk_bf16_f32 v126, v204, v205
v_max3_f32 v233, v233, v206, v207
v_cvt_pk_bf16_f32 v127, v206, v207
v_max3_f32 v234, v234, v208, v209
v_cvt_pk_bf16_f32 v130, v208, v209
v_max3_f32 v234, v234, v210, v211
v_cvt_pk_bf16_f32 v131, v210, v211
v_max3_f32 v235, v235, v212, v213
v_cvt_pk_bf16_f32 v134, v212, v213
v_max3_f32 v235, v235, v214, v215
v_cvt_pk_bf16_f32 v135, v214, v215
v_max3_f32 v236, v236, v216, v217
v_cvt_pk_bf16_f32 v138, v216, v217
v_max3_f32 v236, v236, v218, v219
v_cvt_pk_bf16_f32 v139, v218, v219
v_add_u32 v237, 49152, v247
v_add_u32 v238, 49152, v254
ds_read_b128 v[220:223], v237 offset:0
ds_read_b128 v[224:227], v238 offset:0
ds_read_b128 v[228:231], v237 offset:8192
ds_read_b128 v[242:245], v238 offset:8192
s_waitcnt lgkmcnt(3)
v_mfma_f32_16x16x32_bf16 v[200:203], v[220:223], v[0:3], 0
v_mfma_f32_16x16x32_bf16 v[204:207], v[220:223], v[4:7], 0
v_mfma_f32_16x16x32_bf16 v[208:211], v[220:223], v[8:11], 0
v_mfma_f32_16x16x32_bf16 v[212:215], v[220:223], v[12:15], 0
v_mfma_f32_16x16x32_bf16 v[216:219], v[220:223], v[16:19], 0
ds_read_b128 v[220:223], v237 offset:16384
s_waitcnt lgkmcnt(3)
v_mfma_f32_16x16x32_bf16 v[200:203], v[224:227], v[20:23], v[200:203]
v_mfma_f32_16x16x32_bf16 v[204:207], v[224:227], v[24:27], v[204:207]
v_mfma_f32_16x16x32_bf16 v[208:211], v[224:227], v[28:31], v[208:211]
v_mfma_f32_16x16x32_bf16 v[212:215], v[224:227], v[32:35], v[212:215]
v_mfma_f32_16x16x32_bf16 v[216:219], v[224:227], v[36:39], v[216:219]
ds_read_b128 v[224:227], v238 offset:16384
s_waitcnt lgkmcnt(3)
v_mfma_f32_16x16x32_bf16 v[200:203], v[228:231], v[40:43], v[200:203]
v_mfma_f32_16x16x32_bf16 v[204:207], v[228:231], v[44:47], v[204:207]
v_mfma_f32_16x16x32_bf16 v[208:211], v[228:231], v[48:51], v[208:211]
v_mfma_f32_16x16x32_bf16 v[212:215], v[228:231], v[52:55], v[212:215]
v_mfma_f32_16x16x32_bf16 v[216:219], v[228:231], v[56:59], v[216:219]
s_waitcnt lgkmcnt(0)
s_barrier
v_mfma_f32_16x16x32_bf16 v[200:203], v[242:245], v[60:63], v[200:203]
v_mfma_f32_16x16x32_bf16 v[204:207], v[242:245], v[64:67], v[204:207]
v_mfma_f32_16x16x32_bf16 v[208:211], v[242:245], v[68:71], v[208:211]
v_mfma_f32_16x16x32_bf16 v[212:215], v[242:245], v[72:75], v[212:215]
v_mfma_f32_16x16x32_bf16 v[216:219], v[242:245], v[76:79], v[216:219]
v_mfma_f32_16x16x32_bf16 v[200:203], v[220:223], v[80:83], v[200:203]
v_mfma_f32_16x16x32_bf16 v[204:207], v[220:223], v[84:87], v[204:207]
v_mfma_f32_16x16x32_bf16 v[208:211], v[220:223], v[88:91], v[208:211]
v_mfma_f32_16x16x32_bf16 v[212:215], v[220:223], v[92:95], v[212:215]
v_mfma_f32_16x16x32_bf16 v[216:219], v[220:223], v[96:99], v[216:219]
v_mfma_f32_16x16x32_bf16 v[200:203], v[224:227], v[100:103], v[200:203]
v_mfma_f32_16x16x32_bf16 v[204:207], v[224:227], v[104:107], v[204:207]
v_mfma_f32_16x16x32_bf16 v[208:211], v[224:227], v[108:111], v[208:211]
v_mfma_f32_16x16x32_bf16 v[212:215], v[224:227], v[112:115], v[212:215]
v_mfma_f32_16x16x32_bf16 v[216:219], v[224:227], v[116:119], v[216:219]
s_nop 4
v_max3_f32 v232, v232, v200, v201
v_cvt_pk_bf16_f32 v140, v200, v201
v_max3_f32 v232, v232, v202, v203
v_cvt_pk_bf16_f32 v141, v202, v203
v_max3_f32 v233, v233, v204, v205
v_cvt_pk_bf16_f32 v144, v204, v205
v_max3_f32 v233, v233, v206, v207
v_cvt_pk_bf16_f32 v145, v206, v207
v_max3_f32 v234, v234, v208, v209
v_cvt_pk_bf16_f32 v148, v208, v209
v_max3_f32 v234, v234, v210, v211
v_cvt_pk_bf16_f32 v149, v210, v211
v_max3_f32 v235, v235, v212, v213
v_cvt_pk_bf16_f32 v152, v212, v213
v_max3_f32 v235, v235, v214, v215
v_cvt_pk_bf16_f32 v153, v214, v215
v_max3_f32 v236, v236, v216, v217
v_cvt_pk_bf16_f32 v156, v216, v217
v_max3_f32 v236, v236, v218, v219
v_cvt_pk_bf16_f32 v157, v218, v219
ds_read_b128 v[220:223], v237 offset:24576
ds_read_b128 v[224:227], v238 offset:24576
ds_read_b128 v[228:231], v237 offset:32768
ds_read_b128 v[242:245], v238 offset:32768
s_waitcnt lgkmcnt(3)
v_mfma_f32_16x16x32_bf16 v[200:203], v[220:223], v[0:3], 0
v_mfma_f32_16x16x32_bf16 v[204:207], v[220:223], v[4:7], 0
v_mfma_f32_16x16x32_bf16 v[208:211], v[220:223], v[8:11], 0
v_mfma_f32_16x16x32_bf16 v[212:215], v[220:223], v[12:15], 0
v_mfma_f32_16x16x32_bf16 v[216:219], v[220:223], v[16:19], 0
ds_read_b128 v[220:223], v237 offset:40960
s_waitcnt lgkmcnt(3)
v_mfma_f32_16x16x32_bf16 v[200:203], v[224:227], v[20:23], v[200:203]
v_mfma_f32_16x16x32_bf16 v[204:207], v[224:227], v[24:27], v[204:207]
v_mfma_f32_16x16x32_bf16 v[208:211], v[224:227], v[28:31], v[208:211]
v_mfma_f32_16x16x32_bf16 v[212:215], v[224:227], v[32:35], v[212:215]
v_mfma_f32_16x16x32_bf16 v[216:219], v[224:227], v[36:39], v[216:219]
ds_read_b128 v[224:227], v238 offset:40960
s_waitcnt lgkmcnt(3)
v_mfma_f32_16x16x32_bf16 v[200:203], v[228:231], v[40:43], v[200:203]
v_mfma_f32_16x16x32_bf16 v[204:207], v[228:231], v[44:47], v[204:207]
v_mfma_f32_16x16x32_bf16 v[208:211], v[228:231], v[48:51], v[208:211]
v_mfma_f32_16x16x32_bf16 v[212:215], v[228:231], v[52:55], v[212:215]
v_mfma_f32_16x16x32_bf16 v[216:219], v[228:231], v[56:59], v[216:219]
s_waitcnt lgkmcnt(0)
s_barrier
v_mfma_f32_16x16x32_bf16 v[200:203], v[242:245], v[60:63], v[200:203]
v_mfma_f32_16x16x32_bf16 v[204:207], v[242:245], v[64:67], v[204:207]
v_mfma_f32_16x16x32_bf16 v[208:211], v[242:245], v[68:71], v[208:211]
v_mfma_f32_16x16x32_bf16 v[212:215], v[242:245], v[72:75], v[212:215]
v_mfma_f32_16x16x32_bf16 v[216:219], v[242:245], v[76:79], v[216:219]
v_mfma_f32_16x16x32_bf16 v[200:203], v[220:223], v[80:83], v[200:203]
v_mfma_f32_16x16x32_bf16 v[204:207], v[220:223], v[84:87], v[204:207]
v_mfma_f32_16x16x32_bf16 v[208:211], v[220:223], v[88:91], v[208:211]
v_mfma_f32_16x16x32_bf16 v[212:215], v[220:223], v[92:95], v[212:215]
v_mfma_f32_16x16x32_bf16 v[216:219], v[220:223], v[96:99], v[216:219]
v_mfma_f32_16x16x32_bf16 v[200:203], v[224:227], v[100:103], v[200:203]
v_mfma_f32_16x16x32_bf16 v[204:207], v[224:227], v[104:107], v[204:207]
v_mfma_f32_16x16x32_bf16 v[208:211], v[224:227], v[108:111], v[208:211]
v_mfma_f32_16x16x32_bf16 v[212:215], v[224:227], v[112:115], v[212:215]
v_mfma_f32_16x16x32_bf16 v[216:219], v[224:227], v[116:119], v[216:219]
s_nop 4
v_max3_f32 v232, v232, v200, v201
v_cvt_pk_bf16_f32 v142, v200, v201
v_max3_f32 v232, v232, v202, v203
v_cvt_pk_bf16_f32 v143, v202, v203
v_max3_f32 v233, v233, v204, v205
v_cvt_pk_bf16_f32 v146, v204, v205
v_max3_f32 v233, v233, v206, v207
v_cvt_pk_bf16_f32 v147, v206, v207
v_max3_f32 v234, v234, v208, v209
v_cvt_pk_bf16_f32 v150, v208, v209
v_max3_f32 v234, v234, v210, v211
v_cvt_pk_bf16_f32 v151, v210, v211
v_max3_f32 v235, v235, v212, v213
v_cvt_pk_bf16_f32 v154, v212, v213
v_max3_f32 v235, v235, v214, v215
v_cvt_pk_bf16_f32 v155, v214, v215
v_max3_f32 v236, v236, v216, v217
v_cvt_pk_bf16_f32 v158, v216, v217
v_max3_f32 v236, v236, v218, v219
v_cvt_pk_bf16_f32 v159, v218, v219
ds_read_b128 v[220:223], v247 offset:0
ds_read_b128 v[224:227], v254 offset:0
ds_read_b128 v[228:231], v247 offset:8192
ds_read_b128 v[242:245], v254 offset:8192
s_waitcnt lgkmcnt(3)
v_mfma_f32_16x16x32_bf16 v[200:203], v[220:223], v[0:3], 0
v_mfma_f32_16x16x32_bf16 v[204:207], v[220:223], v[4:7], 0
v_mfma_f32_16x16x32_bf16 v[208:211], v[220:223], v[8:11], 0
v_mfma_f32_16x16x32_bf16 v[212:215], v[220:223], v[12:15], 0
v_mfma_f32_16x16x32_bf16 v[216:219], v[220:223], v[16:19], 0
ds_read_b128 v[220:223], v247 offset:16384
s_waitcnt lgkmcnt(3)
v_mfma_f32_16x16x32_bf16 v[200:203], v[224:227], v[20:23], v[200:203]
v_mfma_f32_16x16x32_bf16 v[204:207], v[224:227], v[24:27], v[204:207]
v_mfma_f32_16x16x32_bf16 v[208:211], v[224:227], v[28:31], v[208:211]
v_mfma_f32_16x16x32_bf16 v[212:215], v[224:227], v[32:35], v[212:215]
v_mfma_f32_16x16x32_bf16 v[216:219], v[224:227], v[36:39], v[216:219]
ds_read_b128 v[224:227], v254 offset:16384
s_waitcnt lgkmcnt(3)
v_mfma_f32_16x16x32_bf16 v[200:203], v[228:231], v[40:43], v[200:203]
v_mfma_f32_16x16x32_bf16 v[204:207], v[228:231], v[44:47], v[204:207]
v_mfma_f32_16x16x32_bf16 v[208:211], v[228:231], v[48:51], v[208:211]
v_mfma_f32_16x16x32_bf16 v[212:215], v[228:231], v[52:55], v[212:215]
v_mfma_f32_16x16x32_bf16 v[216:219], v[228:231], v[56:59], v[216:219]
s_waitcnt lgkmcnt(0)
s_barrier
v_mfma_f32_16x16x32_bf16 v[200:203], v[242:245], v[60:63], v[200:203]
v_mfma_f32_16x16x32_bf16 v[204:207], v[242:245], v[64:67], v[204:207]
v_mfma_f32_16x16x32_bf16 v[208:211], v[242:245], v[68:71], v[208:211]
v_mfma_f32_16x16x32_bf16 v[212:215], v[242:245], v[72:75], v[212:215]
v_mfma_f32_16x16x32_bf16 v[216:219], v[242:245], v[76:79], v[216:219]
v_mfma_f32_16x16x32_bf16 v[200:203], v[220:223], v[80:83], v[200:203]
v_mfma_f32_16x16x32_bf16 v[204:207], v[220:223], v[84:87], v[204:207]
v_mfma_f32_16x16x32_bf16 v[208:211], v[220:223], v[88:91], v[208:211]
v_mfma_f32_16x16x32_bf16 v[212:215], v[220:223], v[92:95], v[212:215]
v_mfma_f32_16x16x32_bf16 v[216:219], v[220:223], v[96:99], v[216:219]
v_mfma_f32_16x16x32_bf16 v[200:203], v[224:227], v[100:103], v[200:203]
v_mfma_f32_16x16x32_bf16 v[204:207], v[224:227], v[104:107], v[204:207]
v_mfma_f32_16x16x32_bf16 v[208:211], v[224:227], v[108:111], v[208:211]
v_mfma_f32_16x16x32_bf16 v[212:215], v[224:227], v[112:115], v[212:215]
v_mfma_f32_16x16x32_bf16 v[216:219], v[224:227], v[116:119], v[216:219]
s_nop 4
v_max3_f32 v232, v232, v200, v201
v_cvt_pk_bf16_f32 v160, v200, v201
v_max3_f32 v232, v232, v202, v203
v_cvt_pk_bf16_f32 v161, v202, v203
v_max3_f32 v233, v233, v204, v205
v_cvt_pk_bf16_f32 v164, v204, v205
v_max3_f32 v233, v233, v206, v207
v_cvt_pk_bf16_f32 v165, v206, v207
v_max3_f32 v234, v234, v208, v209
v_cvt_pk_bf16_f32 v168, v208, v209
v_max3_f32 v234, v234, v210, v211
v_cvt_pk_bf16_f32 v169, v210, v211
v_max3_f32 v235, v235, v212, v213
v_cvt_pk_bf16_f32 v172, v212, v213
v_max3_f32 v235, v235, v214, v215
v_cvt_pk_bf16_f32 v173, v214, v215
v_max3_f32 v236, v236, v216, v217
v_cvt_pk_bf16_f32 v176, v216, v217
v_max3_f32 v236, v236, v218, v219
v_cvt_pk_bf16_f32 v177, v218, v219
ds_read_b128 v[220:223], v247 offset:24576
ds_read_b128 v[224:227], v254 offset:24576
ds_read_b128 v[228:231], v247 offset:32768
ds_read_b128 v[242:245], v254 offset:32768
s_waitcnt lgkmcnt(3)
v_mfma_f32_16x16x32_bf16 v[200:203], v[220:223], v[0:3], 0
v_mfma_f32_16x16x32_bf16 v[204:207], v[220:223], v[4:7], 0
v_mfma_f32_16x16x32_bf16 v[208:211], v[220:223], v[8:11], 0
v_mfma_f32_16x16x32_bf16 v[212:215], v[220:223], v[12:15], 0
v_mfma_f32_16x16x32_bf16 v[216:219], v[220:223], v[16:19], 0
ds_read_b128 v[220:223], v247 offset:40960
s_waitcnt lgkmcnt(3)
v_mfma_f32_16x16x32_bf16 v[200:203], v[224:227], v[20:23], v[200:203]
v_mfma_f32_16x16x32_bf16 v[204:207], v[224:227], v[24:27], v[204:207]
v_mfma_f32_16x16x32_bf16 v[208:211], v[224:227], v[28:31], v[208:211]
v_mfma_f32_16x16x32_bf16 v[212:215], v[224:227], v[32:35], v[212:215]
v_mfma_f32_16x16x32_bf16 v[216:219], v[224:227], v[36:39], v[216:219]
ds_read_b128 v[224:227], v254 offset:40960
s_waitcnt lgkmcnt(3)
v_mfma_f32_16x16x32_bf16 v[200:203], v[228:231], v[40:43], v[200:203]
v_mfma_f32_16x16x32_bf16 v[204:207], v[228:231], v[44:47], v[204:207]
v_mfma_f32_16x16x32_bf16 v[208:211], v[228:231], v[48:51], v[208:211]
v_mfma_f32_16x16x32_bf16 v[212:215], v[228:231], v[52:55], v[212:215]
v_mfma_f32_16x16x32_bf16 v[216:219], v[228:231], v[56:59], v[216:219]
s_waitcnt lgkmcnt(0)
s_barrier
v_mfma_f32_16x16x32_bf16 v[200:203], v[242:245], v[60:63], v[200:203]
v_mfma_f32_16x16x32_bf16 v[204:207], v[242:245], v[64:67], v[204:207]
v_mfma_f32_16x16x32_bf16 v[208:211], v[242:245], v[68:71], v[208:211]
v_mfma_f32_16x16x32_bf16 v[212:215], v[242:245], v[72:75], v[212:215]
v_mfma_f32_16x16x32_bf16 v[216:219], v[242:245], v[76:79], v[216:219]
v_mfma_f32_16x16x32_bf16 v[200:203], v[220:223], v[80:83], v[200:203]
v_mfma_f32_16x16x32_bf16 v[204:207], v[220:223], v[84:87], v[204:207]
v_mfma_f32_16x16x32_bf16 v[208:211], v[220:223], v[88:91], v[208:211]
v_mfma_f32_16x16x32_bf16 v[212:215], v[220:223], v[92:95], v[212:215]
v_mfma_f32_16x16x32_bf16 v[216:219], v[220:223], v[96:99], v[216:219]
v_mfma_f32_16x16x32_bf16 v[200:203], v[224:227], v[100:103], v[200:203]
v_mfma_f32_16x16x32_bf16 v[204:207], v[224:227], v[104:107], v[204:207]
v_mfma_f32_16x16x32_bf16 v[208:211], v[224:227], v[108:111], v[208:211]
v_mfma_f32_16x16x32_bf16 v[212:215], v[224:227], v[112:115], v[212:215]
v_mfma_f32_16x16x32_bf16 v[216:219], v[224:227], v[116:119], v[216:219]
s_nop 4
v_max3_f32 v232, v232, v200, v201
v_cvt_pk_bf16_f32 v162, v200, v201
v_max3_f32 v232, v232, v202, v203
v_cvt_pk_bf16_f32 v163, v202, v203
v_max3_f32 v233, v233, v204, v205
v_cvt_pk_bf16_f32 v166, v204, v205
v_max3_f32 v233, v233, v206, v207
v_cvt_pk_bf16_f32 v167, v206, v207
v_max3_f32 v234, v234, v208, v209
v_cvt_pk_bf16_f32 v170, v208, v209
v_max3_f32 v234, v234, v210, v211
v_cvt_pk_bf16_f32 v171, v210, v211
v_max3_f32 v235, v235, v212, v213
v_cvt_pk_bf16_f32 v174, v212, v213
v_max3_f32 v235, v235, v214, v215
v_cvt_pk_bf16_f32 v175, v214, v215
v_max3_f32 v236, v236, v216, v217
v_cvt_pk_bf16_f32 v178, v216, v217
v_max3_f32 v236, v236, v218, v219
v_cvt_pk_bf16_f32 v179, v218, v219
ds_read_b128 v[220:223], v237 offset:0
ds_read_b128 v[224:227], v238 offset:0
ds_read_b128 v[228:231], v237 offset:8192
ds_read_b128 v[242:245], v238 offset:8192
s_waitcnt lgkmcnt(3)
v_mfma_f32_16x16x32_bf16 v[200:203], v[220:223], v[0:3], 0
v_mfma_f32_16x16x32_bf16 v[204:207], v[220:223], v[4:7], 0
v_mfma_f32_16x16x32_bf16 v[208:211], v[220:223], v[8:11], 0
v_mfma_f32_16x16x32_bf16 v[212:215], v[220:223], v[12:15], 0
v_mfma_f32_16x16x32_bf16 v[216:219], v[220:223], v[16:19], 0
ds_read_b128 v[220:223], v237 offset:16384
s_waitcnt lgkmcnt(3)
v_mfma_f32_16x16x32_bf16 v[200:203], v[224:227], v[20:23], v[200:203]
v_mfma_f32_16x16x32_bf16 v[204:207], v[224:227], v[24:27], v[204:207]
v_mfma_f32_16x16x32_bf16 v[208:211], v[224:227], v[28:31], v[208:211]
v_mfma_f32_16x16x32_bf16 v[212:215], v[224:227], v[32:35], v[212:215]
v_mfma_f32_16x16x32_bf16 v[216:219], v[224:227], v[36:39], v[216:219]
ds_read_b128 v[224:227], v238 offset:16384
s_waitcnt lgkmcnt(3)
v_mfma_f32_16x16x32_bf16 v[200:203], v[228:231], v[40:43], v[200:203]
v_mfma_f32_16x16x32_bf16 v[204:207], v[228:231], v[44:47], v[204:207]
v_mfma_f32_16x16x32_bf16 v[208:211], v[228:231], v[48:51], v[208:211]
v_mfma_f32_16x16x32_bf16 v[212:215], v[228:231], v[52:55], v[212:215]
v_mfma_f32_16x16x32_bf16 v[216:219], v[228:231], v[56:59], v[216:219]
s_waitcnt lgkmcnt(0)
s_barrier
v_mfma_f32_16x16x32_bf16 v[200:203], v[242:245], v[60:63], v[200:203]
v_mfma_f32_16x16x32_bf16 v[204:207], v[242:245], v[64:67], v[204:207]
v_mfma_f32_16x16x32_bf16 v[208:211], v[242:245], v[68:71], v[208:211]
v_mfma_f32_16x16x32_bf16 v[212:215], v[242:245], v[72:75], v[212:215]
v_mfma_f32_16x16x32_bf16 v[216:219], v[242:245], v[76:79], v[216:219]
v_mfma_f32_16x16x32_bf16 v[200:203], v[220:223], v[80:83], v[200:203]
v_mfma_f32_16x16x32_bf16 v[204:207], v[220:223], v[84:87], v[204:207]
v_mfma_f32_16x16x32_bf16 v[208:211], v[220:223], v[88:91], v[208:211]
v_mfma_f32_16x16x32_bf16 v[212:215], v[220:223], v[92:95], v[212:215]
v_mfma_f32_16x16x32_bf16 v[216:219], v[220:223], v[96:99], v[216:219]
v_mfma_f32_16x16x32_bf16 v[200:203], v[224:227], v[100:103], v[200:203]
v_mfma_f32_16x16x32_bf16 v[204:207], v[224:227], v[104:107], v[204:207]
v_mfma_f32_16x16x32_bf16 v[208:211], v[224:227], v[108:111], v[208:211]
v_mfma_f32_16x16x32_bf16 v[212:215], v[224:227], v[112:115], v[212:215]
v_mfma_f32_16x16x32_bf16 v[216:219], v[224:227], v[116:119], v[216:219]
s_nop 4
v_max3_f32 v232, v232, v200, v201
v_cvt_pk_bf16_f32 v180, v200, v201
v_max3_f32 v232, v232, v202, v203
v_cvt_pk_bf16_f32 v181, v202, v203
v_max3_f32 v233, v233, v204, v205
v_cvt_pk_bf16_f32 v184, v204, v205
v_max3_f32 v233, v233, v206, v207
v_cvt_pk_bf16_f32 v185, v206, v207
v_max3_f32 v234, v234, v208, v209
v_cvt_pk_bf16_f32 v188, v208, v209
v_max3_f32 v234, v234, v210, v211
v_cvt_pk_bf16_f32 v189, v210, v211
v_max3_f32 v235, v235, v212, v213
v_cvt_pk_bf16_f32 v192, v212, v213
v_max3_f32 v235, v235, v214, v215
v_cvt_pk_bf16_f32 v193, v214, v215
v_max3_f32 v236, v236, v216, v217
v_cvt_pk_bf16_f32 v196, v216, v217
v_max3_f32 v236, v236, v218, v219
v_cvt_pk_bf16_f32 v197, v218, v219
ds_read_b128 v[220:223], v237 offset:24576
ds_read_b128 v[224:227], v238 offset:24576
ds_read_b128 v[228:231], v237 offset:32768
ds_read_b128 v[242:245], v238 offset:32768
s_waitcnt lgkmcnt(3)
v_mfma_f32_16x16x32_bf16 v[200:203], v[220:223], v[0:3], 0
v_mfma_f32_16x16x32_bf16 v[204:207], v[220:223], v[4:7], 0
v_mfma_f32_16x16x32_bf16 v[208:211], v[220:223], v[8:11], 0
v_mfma_f32_16x16x32_bf16 v[212:215], v[220:223], v[12:15], 0
v_mfma_f32_16x16x32_bf16 v[216:219], v[220:223], v[16:19], 0
ds_read_b128 v[220:223], v237 offset:40960
s_waitcnt lgkmcnt(3)
v_mfma_f32_16x16x32_bf16 v[200:203], v[224:227], v[20:23], v[200:203]
v_mfma_f32_16x16x32_bf16 v[204:207], v[224:227], v[24:27], v[204:207]
v_mfma_f32_16x16x32_bf16 v[208:211], v[224:227], v[28:31], v[208:211]
v_mfma_f32_16x16x32_bf16 v[212:215], v[224:227], v[32:35], v[212:215]
v_mfma_f32_16x16x32_bf16 v[216:219], v[224:227], v[36:39], v[216:219]
ds_read_b128 v[224:227], v238 offset:40960
s_waitcnt lgkmcnt(3)
v_mfma_f32_16x16x32_bf16 v[200:203], v[228:231], v[40:43], v[200:203]
v_mfma_f32_16x16x32_bf16 v[204:207], v[228:231], v[44:47], v[204:207]
v_mfma_f32_16x16x32_bf16 v[208:211], v[228:231], v[48:51], v[208:211]
v_mfma_f32_16x16x32_bf16 v[212:215], v[228:231], v[52:55], v[212:215]
v_mfma_f32_16x16x32_bf16 v[216:219], v[228:231], v[56:59], v[216:219]
s_waitcnt lgkmcnt(2)
v_mfma_f32_16x16x32_bf16 v[200:203], v[242:245], v[60:63], v[200:203]
v_mfma_f32_16x16x32_bf16 v[204:207], v[242:245], v[64:67], v[204:207]
v_mfma_f32_16x16x32_bf16 v[208:211], v[242:245], v[68:71], v[208:211]
v_mfma_f32_16x16x32_bf16 v[212:215], v[242:245], v[72:75], v[212:215]
v_mfma_f32_16x16x32_bf16 v[216:219], v[242:245], v[76:79], v[216:219]
s_waitcnt lgkmcnt(1)
v_mfma_f32_16x16x32_bf16 v[200:203], v[220:223], v[80:83], v[200:203]
v_mfma_f32_16x16x32_bf16 v[204:207], v[220:223], v[84:87], v[204:207]
v_mfma_f32_16x16x32_bf16 v[208:211], v[220:223], v[88:91], v[208:211]
v_mfma_f32_16x16x32_bf16 v[212:215], v[220:223], v[92:95], v[212:215]
v_mfma_f32_16x16x32_bf16 v[216:219], v[220:223], v[96:99], v[216:219]
s_waitcnt lgkmcnt(0)
v_mfma_f32_16x16x32_bf16 v[200:203], v[224:227], v[100:103], v[200:203]
v_mfma_f32_16x16x32_bf16 v[204:207], v[224:227], v[104:107], v[204:207]
v_mfma_f32_16x16x32_bf16 v[208:211], v[224:227], v[108:111], v[208:211]
v_mfma_f32_16x16x32_bf16 v[212:215], v[224:227], v[112:115], v[212:215]
v_mfma_f32_16x16x32_bf16 v[216:219], v[224:227], v[116:119], v[216:219]
s_nop 4
v_max3_f32 v232, v232, v200, v201
v_cvt_pk_bf16_f32 v182, v200, v201
v_max3_f32 v232, v232, v202, v203
v_cvt_pk_bf16_f32 v183, v202, v203
v_max3_f32 v233, v233, v204, v205
v_cvt_pk_bf16_f32 v186, v204, v205
v_max3_f32 v233, v233, v206, v207
v_cvt_pk_bf16_f32 v187, v206, v207
v_max3_f32 v234, v234, v208, v209
v_cvt_pk_bf16_f32 v190, v208, v209
v_max3_f32 v234, v234, v210, v211
v_cvt_pk_bf16_f32 v191, v210, v211
v_max3_f32 v235, v235, v212, v213
v_cvt_pk_bf16_f32 v194, v212, v213
v_max3_f32 v235, v235, v214, v215
v_cvt_pk_bf16_f32 v195, v214, v215
v_max3_f32 v236, v236, v216, v217
v_cvt_pk_bf16_f32 v198, v216, v217
v_max3_f32 v236, v236, v218, v219
v_cvt_pk_bf16_f32 v199, v218, v219
v_mov_b32 v200, v232
v_mov_b32 v201, v233
v_mov_b32 v202, v234
v_mov_b32 v203, v235
v_mov_b32 v204, v236
s_nop 1
v_permlane32_swap_b32 v232, v200
v_permlane32_swap_b32 v233, v201
v_permlane32_swap_b32 v234, v202
v_permlane32_swap_b32 v235, v203
v_permlane32_swap_b32 v236, v204
s_nop 1
v_max_f32 v232, v232, v200
v_max_f32 v233, v233, v201
v_max_f32 v234, v234, v202
v_max_f32 v235, v235, v203
v_max_f32 v236, v236, v204
v_mov_b32 v200, v232
v_mov_b32 v201, v233
v_mov_b32 v202, v234
v_mov_b32 v203, v235
v_mov_b32 v204, v236
s_nop 1
v_permlane16_swap_b32 v232, v200
v_permlane16_swap_b32 v233, v201
v_permlane16_swap_b32 v234, v202
v_permlane16_swap_b32 v235, v203
v_permlane16_swap_b32 v236, v204
s_nop 1
v_max_f32 v232, v232, v200
v_max_f32 v233, v233, v201
v_max_f32 v234, v234, v202
v_max_f32 v235, v235, v203
v_max_f32 v236, v236, v204
ds_write_b32 v250, v232 offset:0
ds_write_b32 v250, v233 offset:256
ds_write_b32 v250, v234 offset:512
ds_write_b32 v250, v235 offset:768
ds_write_b32 v250, v236 offset:1024
s_waitcnt lgkmcnt(0)
s_barrier
v_and_b32 v242, -16, v250
ds_read_b128 v[200:203], v242 offset:0
ds_read_b128 v[204:207], v242 offset:256
ds_read_b128 v[208:211], v242 offset:512
ds_read_b128 v[212:215], v242 offset:768
ds_read_b128 v[216:219], v242 offset:1024
s_waitcnt lgkmcnt(4)
v_max3_f32 v200, v200, v201, v202
v_max_f32 v200, v200, v203
v_cvt_pk_bf16_f32 v200, v200, v200
v_and_b32 v200, s36, v200
v_mul_f32 v232, s35, -v200
v_mov_b32 v237, 0
s_waitcnt lgkmcnt(3)
v_max3_f32 v204, v204, v205, v206
v_max_f32 v204, v204, v207
v_cvt_pk_bf16_f32 v204, v204, v204
v_and_b32 v204, s36, v204
v_mul_f32 v233, s35, -v204
v_mov_b32 v238, 0
s_waitcnt lgkmcnt(2)
v_max3_f32 v208, v208, v209, v210
v_max_f32 v208, v208, v211
v_cvt_pk_bf16_f32 v208, v208, v208
v_and_b32 v208, s36, v208
v_mul_f32 v234, s35, -v208
v_mov_b32 v239, 0
s_waitcnt lgkmcnt(1)
v_max3_f32 v212, v212, v213, v214
v_max_f32 v212, v212, v215
v_cvt_pk_bf16_f32 v212, v212, v212
v_and_b32 v212, s36, v212
v_mul_f32 v235, s35, -v212
v_mov_b32 v240, 0
s_waitcnt lgkmcnt(0)
v_max3_f32 v216, v216, v217, v218
v_max_f32 v216, v216, v219
v_cvt_pk_bf16_f32 v216, v216, v216
v_and_b32 v216, s36, v216
v_mul_f32 v236, s35, -v216
v_mov_b32 v241, 0
v_lshlrev_b32 v242, 16, v120
v_and_b32 v243, s36, v120
v_fma_f32 v242, v242, s35, v232
v_fma_f32 v243, v243, s35, v232
v_exp_f32 v242, v242
v_exp_f32 v243, v243
v_add_f32 v237, v237, v242
v_cvt_pk_bf16_f32 v120, v242, v243
v_add_f32 v237, v237, v243
v_lshlrev_b32 v244, 16, v121
v_and_b32 v245, s36, v121
v_fma_f32 v244, v244, s35, v232
v_fma_f32 v245, v245, s35, v232
v_exp_f32 v244, v244
v_exp_f32 v245, v245
v_add_f32 v237, v237, v244
v_cvt_pk_bf16_f32 v121, v244, v245
v_add_f32 v237, v237, v245
v_lshlrev_b32 v242, 16, v122
v_and_b32 v243, s36, v122
v_fma_f32 v242, v242, s35, v232
v_fma_f32 v243, v243, s35, v232
v_exp_f32 v242, v242
v_exp_f32 v243, v243
v_add_f32 v237, v237, v242
v_cvt_pk_bf16_f32 v122, v242, v243
v_add_f32 v237, v237, v243
v_lshlrev_b32 v244, 16, v123
v_and_b32 v245, s36, v123
v_fma_f32 v244, v244, s35, v232
v_fma_f32 v245, v245, s35, v232
v_exp_f32 v244, v244
v_exp_f32 v245, v245
v_add_f32 v237, v237, v244
v_cvt_pk_bf16_f32 v123, v244, v245
v_add_f32 v237, v237, v245
ds_write_b128 v255, v[120:123] offset:0
v_lshlrev_b32 v242, 16, v124
v_and_b32 v243, s36, v124
v_fma_f32 v242, v242, s35, v233
v_fma_f32 v243, v243, s35, v233
v_exp_f32 v242, v242
v_exp_f32 v243, v243
v_add_f32 v238, v238, v242
v_cvt_pk_bf16_f32 v124, v242, v243
v_add_f32 v238, v238, v243
v_lshlrev_b32 v244, 16, v125
v_and_b32 v245, s36, v125
v_fma_f32 v244, v244, s35, v233
v_fma_f32 v245, v245, s35, v233
v_exp_f32 v244, v244
v_exp_f32 v245, v245
v_add_f32 v238, v238, v244
v_cvt_pk_bf16_f32 v125, v244, v245
v_add_f32 v238, v238, v245
v_lshlrev_b32 v242, 16, v126
v_and_b32 v243, s36, v126
v_fma_f32 v242, v242, s35, v233
v_fma_f32 v243, v243, s35, v233
v_exp_f32 v242, v242
v_exp_f32 v243, v243
v_add_f32 v238, v238, v242
v_cvt_pk_bf16_f32 v126, v242, v243
v_add_f32 v238, v238, v243
v_lshlrev_b32 v244, 16, v127
v_and_b32 v245, s36, v127
v_fma_f32 v244, v244, s35, v233
v_fma_f32 v245, v245, s35, v233
v_exp_f32 v244, v244
v_exp_f32 v245, v245
v_add_f32 v238, v238, v244
v_cvt_pk_bf16_f32 v127, v244, v245
v_add_f32 v238, v238, v245
ds_write_b128 v255, v[124:127] offset:1024
v_lshlrev_b32 v242, 16, v128
v_and_b32 v243, s36, v128
v_fma_f32 v242, v242, s35, v234
v_fma_f32 v243, v243, s35, v234
v_exp_f32 v242, v242
v_exp_f32 v243, v243
v_add_f32 v239, v239, v242
v_cvt_pk_bf16_f32 v128, v242, v243
v_add_f32 v239, v239, v243
s_waitcnt lgkmcnt(0)
s_barrier
v_lshlrev_b32 v242, 16, v129
v_and_b32 v243, s36, v129
v_fma_f32 v242, v242, s35, v234
v_fma_f32 v243, v243, s35, v234
v_exp_f32 v242, v242
v_exp_f32 v243, v243
v_add_f32 v239, v239, v242
v_cvt_pk_bf16_f32 v129, v242, v243
v_add_f32 v239, v239, v243
v_lshlrev_b32 v244, 16, v130
v_and_b32 v245, s36, v130
v_fma_f32 v244, v244, s35, v234
v_fma_f32 v245, v245, s35, v234
v_exp_f32 v244, v244
v_exp_f32 v245, v245
v_add_f32 v239, v239, v244
v_cvt_pk_bf16_f32 v130, v244, v245
v_add_f32 v239, v239, v245
v_lshlrev_b32 v242, 16, v131
v_and_b32 v243, s36, v131
v_fma_f32 v242, v242, s35, v234
v_fma_f32 v243, v243, s35, v234
v_exp_f32 v242, v242
v_exp_f32 v243, v243
v_add_f32 v239, v239, v242
v_cvt_pk_bf16_f32 v131, v242, v243
v_add_f32 v239, v239, v243
ds_write_b128 v255, v[128:131] offset:2048
v_lshlrev_b32 v244, 16, v132
v_and_b32 v245, s36, v132
v_fma_f32 v244, v244, s35, v235
v_fma_f32 v245, v245, s35, v235
v_exp_f32 v244, v244
v_exp_f32 v245, v245
v_add_f32 v240, v240, v244
v_cvt_pk_bf16_f32 v132, v244, v245
v_add_f32 v240, v240, v245
v_lshlrev_b32 v242, 16, v133
v_and_b32 v243, s36, v133
v_fma_f32 v242, v242, s35, v235
v_fma_f32 v243, v243, s35, v235
v_exp_f32 v242, v242
v_exp_f32 v243, v243
v_add_f32 v240, v240, v242
v_cvt_pk_bf16_f32 v133, v242, v243
v_add_f32 v240, v240, v243
v_lshlrev_b32 v244, 16, v134
v_and_b32 v245, s36, v134
v_fma_f32 v244, v244, s35, v235
v_fma_f32 v245, v245, s35, v235
v_exp_f32 v244, v244
v_exp_f32 v245, v245
v_add_f32 v240, v240, v244
v_cvt_pk_bf16_f32 v134, v244, v245
v_add_f32 v240, v240, v245
v_lshlrev_b32 v242, 16, v135
v_and_b32 v243, s36, v135
v_fma_f32 v242, v242, s35, v235
v_fma_f32 v243, v243, s35, v235
v_exp_f32 v242, v242
v_exp_f32 v243, v243
v_add_f32 v240, v240, v242
v_cvt_pk_bf16_f32 v135, v242, v243
v_add_f32 v240, v240, v243
ds_write_b128 v255, v[132:135] offset:3072
v_lshlrev_b32 v244, 16, v136
v_and_b32 v245, s36, v136
v_fma_f32 v244, v244, s35, v236
v_fma_f32 v245, v245, s35, v236
v_exp_f32 v244, v244
v_exp_f32 v245, v245
v_add_f32 v241, v241, v244
v_cvt_pk_bf16_f32 v136, v244, v245
v_add_f32 v241, v241, v245
v_lshlrev_b32 v242, 16, v137
v_and_b32 v243, s36, v137
v_fma_f32 v242, v242, s35, v236
v_fma_f32 v243, v243, s35, v236
v_exp_f32 v242, v242
v_exp_f32 v243, v243
v_add_f32 v241, v241, v242
v_cvt_pk_bf16_f32 v137, v242, v243
v_add_f32 v241, v241, v243
v_lshlrev_b32 v244, 16, v138
v_and_b32 v245, s36, v138
v_fma_f32 v244, v244, s35, v236
v_fma_f32 v245, v245, s35, v236
v_exp_f32 v244, v244
v_exp_f32 v245, v245
v_add_f32 v241, v241, v244
v_cvt_pk_bf16_f32 v138, v244, v245
v_add_f32 v241, v241, v245
v_lshlrev_b32 v242, 16, v139
v_and_b32 v243, s36, v139
v_fma_f32 v242, v242, s35, v236
v_fma_f32 v243, v243, s35, v236
v_exp_f32 v242, v242
v_exp_f32 v243, v243
v_add_f32 v241, v241, v242
v_cvt_pk_bf16_f32 v139, v242, v243
v_add_f32 v241, v241, v243
ds_write_b128 v255, v[136:139] offset:4096
s_waitcnt lgkmcnt(0)
s_add_u32 s28, s28, 196608
s_add_u32 s29, s29, 384
s_add_u32 s30, s30, 245760
s_add_u32 s38, s38, 245760
s_mov_b32 s33, 3
L_att_loop:
s_barrier
ds_read_b64_tr_b16 v[220:221], v246 offset:0
ds_read_b64_tr_b16 v[222:223], v246 offset:2048
ds_read_b128 v[200:203], v248 offset:30720
ds_read_b64_tr_b16 v[224:225], v246 offset:4096
ds_read_b64_tr_b16 v[226:227], v246 offset:6144
ds_read_b64_tr_b16 v[228:229], v246 offset:8192
ds_read_b64_tr_b16 v[230:231], v246 offset:10240
ds_read_b128 v[204:207], v248 offset:31744
ds_read_b128 v[208:211], v248 offset:32768
ds_read_b128 v[212:215], v248 offset:33792
ds_read_b128 v[216:219], v248 offset:34816
s_waitcnt lgkmcnt(8)
v_mfma_f32_16x16x32_bf16 v[0:3], v[220:223], v[200:203], 0
v_lshlrev_b32 v242, 16, v140
ds_read_b64_tr_b16 v[120:121], v246 offset:12288
ds_read_b64_tr_b16 v[122:123], v246 offset:14336
s_waitcnt lgkmcnt(8)
v_mfma_f32_16x16x32_bf16 v[20:23], v[224:227], v[200:203], 0
v_and_b32 v243, s36, v140
ds_read_b128 v[132:135], v248 offset:35840
s_waitcnt lgkmcnt(7)
v_mfma_f32_16x16x32_bf16 v[40:43], v[228:231], v[200:203], 0
v_fma_f32 v242, v242, s35, v232
s_waitcnt lgkmcnt(6)
v_mfma_f32_16x16x32_bf16 v[4:7], v[220:223], v[204:207], 0
v_fma_f32 v243, v243, s35, v232
ds_read_b64_tr_b16 v[124:125], v246 offset:16384
ds_read_b64_tr_b16 v[126:127], v246 offset:18432
v_mfma_f32_16x16x32_bf16 v[24:27], v[224:227], v[204:207], 0
v_exp_f32 v242, v242
ds_read_b128 v[136:139], v248 offset:36864
v_mfma_f32_16x16x32_bf16 v[44:47], v[228:231], v[204:207], 0
v_exp_f32 v243, v243
s_waitcnt lgkmcnt(8)
v_mfma_f32_16x16x32_bf16 v[8:11], v[220:223], v[208:211], 0
v_add_f32 v237, v237, v242
ds_read_b64_tr_b16 v[128:129], v246 offset:20480
ds_read_b64_tr_b16 v[130:131], v246 offset:22528
v_mfma_f32_16x16x32_bf16 v[28:31], v[224:227], v[208:211], 0
v_cvt_pk_bf16_f32 v140, v242, v243
ds_read_b128 v[200:203], v248 offset:37888
v_mfma_f32_16x16x32_bf16 v[48:51], v[228:231], v[208:211], 0
v_add_f32 v237, v237, v243
s_waitcnt lgkmcnt(10)
v_mfma_f32_16x16x32_bf16 v[12:15], v[220:223], v[212:215], 0
v_mfma_f32_16x16x32_bf16 v[32:35], v[224:227], v[212:215], 0
v_lshlrev_b32 v244, 16, v141
ds_read_b128 v[204:207], v248 offset:38912
v_mfma_f32_16x16x32_bf16 v[52:55], v[228:231], v[212:215], 0
v_and_b32 v245, s36, v141
s_waitcnt lgkmcnt(10)
v_mfma_f32_16x16x32_bf16 v[16:19], v[220:223], v[216:219], 0
v_fma_f32 v244, v244, s35, v232
v_mfma_f32_16x16x32_bf16 v[36:39], v[224:227], v[216:219], 0
v_fma_f32 v245, v245, s35, v232
ds_read_b128 v[208:211], v248 offset:39936
v_mfma_f32_16x16x32_bf16 v[56:59], v[228:231], v[216:219], 0
v_exp_f32 v244, v244
s_waitcnt lgkmcnt(2)
v_mfma_f32_16x16x32_bf16 v[0:3], v[120:123], v[132:135], v[0:3]
v_exp_f32 v245, v245
v_mfma_f32_16x16x32_bf16 v[20:23], v[124:127], v[132:135], v[20:23]
v_add_f32 v237, v237, v244
ds_read_b128 v[212:215], v248 offset:40960
v_mfma_f32_16x16x32_bf16 v[40:43], v[128:131], v[132:135], v[40:43]
v_cvt_pk_bf16_f32 v141, v244, v245
v_mfma_f32_16x16x32_bf16 v[4:7], v[120:123], v[136:139], v[4:7]
v_add_f32 v237, v237, v245
v_mfma_f32_16x16x32_bf16 v[24:27], v[124:127], v[136:139], v[24:27]
ds_read_b128 v[216:219], v248 offset:41984
v_mfma_f32_16x16x32_bf16 v[44:47], v[128:131], v[136:139], v[44:47]
v_lshlrev_b32 v242, 16, v142
v_mfma_f32_16x16x32_bf16 v[8:11], v[120:123], v[200:203], v[8:11]
v_and_b32 v243, s36, v142
v_mfma_f32_16x16x32_bf16 v[28:31], v[124:127], v[200:203], v[28:31]
v_fma_f32 v242, v242, s35, v232
ds_read_b128 v[132:135], v248 offset:43008
v_mfma_f32_16x16x32_bf16 v[48:51], v[128:131], v[200:203], v[48:51]
v_fma_f32 v243, v243, s35, v232
s_waitcnt lgkmcnt(3)
v_mfma_f32_16x16x32_bf16 v[12:15], v[120:123], v[204:207], v[12:15]
v_exp_f32 v242, v242
v_mfma_f32_16x16x32_bf16 v[32:35], v[124:127], v[204:207], v[32:35]
v_exp_f32 v243, v243
ds_read_b128 v[136:139], v248 offset:44032
v_mfma_f32_16x16x32_bf16 v[52:55], v[128:131], v[204:207], v[52:55]
v_add_f32 v237, v237, v242
v_mfma_f32_16x16x32_bf16 v[16:19], v[120:123], v[208:211], v[16:19]
v_cvt_pk_bf16_f32 v142, v242, v243
v_mfma_f32_16x16x32_bf16 v[36:39], v[124:127], v[208:211], v[36:39]
v_add_f32 v237, v237, v243
ds_read_b128 v[200:203], v248 offset:45056
v_mfma_f32_16x16x32_bf16 v[56:59], v[128:131], v[208:211], v[56:59]
s_barrier
ds_read_b64_tr_b16 v[220:221], v246 offset:24576
ds_read_b64_tr_b16 v[222:223], v246 offset:26624
ds_read_b64_tr_b16 v[224:225], v246 offset:28672
ds_read_b64_tr_b16 v[226:227], v246 offset:30720
ds_read_b64_tr_b16 v[228:229], v246 offset:32768
ds_read_b64_tr_b16 v[230:231], v246 offset:34816
s_waitcnt lgkmcnt(4)
v_mfma_f32_16x16x32_bf16 v[0:3], v[220:223], v[212:215], v[0:3]
ds_read_b64_tr_b16 v[120:121], v246 offset:36864
ds_read_b64_tr_b16 v[122:123], v246 offset:38912
s_waitcnt lgkmcnt(4)
v_mfma_f32_16x16x32_bf16 v[20:23], v[224:227], v[212:215], v[20:23]
ds_read_b128 v[204:207], v248 offset:46080
s_waitcnt lgkmcnt(3)
v_mfma_f32_16x16x32_bf16 v[40:43], v[228:231], v[212:215], v[40:43]
v_mfma_f32_16x16x32_bf16 v[4:7], v[220:223], v[216:219], v[4:7]
ds_read_b64_tr_b16 v[124:125], v246 offset:40960
ds_read_b64_tr_b16 v[126:127], v246 offset:43008
v_mfma_f32_16x16x32_bf16 v[24:27], v[224:227], v[216:219], v[24:27]
ds_read_b128 v[208:211], v248 offset:47104
v_mfma_f32_16x16x32_bf16 v[44:47], v[228:231], v[216:219], v[44:47]
v_mfma_f32_16x16x32_bf16 v[8:11], v[220:223], v[132:135], v[8:11]
ds_read_b64_tr_b16 v[128:129], v246 offset:45056
ds_read_b64_tr_b16 v[130:131], v246 offset:47104
v_mfma_f32_16x16x32_bf16 v[28:31], v[224:227], v[132:135], v[28:31]
ds_read_b128 v[212:215], v248 offset:48128
v_mfma_f32_16x16x32_bf16 v[48:51], v[228:231], v[132:135], v[48:51]
v_mfma_f32_16x16x32_bf16 v[12:15], v[220:223], v[136:139], v[12:15]
v_mfma_f32_16x16x32_bf16 v[32:35], v[224:227], v[136:139], v[32:35]
ds_read_b128 v[216:219], v248 offset:49152
v_mfma_f32_16x16x32_bf16 v[52:55], v[228:231], v[136:139], v[52:55]
v_mfma_f32_16x16x32_bf16 v[16:19], v[220:223], v[200:203], v[16:19]
v_mfma_f32_16x16x32_bf16 v[36:39], v[224:227], v[200:203], v[36:39]
ds_read_b128 v[132:135], v248 offset:50176
v_mfma_f32_16x16x32_bf16 v[56:59], v[228:231], v[200:203], v[56:59]
s_waitcnt lgkmcnt(0)
s_barrier
v_mfma_f32_16x16x32_bf16 v[0:3], v[120:123], v[204:207], v[0:3]
v_lshlrev_b32 v242, 16, v143
v_and_b32 v243, s36, v143
ds_read_b64_tr_b16 v[220:221], v253 offset:0
ds_read_b64_tr_b16 v[222:223], v253 offset:2048
v_mfma_f32_16x16x32_bf16 v[20:23], v[124:127], v[204:207], v[20:23]
v_fma_f32 v242, v242, s35, v232
ds_read_b128 v[136:139], v251 offset:0
v_mfma_f32_16x16x32_bf16 v[40:43], v[128:131], v[204:207], v[40:43]
v_fma_f32 v243, v243, s35, v232
v_mfma_f32_16x16x32_bf16 v[4:7], v[120:123], v[208:211], v[4:7]
v_exp_f32 v242, v242
ds_read_b64_tr_b16 v[224:225], v253 offset:4096
ds_read_b64_tr_b16 v[226:227], v253 offset:6144
v_mfma_f32_16x16x32_bf16 v[24:27], v[124:127], v[208:211], v[24:27]
v_exp_f32 v243, v243
ds_read_b128 v[200:203], v251 offset:2048
v_mfma_f32_16x16x32_bf16 v[44:47], v[128:131], v[208:211], v[44:47]
v_add_f32 v237, v237, v242
v_cvt_pk_bf16_f32 v143, v242, v243
v_mfma_f32_16x16x32_bf16 v[8:11], v[120:123], v[212:215], v[8:11]
v_add_f32 v237, v237, v243
ds_read_b64_tr_b16 v[228:229], v253 offset:8192
ds_read_b64_tr_b16 v[230:231], v253 offset:10240
v_mfma_f32_16x16x32_bf16 v[28:31], v[124:127], v[212:215], v[28:31]
v_lshlrev_b32 v244, 16, v144
ds_read_b128 v[204:207], v251 offset:4096
v_mfma_f32_16x16x32_bf16 v[48:51], v[128:131], v[212:215], v[48:51]
v_and_b32 v245, s36, v144
v_mfma_f32_16x16x32_bf16 v[12:15], v[120:123], v[216:219], v[12:15]
v_fma_f32 v244, v244, s35, v233
v_mfma_f32_16x16x32_bf16 v[32:35], v[124:127], v[216:219], v[32:35]
v_fma_f32 v245, v245, s35, v233
v_exp_f32 v244, v244
ds_read_b128 v[208:211], v251 offset:6144
v_mfma_f32_16x16x32_bf16 v[52:55], v[128:131], v[216:219], v[52:55]
v_exp_f32 v245, v245
v_mfma_f32_16x16x32_bf16 v[16:19], v[120:123], v[132:135], v[16:19]
v_add_f32 v238, v238, v244
v_mfma_f32_16x16x32_bf16 v[36:39], v[124:127], v[132:135], v[36:39]
v_cvt_pk_bf16_f32 v144, v244, v245
ds_read_b128 v[212:215], v251 offset:8192
v_mfma_f32_16x16x32_bf16 v[56:59], v[128:131], v[132:135], v[56:59]
v_add_f32 v238, v238, v245
s_waitcnt lgkmcnt(2)
v_mfma_f32_16x16x32_bf16 v[60:63], v[220:223], v[136:139], 0
ds_write_b128 v255, v[140:143] offset:0
v_lshlrev_b32 v242, 16, v145
ds_read_b64_tr_b16 v[120:121], v253 offset:12288
ds_read_b64_tr_b16 v[122:123], v253 offset:14336
v_mfma_f32_16x16x32_bf16 v[80:83], v[224:227], v[136:139], 0
v_and_b32 v243, s36, v145
v_fma_f32 v242, v242, s35, v233
ds_read_b128 v[216:219], v252 offset:0
v_mfma_f32_16x16x32_bf16 v[100:103], v[228:231], v[136:139], 0
v_fma_f32 v243, v243, s35, v233
v_exp_f32 v242, v242
v_mfma_f32_16x16x32_bf16 v[64:67], v[220:223], v[200:203], 0
v_exp_f32 v243, v243
v_add_f32 v238, v238, v242
ds_read_b64_tr_b16 v[124:125], v253 offset:16384
ds_read_b64_tr_b16 v[126:127], v253 offset:18432
v_mfma_f32_16x16x32_bf16 v[84:87], v[224:227], v[200:203], 0
v_cvt_pk_bf16_f32 v145, v242, v243
v_add_f32 v238, v238, v243
ds_read_b128 v[132:135], v252 offset:2048
v_mfma_f32_16x16x32_bf16 v[104:107], v[228:231], v[200:203], 0
v_lshlrev_b32 v244, 16, v146
v_and_b32 v245, s36, v146
v_mfma_f32_16x16x32_bf16 v[68:71], v[220:223], v[204:207], 0
v_fma_f32 v244, v244, s35, v233
v_fma_f32 v245, v245, s35, v233
ds_read_b64_tr_b16 v[128:129], v253 offset:20480
ds_read_b64_tr_b16 v[130:131], v253 offset:22528
v_mfma_f32_16x16x32_bf16 v[88:91], v[224:227], v[204:207], 0
v_exp_f32 v244, v244
ds_read_b128 v[136:139], v252 offset:4096
v_mfma_f32_16x16x32_bf16 v[108:111], v[228:231], v[204:207], 0
v_exp_f32 v245, v245
v_add_f32 v238, v238, v244
s_waitcnt lgkmcnt(10)
v_mfma_f32_16x16x32_bf16 v[72:75], v[220:223], v[208:211], 0
v_cvt_pk_bf16_f32 v146, v244, v245
v_add_f32 v238, v238, v245
v_mfma_f32_16x16x32_bf16 v[92:95], v[224:227], v[208:211], 0
v_lshlrev_b32 v242, 16, v147
v_and_b32 v243, s36, v147
ds_read_b128 v[200:203], v252 offset:6144
v_mfma_f32_16x16x32_bf16 v[112:115], v[228:231], v[208:211], 0
v_fma_f32 v242, v242, s35, v233
v_fma_f32 v243, v243, s35, v233
v_mfma_f32_16x16x32_bf16 v[76:79], v[220:223], v[212:215], 0
v_exp_f32 v242, v242
v_exp_f32 v243, v243
v_mfma_f32_16x16x32_bf16 v[96:99], v[224:227], v[212:215], 0
v_add_f32 v238, v238, v242
v_cvt_pk_bf16_f32 v147, v242, v243
ds_read_b128 v[204:207], v252 offset:8192
v_mfma_f32_16x16x32_bf16 v[116:119], v[228:231], v[212:215], 0
v_add_f32 v238, v238, v243
s_waitcnt lgkmcnt(2)
v_mfma_f32_16x16x32_bf16 v[60:63], v[120:123], v[216:219], v[60:63]
ds_write_b128 v255, v[144:147] offset:1024
v_lshlrev_b32 v244, 16, v148
ds_read_b64_tr_b16 v[220:221], v253 offset:24576
ds_read_b64_tr_b16 v[222:223], v253 offset:26624
v_mfma_f32_16x16x32_bf16 v[80:83], v[124:127], v[216:219], v[80:83]
v_and_b32 v245, s36, v148
v_fma_f32 v244, v244, s35, v234
ds_read_b128 v[208:211], v251 offset:10240
v_mfma_f32_16x16x32_bf16 v[100:103], v[128:131], v[216:219], v[100:103]
v_fma_f32 v245, v245, s35, v234
v_exp_f32 v244, v244
v_mfma_f32_16x16x32_bf16 v[64:67], v[120:123], v[132:135], v[64:67]
v_exp_f32 v245, v245
v_add_f32 v239, v239, v244
ds_read_b64_tr_b16 v[224:225], v253 offset:28672
ds_read_b64_tr_b16 v[226:227], v253 offset:30720
v_mfma_f32_16x16x32_bf16 v[84:87], v[124:127], v[132:135], v[84:87]
v_cvt_pk_bf16_f32 v148, v244, v245
v_add_f32 v239, v239, v245
ds_read_b128 v[212:215], v251 offset:12288
v_mfma_f32_16x16x32_bf16 v[104:107], v[128:131], v[132:135], v[104:107]
v_lshlrev_b32 v242, 16, v149
v_and_b32 v243, s36, v149
v_mfma_f32_16x16x32_bf16 v[68:71], v[120:123], v[136:139], v[68:71]
v_fma_f32 v242, v242, s35, v234
v_fma_f32 v243, v243, s35, v234
ds_read_b64_tr_b16 v[228:229], v253 offset:32768
ds_read_b64_tr_b16 v[230:231], v253 offset:34816
v_mfma_f32_16x16x32_bf16 v[88:91], v[124:127], v[136:139], v[88:91]
v_exp_f32 v242, v242
ds_read_b128 v[216:219], v251 offset:14336
v_mfma_f32_16x16x32_bf16 v[108:111], v[128:131], v[136:139], v[108:111]
v_exp_f32 v243, v243
v_add_f32 v239, v239, v242
s_waitcnt lgkmcnt(10)
v_mfma_f32_16x16x32_bf16 v[72:75], v[120:123], v[200:203], v[72:75]
v_cvt_pk_bf16_f32 v149, v242, v243
v_add_f32 v239, v239, v243
v_mfma_f32_16x16x32_bf16 v[92:95], v[124:127], v[200:203], v[92:95]
v_lshlrev_b32 v244, 16, v150
v_and_b32 v245, s36, v150
ds_read_b128 v[132:135], v251 offset:16384
v_mfma_f32_16x16x32_bf16 v[112:115], v[128:131], v[200:203], v[112:115]
v_fma_f32 v244, v244, s35, v234
v_fma_f32 v245, v245, s35, v234
v_mfma_f32_16x16x32_bf16 v[76:79], v[120:123], v[204:207], v[76:79]
v_exp_f32 v244, v244
v_exp_f32 v245, v245
v_mfma_f32_16x16x32_bf16 v[96:99], v[124:127], v[204:207], v[96:99]
v_add_f32 v239, v239, v244
v_cvt_pk_bf16_f32 v150, v244, v245
ds_read_b128 v[136:139], v251 offset:18432
v_mfma_f32_16x16x32_bf16 v[116:119], v[128:131], v[204:207], v[116:119]
v_add_f32 v239, v239, v245
s_waitcnt lgkmcnt(2)
v_mfma_f32_16x16x32_bf16 v[60:63], v[220:223], v[208:211], v[60:63]
v_lshlrev_b32 v242, 16, v151
v_and_b32 v243, s36, v151
ds_read_b64_tr_b16 v[120:121], v253 offset:36864
ds_read_b64_tr_b16 v[122:123], v253 offset:38912
v_mfma_f32_16x16x32_bf16 v[80:83], v[224:227], v[208:211], v[80:83]
v_fma_f32 v242, v242, s35, v234
v_fma_f32 v243, v243, s35, v234
ds_read_b128 v[200:203], v252 offset:10240
v_mfma_f32_16x16x32_bf16 v[100:103], v[228:231], v[208:211], v[100:103]
v_exp_f32 v242, v242
v_exp_f32 v243, v243
v_mfma_f32_16x16x32_bf16 v[64:67], v[220:223], v[212:215], v[64:67]
v_add_f32 v239, v239, v242
v_cvt_pk_bf16_f32 v151, v242, v243
ds_read_b64_tr_b16 v[124:125], v253 offset:40960
ds_read_b64_tr_b16 v[126:127], v253 offset:43008
v_mfma_f32_16x16x32_bf16 v[84:87], v[224:227], v[212:215], v[84:87]
v_add_f32 v239, v239, v243
ds_write_b128 v255, v[148:151] offset:2048
ds_read_b128 v[204:207], v252 offset:12288
v_mfma_f32_16x16x32_bf16 v[104:107], v[228:231], v[212:215], v[104:107]
v_lshlrev_b32 v244, 16, v152
v_and_b32 v245, s36, v152
v_mfma_f32_16x16x32_bf16 v[68:71], v[220:223], v[216:219], v[68:71]
v_fma_f32 v244, v244, s35, v235
v_fma_f32 v245, v245, s35, v235
ds_read_b64_tr_b16 v[128:129], v253 offset:45056
ds_read_b64_tr_b16 v[130:131], v253 offset:47104
v_mfma_f32_16x16x32_bf16 v[88:91], v[224:227], v[216:219], v[88:91]
v_exp_f32 v244, v244
ds_read_b128 v[208:211], v252 offset:14336
v_mfma_f32_16x16x32_bf16 v[108:111], v[228:231], v[216:219], v[108:111]
v_exp_f32 v245, v245
v_add_f32 v240, v240, v244
s_waitcnt lgkmcnt(10)
v_mfma_f32_16x16x32_bf16 v[72:75], v[220:223], v[132:135], v[72:75]
v_cvt_pk_bf16_f32 v152, v244, v245
v_add_f32 v240, v240, v245
v_mfma_f32_16x16x32_bf16 v[92:95], v[224:227], v[132:135], v[92:95]
v_lshlrev_b32 v242, 16, v153
v_and_b32 v243, s36, v153
ds_read_b128 v[212:215], v252 offset:16384
v_mfma_f32_16x16x32_bf16 v[112:115], v[228:231], v[132:135], v[112:115]
v_fma_f32 v242, v242, s35, v235
v_fma_f32 v243, v243, s35, v235
v_mfma_f32_16x16x32_bf16 v[76:79], v[220:223], v[136:139], v[76:79]
v_exp_f32 v242, v242
v_exp_f32 v243, v243
v_mfma_f32_16x16x32_bf16 v[96:99], v[224:227], v[136:139], v[96:99]
v_add_f32 v240, v240, v242
v_cvt_pk_bf16_f32 v153, v242, v243
ds_read_b128 v[216:219], v252 offset:18432
v_mfma_f32_16x16x32_bf16 v[116:119], v[228:231], v[136:139], v[116:119]
v_add_f32 v240, v240, v243
s_waitcnt lgkmcnt(0)
s_barrier
v_mfma_f32_16x16x32_bf16 v[60:63], v[120:123], v[200:203], v[60:63]
v_lshlrev_b32 v242, 16, v154
v_and_b32 v243, s36, v154
ds_read_b64_tr_b16 v[220:221], v253 offset:49152
ds_read_b64_tr_b16 v[222:223], v253 offset:51200
v_mfma_f32_16x16x32_bf16 v[80:83], v[124:127], v[200:203], v[80:83]
v_fma_f32 v242, v242, s35, v235
v_fma_f32 v243, v243, s35, v235
ds_read_b128 v[132:135], v251 offset:40960
v_mfma_f32_16x16x32_bf16 v[100:103], v[128:131], v[200:203], v[100:103]
v_exp_f32 v242, v242
v_exp_f32 v243, v243
v_mfma_f32_16x16x32_bf16 v[64:67], v[120:123], v[204:207], v[64:67]
v_add_f32 v240, v240, v242
v_cvt_pk_bf16_f32 v154, v242, v243
ds_read_b64_tr_b16 v[224:225], v253 offset:53248
ds_read_b64_tr_b16 v[226:227], v253 offset:55296
v_mfma_f32_16x16x32_bf16 v[84:87], v[124:127], v[204:207], v[84:87]
v_add_f32 v240, v240, v243
v_lshlrev_b32 v244, 16, v155
ds_read_b128 v[136:139], v251 offset:43008
v_mfma_f32_16x16x32_bf16 v[104:107], v[128:131], v[204:207], v[104:107]
v_and_b32 v245, s36, v155
v_fma_f32 v244, v244, s35, v235
v_mfma_f32_16x16x32_bf16 v[68:71], v[120:123], v[208:211], v[68:71]
v_fma_f32 v245, v245, s35, v235
v_exp_f32 v244, v244
ds_read_b64_tr_b16 v[228:229], v253 offset:57344
ds_read_b64_tr_b16 v[230:231], v253 offset:59392
v_mfma_f32_16x16x32_bf16 v[88:91], v[124:127], v[208:211], v[88:91]
v_exp_f32 v245, v245
ds_read_b128 v[200:203], v251 offset:45056
v_mfma_f32_16x16x32_bf16 v[108:111], v[128:131], v[208:211], v[108:111]
v_add_f32 v240, v240, v244
v_cvt_pk_bf16_f32 v155, v244, v245
v_mfma_f32_16x16x32_bf16 v[72:75], v[120:123], v[212:215], v[72:75]
v_add_f32 v240, v240, v245
ds_write_b128 v255, v[152:155] offset:3072
v_mfma_f32_16x16x32_bf16 v[92:95], v[124:127], v[212:215], v[92:95]
v_lshlrev_b32 v242, 16, v156
v_and_b32 v243, s36, v156
ds_read_b128 v[204:207], v251 offset:47104
v_mfma_f32_16x16x32_bf16 v[112:115], v[128:131], v[212:215], v[112:115]
v_fma_f32 v242, v242, s35, v236
v_fma_f32 v243, v243, s35, v236
v_mfma_f32_16x16x32_bf16 v[76:79], v[120:123], v[216:219], v[76:79]
v_exp_f32 v242, v242
v_exp_f32 v243, v243
v_mfma_f32_16x16x32_bf16 v[96:99], v[124:127], v[216:219], v[96:99]
v_add_f32 v241, v241, v242
v_cvt_pk_bf16_f32 v156, v242, v243
ds_read_b128 v[208:211], v251 offset:49152
v_mfma_f32_16x16x32_bf16 v[116:119], v[128:131], v[216:219], v[116:119]
v_add_f32 v241, v241, v243
s_waitcnt lgkmcnt(3)
v_mfma_f32_16x16x32_bf16 v[60:63], v[220:223], v[132:135], v[60:63]
v_lshlrev_b32 v244, 16, v157
v_and_b32 v245, s36, v157
v_mfma_f32_16x16x32_bf16 v[80:83], v[224:227], v[132:135], v[80:83]
v_fma_f32 v244, v244, s35, v236
v_fma_f32 v245, v245, s35, v236
v_mfma_f32_16x16x32_bf16 v[100:103], v[228:231], v[132:135], v[100:103]
v_exp_f32 v244, v244
v_exp_f32 v245, v245
v_mfma_f32_16x16x32_bf16 v[64:67], v[220:223], v[136:139], v[64:67]
v_add_f32 v241, v241, v244
v_cvt_pk_bf16_f32 v157, v244, v245
v_mfma_f32_16x16x32_bf16 v[84:87], v[224:227], v[136:139], v[84:87]
v_add_f32 v241, v241, v245
v_lshlrev_b32 v242, 16, v158
v_mfma_f32_16x16x32_bf16 v[104:107], v[228:231], v[136:139], v[104:107]
v_and_b32 v243, s36, v158
v_fma_f32 v242, v242, s35, v236
v_mfma_f32_16x16x32_bf16 v[68:71], v[220:223], v[200:203], v[68:71]
v_fma_f32 v243, v243, s35, v236
v_exp_f32 v242, v242
v_mfma_f32_16x16x32_bf16 v[88:91], v[224:227], v[200:203], v[88:91]
v_exp_f32 v243, v243
v_mfma_f32_16x16x32_bf16 v[108:111], v[228:231], v[200:203], v[108:111]
v_add_f32 v241, v241, v242
v_cvt_pk_bf16_f32 v158, v242, v243
s_waitcnt lgkmcnt(0)
v_mfma_f32_16x16x32_bf16 v[72:75], v[220:223], v[204:207], v[72:75]
v_add_f32 v241, v241, v243
v_lshlrev_b32 v244, 16, v159
v_mfma_f32_16x16x32_bf16 v[92:95], v[224:227], v[204:207], v[92:95]
v_and_b32 v245, s36, v159
v_fma_f32 v244, v244, s35, v236
v_mfma_f32_16x16x32_bf16 v[112:115], v[228:231], v[204:207], v[112:115]
v_fma_f32 v245, v245, s35, v236
v_exp_f32 v244, v244
v_mfma_f32_16x16x32_bf16 v[76:79], v[220:223], v[208:211], v[76:79]
v_exp_f32 v245, v245
v_add_f32 v241, v241, v244
v_mfma_f32_16x16x32_bf16 v[96:99], v[224:227], v[208:211], v[96:99]
v_cvt_pk_bf16_f32 v159, v244, v245
v_add_f32 v241, v241, v245
v_mfma_f32_16x16x32_bf16 v[116:119], v[228:231], v[208:211], v[116:119]
ds_write_b128 v255, v[156:159] offset:4096
s_waitcnt lgkmcnt(0)
s_barrier
ds_read_b64_tr_b16 v[120:121], v246 offset:0
ds_read_b64_tr_b16 v[122:123], v246 offset:2048
ds_read_b128 v[212:215], v248 offset:30720
ds_read_b64_tr_b16 v[124:125], v246 offset:4096
ds_read_b64_tr_b16 v[126:127], v246 offset:6144
ds_read_b64_tr_b16 v[128:129], v246 offset:8192
ds_read_b64_tr_b16 v[130:131], v246 offset:10240
ds_read_b128 v[216:219], v248 offset:31744
ds_read_b128 v[132:135], v248 offset:32768
ds_read_b128 v[136:139], v248 offset:33792
ds_read_b128 v[200:203], v248 offset:34816
s_waitcnt lgkmcnt(8)
v_mfma_f32_16x16x32_bf16 v[0:3], v[120:123], v[212:215], v[0:3]
v_lshlrev_b32 v242, 16, v160
ds_read_b64_tr_b16 v[220:221], v246 offset:12288
ds_read_b64_tr_b16 v[222:223], v246 offset:14336
s_waitcnt lgkmcnt(8)
v_mfma_f32_16x16x32_bf16 v[20:23], v[124:127], v[212:215], v[20:23]
v_and_b32 v243, s36, v160
ds_read_b128 v[204:207], v248 offset:35840
s_waitcnt lgkmcnt(7)
v_mfma_f32_16x16x32_bf16 v[40:43], v[128:131], v[212:215], v[40:43]
v_fma_f32 v242, v242, s35, v232
s_waitcnt lgkmcnt(6)
v_mfma_f32_16x16x32_bf16 v[4:7], v[120:123], v[216:219], v[4:7]
v_fma_f32 v243, v243, s35, v232
ds_read_b64_tr_b16 v[224:225], v246 offset:16384
ds_read_b64_tr_b16 v[226:227], v246 offset:18432
v_mfma_f32_16x16x32_bf16 v[24:27], v[124:127], v[216:219], v[24:27]
v_exp_f32 v242, v242
ds_read_b128 v[208:211], v248 offset:36864
v_mfma_f32_16x16x32_bf16 v[44:47], v[128:131], v[216:219], v[44:47]
v_exp_f32 v243, v243
s_waitcnt lgkmcnt(8)
v_mfma_f32_16x16x32_bf16 v[8:11], v[120:123], v[132:135], v[8:11]
v_add_f32 v237, v237, v242
ds_read_b64_tr_b16 v[228:229], v246 offset:20480
ds_read_b64_tr_b16 v[230:231], v246 offset:22528
v_mfma_f32_16x16x32_bf16 v[28:31], v[124:127], v[132:135], v[28:31]
v_cvt_pk_bf16_f32 v160, v242, v243
ds_read_b128 v[212:215], v248 offset:37888
v_mfma_f32_16x16x32_bf16 v[48:51], v[128:131], v[132:135], v[48:51]
v_add_f32 v237, v237, v243
s_waitcnt lgkmcnt(10)
v_mfma_f32_16x16x32_bf16 v[12:15], v[120:123], v[136:139], v[12:15]
v_mfma_f32_16x16x32_bf16 v[32:35], v[124:127], v[136:139], v[32:35]
v_lshlrev_b32 v244, 16, v161
ds_read_b128 v[216:219], v248 offset:38912
v_mfma_f32_16x16x32_bf16 v[52:55], v[128:131], v[136:139], v[52:55]
v_and_b32 v245, s36, v161
s_waitcnt lgkmcnt(10)
v_mfma_f32_16x16x32_bf16 v[16:19], v[120:123], v[200:203], v[16:19]
v_fma_f32 v244, v244, s35, v232
v_mfma_f32_16x16x32_bf16 v[36:39], v[124:127], v[200:203], v[36:39]
v_fma_f32 v245, v245, s35, v232
ds_read_b128 v[132:135], v248 offset:39936
v_mfma_f32_16x16x32_bf16 v[56:59], v[128:131], v[200:203], v[56:59]
v_exp_f32 v244, v244
s_waitcnt lgkmcnt(2)
v_mfma_f32_16x16x32_bf16 v[0:3], v[220:223], v[204:207], v[0:3]
v_exp_f32 v245, v245
v_mfma_f32_16x16x32_bf16 v[20:23], v[224:227], v[204:207], v[20:23]
v_add_f32 v237, v237, v244
ds_read_b128 v[136:139], v248 offset:40960
v_mfma_f32_16x16x32_bf16 v[40:43], v[228:231], v[204:207], v[40:43]
v_cvt_pk_bf16_f32 v161, v244, v245
v_mfma_f32_16x16x32_bf16 v[4:7], v[220:223], v[208:211], v[4:7]
v_add_f32 v237, v237, v245
v_mfma_f32_16x16x32_bf16 v[24:27], v[224:227], v[208:211], v[24:27]
ds_read_b128 v[200:203], v248 offset:41984
v_mfma_f32_16x16x32_bf16 v[44:47], v[228:231], v[208:211], v[44:47]
v_lshlrev_b32 v242, 16, v162
v_mfma_f32_16x16x32_bf16 v[8:11], v[220:223], v[212:215], v[8:11]
v_and_b32 v243, s36, v162
v_mfma_f32_16x16x32_bf16 v[28:31], v[224:227], v[212:215], v[28:31]
v_fma_f32 v242, v242, s35, v232
ds_read_b128 v[204:207], v248 offset:43008
v_mfma_f32_16x16x32_bf16 v[48:51], v[228:231], v[212:215], v[48:51]
v_fma_f32 v243, v243, s35, v232
s_waitcnt lgkmcnt(3)
v_mfma_f32_16x16x32_bf16 v[12:15], v[220:223], v[216:219], v[12:15]
v_exp_f32 v242, v242
v_mfma_f32_16x16x32_bf16 v[32:35], v[224:227], v[216:219], v[32:35]
v_exp_f32 v243, v243
ds_read_b128 v[208:211], v248 offset:44032
v_mfma_f32_16x16x32_bf16 v[52:55], v[228:231], v[216:219], v[52:55]
v_add_f32 v237, v237, v242
v_mfma_f32_16x16x32_bf16 v[16:19], v[220:223], v[132:135], v[16:19]
v_cvt_pk_bf16_f32 v162, v242, v243
v_mfma_f32_16x16x32_bf16 v[36:39], v[224:227], v[132:135], v[36:39]
v_add_f32 v237, v237, v243
ds_read_b128 v[212:215], v248 offset:45056
v_mfma_f32_16x16x32_bf16 v[56:59], v[228:231], v[132:135], v[56:59]
s_barrier
ds_read_b64_tr_b16 v[120:121], v246 offset:24576
ds_read_b64_tr_b16 v[122:123], v246 offset:26624
ds_read_b64_tr_b16 v[124:125], v246 offset:28672
ds_read_b64_tr_b16 v[126:127], v246 offset:30720
ds_read_b64_tr_b16 v[128:129], v246 offset:32768
ds_read_b64_tr_b16 v[130:131], v246 offset:34816
s_waitcnt lgkmcnt(4)
v_mfma_f32_16x16x32_bf16 v[0:3], v[120:123], v[136:139], v[0:3]
ds_read_b64_tr_b16 v[220:221], v246 offset:36864
ds_read_b64_tr_b16 v[222:223], v246 offset:38912
s_waitcnt lgkmcnt(4)
v_mfma_f32_16x16x32_bf16 v[20:23], v[124:127], v[136:139], v[20:23]
ds_read_b128 v[216:219], v248 offset:46080
s_waitcnt lgkmcnt(3)
v_mfma_f32_16x16x32_bf16 v[40:43], v[128:131], v[136:139], v[40:43]
v_mfma_f32_16x16x32_bf16 v[4:7], v[120:123], v[200:203], v[4:7]
ds_read_b64_tr_b16 v[224:225], v246 offset:40960
ds_read_b64_tr_b16 v[226:227], v246 offset:43008
v_mfma_f32_16x16x32_bf16 v[24:27], v[124:127], v[200:203], v[24:27]
ds_read_b128 v[132:135], v248 offset:47104
v_mfma_f32_16x16x32_bf16 v[44:47], v[128:131], v[200:203], v[44:47]
v_mfma_f32_16x16x32_bf16 v[8:11], v[120:123], v[204:207], v[8:11]
ds_read_b64_tr_b16 v[228:229], v246 offset:45056
ds_read_b64_tr_b16 v[230:231], v246 offset:47104
v_mfma_f32_16x16x32_bf16 v[28:31], v[124:127], v[204:207], v[28:31]
ds_read_b128 v[136:139], v248 offset:48128
v_mfma_f32_16x16x32_bf16 v[48:51], v[128:131], v[204:207], v[48:51]
v_mfma_f32_16x16x32_bf16 v[12:15], v[120:123], v[208:211], v[12:15]
v_mfma_f32_16x16x32_bf16 v[32:35], v[124:127], v[208:211], v[32:35]
ds_read_b128 v[200:203], v248 offset:49152
v_mfma_f32_16x16x32_bf16 v[52:55], v[128:131], v[208:211], v[52:55]
v_mfma_f32_16x16x32_bf16 v[16:19], v[120:123], v[212:215], v[16:19]
v_mfma_f32_16x16x32_bf16 v[36:39], v[124:127], v[212:215], v[36:39]
ds_read_b128 v[204:207], v248 offset:50176
v_mfma_f32_16x16x32_bf16 v[56:59], v[128:131], v[212:215], v[56:59]
s_waitcnt lgkmcnt(0)
s_barrier
v_mfma_f32_16x16x32_bf16 v[0:3], v[220:223], v[216:219], v[0:3]
v_lshlrev_b32 v242, 16, v163
v_and_b32 v243, s36, v163
ds_read_b64_tr_b16 v[120:121], v253 offset:0
ds_read_b64_tr_b16 v[122:123], v253 offset:2048
v_mfma_f32_16x16x32_bf16 v[20:23], v[224:227], v[216:219], v[20:23]
v_fma_f32 v242, v242, s35, v232
ds_read_b128 v[208:211], v252 offset:40960
v_mfma_f32_16x16x32_bf16 v[40:43], v[228:231], v[216:219], v[40:43]
v_fma_f32 v243, v243, s35, v232
v_mfma_f32_16x16x32_bf16 v[4:7], v[220:223], v[132:135], v[4:7]
v_exp_f32 v242, v242
ds_read_b64_tr_b16 v[124:125], v253 offset:4096
ds_read_b64_tr_b16 v[126:127], v253 offset:6144
v_mfma_f32_16x16x32_bf16 v[24:27], v[224:227], v[132:135], v[24:27]
v_exp_f32 v243, v243
ds_read_b128 v[212:215], v252 offset:43008
v_mfma_f32_16x16x32_bf16 v[44:47], v[228:231], v[132:135], v[44:47]
v_add_f32 v237, v237, v242
v_cvt_pk_bf16_f32 v163, v242, v243
v_mfma_f32_16x16x32_bf16 v[8:11], v[220:223], v[136:139], v[8:11]
v_add_f32 v237, v237, v243
ds_read_b64_tr_b16 v[128:129], v253 offset:8192
ds_read_b64_tr_b16 v[130:131], v253 offset:10240
v_mfma_f32_16x16x32_bf16 v[28:31], v[224:227], v[136:139], v[28:31]
v_lshlrev_b32 v244, 16, v164
ds_read_b128 v[216:219], v252 offset:45056
v_mfma_f32_16x16x32_bf16 v[48:51], v[228:231], v[136:139], v[48:51]
v_and_b32 v245, s36, v164
v_mfma_f32_16x16x32_bf16 v[12:15], v[220:223], v[200:203], v[12:15]
v_fma_f32 v244, v244, s35, v233
v_mfma_f32_16x16x32_bf16 v[32:35], v[224:227], v[200:203], v[32:35]
v_fma_f32 v245, v245, s35, v233
v_exp_f32 v244, v244
ds_read_b128 v[132:135], v252 offset:47104
v_mfma_f32_16x16x32_bf16 v[52:55], v[228:231], v[200:203], v[52:55]
v_exp_f32 v245, v245
v_mfma_f32_16x16x32_bf16 v[16:19], v[220:223], v[204:207], v[16:19]
v_add_f32 v238, v238, v244
v_mfma_f32_16x16x32_bf16 v[36:39], v[224:227], v[204:207], v[36:39]
v_cvt_pk_bf16_f32 v164, v244, v245
ds_read_b128 v[136:139], v252 offset:49152
v_mfma_f32_16x16x32_bf16 v[56:59], v[228:231], v[204:207], v[56:59]
v_add_f32 v238, v238, v245
s_waitcnt lgkmcnt(2)
v_mfma_f32_16x16x32_bf16 v[60:63], v[120:123], v[208:211], v[60:63]
ds_write_b128 v255, v[160:163] offset:0
v_lshlrev_b32 v242, 16, v165
ds_read_b64_tr_b16 v[220:221], v253 offset:12288
ds_read_b64_tr_b16 v[222:223], v253 offset:14336
v_mfma_f32_16x16x32_bf16 v[80:83], v[124:127], v[208:211], v[80:83]
v_and_b32 v243, s36, v165
v_fma_f32 v242, v242, s35, v233
ds_read_b128 v[200:203], v251 offset:0
v_mfma_f32_16x16x32_bf16 v[100:103], v[128:131], v[208:211], v[100:103]
v_fma_f32 v243, v243, s35, v233
v_exp_f32 v242, v242
v_mfma_f32_16x16x32_bf16 v[64:67], v[120:123], v[212:215], v[64:67]
v_exp_f32 v243, v243
v_add_f32 v238, v238, v242
ds_read_b64_tr_b16 v[224:225], v253 offset:16384
ds_read_b64_tr_b16 v[226:227], v253 offset:18432
v_mfma_f32_16x16x32_bf16 v[84:87], v[124:127], v[212:215], v[84:87]
v_cvt_pk_bf16_f32 v165, v242, v243
v_add_f32 v238, v238, v243
ds_read_b128 v[204:207], v251 offset:2048
v_mfma_f32_16x16x32_bf16 v[104:107], v[128:131], v[212:215], v[104:107]
v_lshlrev_b32 v244, 16, v166
v_and_b32 v245, s36, v166
v_mfma_f32_16x16x32_bf16 v[68:71], v[120:123], v[216:219], v[68:71]
v_fma_f32 v244, v244, s35, v233
v_fma_f32 v245, v245, s35, v233
ds_read_b64_tr_b16 v[228:229], v253 offset:20480
ds_read_b64_tr_b16 v[230:231], v253 offset:22528
v_mfma_f32_16x16x32_bf16 v[88:91], v[124:127], v[216:219], v[88:91]
v_exp_f32 v244, v244
ds_read_b128 v[208:211], v251 offset:4096
v_mfma_f32_16x16x32_bf16 v[108:111], v[128:131], v[216:219], v[108:111]
v_exp_f32 v245, v245
v_add_f32 v238, v238, v244
s_waitcnt lgkmcnt(10)
v_mfma_f32_16x16x32_bf16 v[72:75], v[120:123], v[132:135], v[72:75]
v_cvt_pk_bf16_f32 v166, v244, v245
v_add_f32 v238, v238, v245
v_mfma_f32_16x16x32_bf16 v[92:95], v[124:127], v[132:135], v[92:95]
v_lshlrev_b32 v242, 16, v167
v_and_b32 v243, s36, v167
ds_read_b128 v[212:215], v251 offset:6144
v_mfma_f32_16x16x32_bf16 v[112:115], v[128:131], v[132:135], v[112:115]
v_fma_f32 v242, v242, s35, v233
v_fma_f32 v243, v243, s35, v233
v_mfma_f32_16x16x32_bf16 v[76:79], v[120:123], v[136:139], v[76:79]
v_exp_f32 v242, v242
v_exp_f32 v243, v243
v_mfma_f32_16x16x32_bf16 v[96:99], v[124:127], v[136:139], v[96:99]
v_add_f32 v238, v238, v242
v_cvt_pk_bf16_f32 v167, v242, v243
ds_read_b128 v[216:219], v251 offset:8192
v_mfma_f32_16x16x32_bf16 v[116:119], v[128:131], v[136:139], v[116:119]
v_add_f32 v238, v238, v243
s_waitcnt lgkmcnt(2)
v_mfma_f32_16x16x32_bf16 v[60:63], v[220:223], v[200:203], v[60:63]
ds_write_b128 v255, v[164:167] offset:1024
v_lshlrev_b32 v244, 16, v168
ds_read_b64_tr_b16 v[120:121], v253 offset:24576
ds_read_b64_tr_b16 v[122:123], v253 offset:26624
v_mfma_f32_16x16x32_bf16 v[80:83], v[224:227], v[200:203], v[80:83]
v_and_b32 v245, s36, v168
v_fma_f32 v244, v244, s35, v234
ds_read_b128 v[132:135], v252 offset:0
v_mfma_f32_16x16x32_bf16 v[100:103], v[228:231], v[200:203], v[100:103]
v_fma_f32 v245, v245, s35, v234
v_exp_f32 v244, v244
v_mfma_f32_16x16x32_bf16 v[64:67], v[220:223], v[204:207], v[64:67]
v_exp_f32 v245, v245
v_add_f32 v239, v239, v244
ds_read_b64_tr_b16 v[124:125], v253 offset:28672
ds_read_b64_tr_b16 v[126:127], v253 offset:30720
v_mfma_f32_16x16x32_bf16 v[84:87], v[224:227], v[204:207], v[84:87]
v_cvt_pk_bf16_f32 v168, v244, v245
v_add_f32 v239, v239, v245
ds_read_b128 v[136:139], v252 offset:2048
v_mfma_f32_16x16x32_bf16 v[104:107], v[228:231], v[204:207], v[104:107]
v_lshlrev_b32 v242, 16, v169
v_and_b32 v243, s36, v169
v_mfma_f32_16x16x32_bf16 v[68:71], v[220:223], v[208:211], v[68:71]
v_fma_f32 v242, v242, s35, v234
v_fma_f32 v243, v243, s35, v234
ds_read_b64_tr_b16 v[128:129], v253 offset:32768
ds_read_b64_tr_b16 v[130:131], v253 offset:34816
v_mfma_f32_16x16x32_bf16 v[88:91], v[224:227], v[208:211], v[88:91]
v_exp_f32 v242, v242
ds_read_b128 v[200:203], v252 offset:4096
v_mfma_f32_16x16x32_bf16 v[108:111], v[228:231], v[208:211], v[108:111]
v_exp_f32 v243, v243
v_add_f32 v239, v239, v242
s_waitcnt lgkmcnt(10)
v_mfma_f32_16x16x32_bf16 v[72:75], v[220:223], v[212:215], v[72:75]
v_cvt_pk_bf16_f32 v169, v242, v243
v_add_f32 v239, v239, v243
v_mfma_f32_16x16x32_bf16 v[92:95], v[224:227], v[212:215], v[92:95]
v_lshlrev_b32 v244, 16, v170
v_and_b32 v245, s36, v170
ds_read_b128 v[204:207], v252 offset:6144
v_mfma_f32_16x16x32_bf16 v[112:115], v[228:231], v[212:215], v[112:115]
v_fma_f32 v244, v244, s35, v234
v_fma_f32 v245, v245, s35, v234
v_mfma_f32_16x16x32_bf16 v[76:79], v[220:223], v[216:219], v[76:79]
v_exp_f32 v244, v244
v_exp_f32 v245, v245
v_mfma_f32_16x16x32_bf16 v[96:99], v[224:227], v[216:219], v[96:99]
v_add_f32 v239, v239, v244
v_cvt_pk_bf16_f32 v170, v244, v245
ds_read_b128 v[208:211], v252 offset:8192
v_mfma_f32_16x16x32_bf16 v[116:119], v[228:231], v[216:219], v[116:119]
v_add_f32 v239, v239, v245
s_waitcnt lgkmcnt(2)
v_mfma_f32_16x16x32_bf16 v[60:63], v[120:123], v[132:135], v[60:63]
v_lshlrev_b32 v242, 16, v171
v_and_b32 v243, s36, v171
ds_read_b64_tr_b16 v[220:221], v253 offset:36864
ds_read_b64_tr_b16 v[222:223], v253 offset:38912
v_mfma_f32_16x16x32_bf16 v[80:83], v[124:127], v[132:135], v[80:83]
v_fma_f32 v242, v242, s35, v234
v_fma_f32 v243, v243, s35, v234
ds_read_b128 v[212:215], v251 offset:10240
v_mfma_f32_16x16x32_bf16 v[100:103], v[128:131], v[132:135], v[100:103]
v_exp_f32 v242, v242
v_exp_f32 v243, v243
v_mfma_f32_16x16x32_bf16 v[64:67], v[120:123], v[136:139], v[64:67]
v_add_f32 v239, v239, v242
v_cvt_pk_bf16_f32 v171, v242, v243
ds_read_b64_tr_b16 v[224:225], v253 offset:40960
ds_read_b64_tr_b16 v[226:227], v253 offset:43008
v_mfma_f32_16x16x32_bf16 v[84:87], v[124:127], v[136:139], v[84:87]
v_add_f32 v239, v239, v243
ds_write_b128 v255, v[168:171] offset:2048
ds_read_b128 v[216:219], v251 offset:12288
v_mfma_f32_16x16x32_bf16 v[104:107], v[128:131], v[136:139], v[104:107]
v_lshlrev_b32 v244, 16, v172
v_and_b32 v245, s36, v172
v_mfma_f32_16x16x32_bf16 v[68:71], v[120:123], v[200:203], v[68:71]
v_fma_f32 v244, v244, s35, v235
v_fma_f32 v245, v245, s35, v235
ds_read_b64_tr_b16 v[228:229], v253 offset:45056
ds_read_b64_tr_b16 v[230:231], v253 offset:47104
v_mfma_f32_16x16x32_bf16 v[88:91], v[124:127], v[200:203], v[88:91]
v_exp_f32 v244, v244
ds_read_b128 v[132:135], v251 offset:14336
v_mfma_f32_16x16x32_bf16 v[108:111], v[128:131], v[200:203], v[108:111]
v_exp_f32 v245, v245
v_add_f32 v240, v240, v244
s_waitcnt lgkmcnt(10)
v_mfma_f32_16x16x32_bf16 v[72:75], v[120:123], v[204:207], v[72:75]
v_cvt_pk_bf16_f32 v172, v244, v245
v_add_f32 v240, v240, v245
v_mfma_f32_16x16x32_bf16 v[92:95], v[124:127], v[204:207], v[92:95]
v_lshlrev_b32 v242, 16, v173
v_and_b32 v243, s36, v173
ds_read_b128 v[136:139], v251 offset:16384
v_mfma_f32_16x16x32_bf16 v[112:115], v[128:131], v[204:207], v[112:115]
v_fma_f32 v242, v242, s35, v235
v_fma_f32 v243, v243, s35, v235
v_mfma_f32_16x16x32_bf16 v[76:79], v[120:123], v[208:211], v[76:79]
v_exp_f32 v242, v242
v_exp_f32 v243, v243
v_mfma_f32_16x16x32_bf16 v[96:99], v[124:127], v[208:211], v[96:99]
v_add_f32 v240, v240, v242
v_cvt_pk_bf16_f32 v173, v242, v243
ds_read_b128 v[200:203], v251 offset:18432
v_mfma_f32_16x16x32_bf16 v[116:119], v[128:131], v[208:211], v[116:119]
v_add_f32 v240, v240, v243
s_waitcnt lgkmcnt(0)
s_barrier
v_mfma_f32_16x16x32_bf16 v[60:63], v[220:223], v[212:215], v[60:63]
v_lshlrev_b32 v242, 16, v174
v_and_b32 v243, s36, v174
ds_read_b64_tr_b16 v[120:121], v253 offset:49152
ds_read_b64_tr_b16 v[122:123], v253 offset:51200
v_mfma_f32_16x16x32_bf16 v[80:83], v[224:227], v[212:215], v[80:83]
v_fma_f32 v242, v242, s35, v235
v_fma_f32 v243, v243, s35, v235
ds_read_b128 v[204:207], v252 offset:10240
v_mfma_f32_16x16x32_bf16 v[100:103], v[228:231], v[212:215], v[100:103]
v_exp_f32 v242, v242
v_exp_f32 v243, v243
v_mfma_f32_16x16x32_bf16 v[64:67], v[220:223], v[216:219], v[64:67]
v_add_f32 v240, v240, v242
v_cvt_pk_bf16_f32 v174, v242, v243
ds_read_b64_tr_b16 v[124:125], v253 offset:53248
ds_read_b64_tr_b16 v[126:127], v253 offset:55296
v_mfma_f32_16x16x32_bf16 v[84:87], v[224:227], v[216:219], v[84:87]
v_add_f32 v240, v240, v243
v_lshlrev_b32 v244, 16, v175
ds_read_b128 v[208:211], v252 offset:12288
v_mfma_f32_16x16x32_bf16 v[104:107], v[228:231], v[216:219], v[104:107]
v_and_b32 v245, s36, v175
v_fma_f32 v244, v244, s35, v235
v_mfma_f32_16x16x32_bf16 v[68:71], v[220:223], v[132:135], v[68:71]
v_fma_f32 v245, v245, s35, v235
v_exp_f32 v244, v244
ds_read_b64_tr_b16 v[128:129], v253 offset:57344
ds_read_b64_tr_b16 v[130:131], v253 offset:59392
v_mfma_f32_16x16x32_bf16 v[88:91], v[224:227], v[132:135], v[88:91]
v_exp_f32 v245, v245
ds_read_b128 v[212:215], v252 offset:14336
v_mfma_f32_16x16x32_bf16 v[108:111], v[228:231], v[132:135], v[108:111]
v_add_f32 v240, v240, v244
v_cvt_pk_bf16_f32 v175, v244, v245
v_mfma_f32_16x16x32_bf16 v[72:75], v[220:223], v[136:139], v[72:75]
v_add_f32 v240, v240, v245
ds_write_b128 v255, v[172:175] offset:3072
v_mfma_f32_16x16x32_bf16 v[92:95], v[224:227], v[136:139], v[92:95]
v_lshlrev_b32 v242, 16, v176
v_and_b32 v243, s36, v176
ds_read_b128 v[216:219], v252 offset:16384
v_mfma_f32_16x16x32_bf16 v[112:115], v[228:231], v[136:139], v[112:115]
v_fma_f32 v242, v242, s35, v236
v_fma_f32 v243, v243, s35, v236
v_mfma_f32_16x16x32_bf16 v[76:79], v[220:223], v[200:203], v[76:79]
v_exp_f32 v242, v242
v_exp_f32 v243, v243
v_mfma_f32_16x16x32_bf16 v[96:99], v[224:227], v[200:203], v[96:99]
v_add_f32 v241, v241, v242
v_cvt_pk_bf16_f32 v176, v242, v243
ds_read_b128 v[132:135], v252 offset:18432
v_mfma_f32_16x16x32_bf16 v[116:119], v[228:231], v[200:203], v[116:119]
v_add_f32 v241, v241, v243
s_waitcnt lgkmcnt(3)
v_mfma_f32_16x16x32_bf16 v[60:63], v[120:123], v[204:207], v[60:63]
v_lshlrev_b32 v244, 16, v177
v_and_b32 v245, s36, v177
v_mfma_f32_16x16x32_bf16 v[80:83], v[124:127], v[204:207], v[80:83]
v_fma_f32 v244, v244, s35, v236
v_fma_f32 v245, v245, s35, v236
v_mfma_f32_16x16x32_bf16 v[100:103], v[128:131], v[204:207], v[100:103]
v_exp_f32 v244, v244
v_exp_f32 v245, v245
v_mfma_f32_16x16x32_bf16 v[64:67], v[120:123], v[208:211], v[64:67]
v_add_f32 v241, v241, v244
v_cvt_pk_bf16_f32 v177, v244, v245
v_mfma_f32_16x16x32_bf16 v[84:87], v[124:127], v[208:211], v[84:87]
v_add_f32 v241, v241, v245
v_lshlrev_b32 v242, 16, v178
v_mfma_f32_16x16x32_bf16 v[104:107], v[128:131], v[208:211], v[104:107]
v_and_b32 v243, s36, v178
v_fma_f32 v242, v242, s35, v236
v_mfma_f32_16x16x32_bf16 v[68:71], v[120:123], v[212:215], v[68:71]
v_fma_f32 v243, v243, s35, v236
v_exp_f32 v242, v242
v_mfma_f32_16x16x32_bf16 v[88:91], v[124:127], v[212:215], v[88:91]
v_exp_f32 v243, v243
v_mfma_f32_16x16x32_bf16 v[108:111], v[128:131], v[212:215], v[108:111]
v_add_f32 v241, v241, v242
v_cvt_pk_bf16_f32 v178, v242, v243
s_waitcnt lgkmcnt(0)
v_mfma_f32_16x16x32_bf16 v[72:75], v[120:123], v[216:219], v[72:75]
v_add_f32 v241, v241, v243
v_lshlrev_b32 v244, 16, v179
v_mfma_f32_16x16x32_bf16 v[92:95], v[124:127], v[216:219], v[92:95]
v_and_b32 v245, s36, v179
v_fma_f32 v244, v244, s35, v236
v_mfma_f32_16x16x32_bf16 v[112:115], v[128:131], v[216:219], v[112:115]
v_fma_f32 v245, v245, s35, v236
v_exp_f32 v244, v244
v_mfma_f32_16x16x32_bf16 v[76:79], v[120:123], v[132:135], v[76:79]
v_exp_f32 v245, v245
v_add_f32 v241, v241, v244
v_mfma_f32_16x16x32_bf16 v[96:99], v[124:127], v[132:135], v[96:99]
v_cvt_pk_bf16_f32 v179, v244, v245
v_add_f32 v241, v241, v245
v_mfma_f32_16x16x32_bf16 v[116:119], v[128:131], v[132:135], v[116:119]
ds_write_b128 v255, v[176:179] offset:4096
s_waitcnt lgkmcnt(0)
s_barrier
ds_read_b64_tr_b16 v[220:221], v246 offset:0
ds_read_b64_tr_b16 v[222:223], v246 offset:2048
ds_read_b128 v[136:139], v248 offset:30720
ds_read_b64_tr_b16 v[224:225], v246 offset:4096
ds_read_b64_tr_b16 v[226:227], v246 offset:6144
ds_read_b64_tr_b16 v[228:229], v246 offset:8192
ds_read_b64_tr_b16 v[230:231], v246 offset:10240
ds_read_b128 v[200:203], v248 offset:31744
ds_read_b128 v[204:207], v248 offset:32768
ds_read_b128 v[208:211], v248 offset:33792
ds_read_b128 v[212:215], v248 offset:34816
s_waitcnt lgkmcnt(8)
v_mfma_f32_16x16x32_bf16 v[0:3], v[220:223], v[136:139], v[0:3]
v_lshlrev_b32 v242, 16, v180
ds_read_b64_tr_b16 v[120:121], v246 offset:12288
ds_read_b64_tr_b16 v[122:123], v246 offset:14336
s_waitcnt lgkmcnt(8)
v_mfma_f32_16x16x32_bf16 v[20:23], v[224:227], v[136:139], v[20:23]
v_and_b32 v243, s36, v180
ds_read_b128 v[216:219], v248 offset:35840
s_waitcnt lgkmcnt(7)
v_mfma_f32_16x16x32_bf16 v[40:43], v[228:231], v[136:139], v[40:43]
v_fma_f32 v242, v242, s35, v232
s_waitcnt lgkmcnt(6)
v_mfma_f32_16x16x32_bf16 v[4:7], v[220:223], v[200:203], v[4:7]
v_fma_f32 v243, v243, s35, v232
ds_read_b64_tr_b16 v[124:125], v246 offset:16384
ds_read_b64_tr_b16 v[126:127], v246 offset:18432
v_mfma_f32_16x16x32_bf16 v[24:27], v[224:227], v[200:203], v[24:27]
v_exp_f32 v242, v242
ds_read_b128 v[132:135], v248 offset:36864
v_mfma_f32_16x16x32_bf16 v[44:47], v[228:231], v[200:203], v[44:47]
v_exp_f32 v243, v243
s_waitcnt lgkmcnt(8)
v_mfma_f32_16x16x32_bf16 v[8:11], v[220:223], v[204:207], v[8:11]
v_add_f32 v237, v237, v242
ds_read_b64_tr_b16 v[128:129], v246 offset:20480
ds_read_b64_tr_b16 v[130:131], v246 offset:22528
v_mfma_f32_16x16x32_bf16 v[28:31], v[224:227], v[204:207], v[28:31]
v_cvt_pk_bf16_f32 v180, v242, v243
ds_read_b128 v[136:139], v248 offset:37888
v_mfma_f32_16x16x32_bf16 v[48:51], v[228:231], v[204:207], v[48:51]
v_add_f32 v237, v237, v243
s_waitcnt lgkmcnt(10)
v_mfma_f32_16x16x32_bf16 v[12:15], v[220:223], v[208:211], v[12:15]
v_mfma_f32_16x16x32_bf16 v[32:35], v[224:227], v[208:211], v[32:35]
v_lshlrev_b32 v244, 16, v181
ds_read_b128 v[200:203], v248 offset:38912
v_mfma_f32_16x16x32_bf16 v[52:55], v[228:231], v[208:211], v[52:55]
v_and_b32 v245, s36, v181
s_waitcnt lgkmcnt(10)
v_mfma_f32_16x16x32_bf16 v[16:19], v[220:223], v[212:215], v[16:19]
v_fma_f32 v244, v244, s35, v232
v_mfma_f32_16x16x32_bf16 v[36:39], v[224:227], v[212:215], v[36:39]
v_fma_f32 v245, v245, s35, v232
ds_read_b128 v[204:207], v248 offset:39936
v_mfma_f32_16x16x32_bf16 v[56:59], v[228:231], v[212:215], v[56:59]
v_exp_f32 v244, v244
s_waitcnt lgkmcnt(2)
v_mfma_f32_16x16x32_bf16 v[0:3], v[120:123], v[216:219], v[0:3]
v_exp_f32 v245, v245
v_mfma_f32_16x16x32_bf16 v[20:23], v[124:127], v[216:219], v[20:23]
v_add_f32 v237, v237, v244
ds_read_b128 v[208:211], v248 offset:40960
v_mfma_f32_16x16x32_bf16 v[40:43], v[128:131], v[216:219], v[40:43]
v_cvt_pk_bf16_f32 v181, v244, v245
v_mfma_f32_16x16x32_bf16 v[4:7], v[120:123], v[132:135], v[4:7]
v_add_f32 v237, v237, v245
v_mfma_f32_16x16x32_bf16 v[24:27], v[124:127], v[132:135], v[24:27]
ds_read_b128 v[212:215], v248 offset:41984
v_mfma_f32_16x16x32_bf16 v[44:47], v[128:131], v[132:135], v[44:47]
v_lshlrev_b32 v242, 16, v182
v_mfma_f32_16x16x32_bf16 v[8:11], v[120:123], v[136:139], v[8:11]
v_and_b32 v243, s36, v182
v_mfma_f32_16x16x32_bf16 v[28:31], v[124:127], v[136:139], v[28:31]
v_fma_f32 v242, v242, s35, v232
ds_read_b128 v[216:219], v248 offset:43008
v_mfma_f32_16x16x32_bf16 v[48:51], v[128:131], v[136:139], v[48:51]
v_fma_f32 v243, v243, s35, v232
s_waitcnt lgkmcnt(3)
v_mfma_f32_16x16x32_bf16 v[12:15], v[120:123], v[200:203], v[12:15]
v_exp_f32 v242, v242
v_mfma_f32_16x16x32_bf16 v[32:35], v[124:127], v[200:203], v[32:35]
v_exp_f32 v243, v243
ds_read_b128 v[132:135], v248 offset:44032
v_mfma_f32_16x16x32_bf16 v[52:55], v[128:131], v[200:203], v[52:55]
v_add_f32 v237, v237, v242
v_mfma_f32_16x16x32_bf16 v[16:19], v[120:123], v[204:207], v[16:19]
v_cvt_pk_bf16_f32 v182, v242, v243
v_mfma_f32_16x16x32_bf16 v[36:39], v[124:127], v[204:207], v[36:39]
v_add_f32 v237, v237, v243
ds_read_b128 v[136:139], v248 offset:45056
v_mfma_f32_16x16x32_bf16 v[56:59], v[128:131], v[204:207], v[56:59]
s_barrier
ds_read_b64_tr_b16 v[220:221], v246 offset:24576
ds_read_b64_tr_b16 v[222:223], v246 offset:26624
ds_read_b64_tr_b16 v[224:225], v246 offset:28672
ds_read_b64_tr_b16 v[226:227], v246 offset:30720
ds_read_b64_tr_b16 v[228:229], v246 offset:32768
ds_read_b64_tr_b16 v[230:231], v246 offset:34816
s_waitcnt lgkmcnt(4)
v_mfma_f32_16x16x32_bf16 v[0:3], v[220:223], v[208:211], v[0:3]
ds_read_b64_tr_b16 v[120:121], v246 offset:36864
ds_read_b64_tr_b16 v[122:123], v246 offset:38912
s_waitcnt lgkmcnt(4)
v_mfma_f32_16x16x32_bf16 v[20:23], v[224:227], v[208:211], v[20:23]
ds_read_b128 v[200:203], v248 offset:46080
s_waitcnt lgkmcnt(3)
v_mfma_f32_16x16x32_bf16 v[40:43], v[228:231], v[208:211], v[40:43]
v_mfma_f32_16x16x32_bf16 v[4:7], v[220:223], v[212:215], v[4:7]
ds_read_b64_tr_b16 v[124:125], v246 offset:40960
ds_read_b64_tr_b16 v[126:127], v246 offset:43008
v_mfma_f32_16x16x32_bf16 v[24:27], v[224:227], v[212:215], v[24:27]
ds_read_b128 v[204:207], v248 offset:47104
v_mfma_f32_16x16x32_bf16 v[44:47], v[228:231], v[212:215], v[44:47]
v_mfma_f32_16x16x32_bf16 v[8:11], v[220:223], v[216:219], v[8:11]
ds_read_b64_tr_b16 v[128:129], v246 offset:45056
ds_read_b64_tr_b16 v[130:131], v246 offset:47104
v_mfma_f32_16x16x32_bf16 v[28:31], v[224:227], v[216:219], v[28:31]
ds_read_b128 v[208:211], v248 offset:48128
v_mfma_f32_16x16x32_bf16 v[48:51], v[228:231], v[216:219], v[48:51]
v_mfma_f32_16x16x32_bf16 v[12:15], v[220:223], v[132:135], v[12:15]
v_mfma_f32_16x16x32_bf16 v[32:35], v[224:227], v[132:135], v[32:35]
ds_read_b128 v[212:215], v248 offset:49152
v_mfma_f32_16x16x32_bf16 v[52:55], v[228:231], v[132:135], v[52:55]
v_mfma_f32_16x16x32_bf16 v[16:19], v[220:223], v[136:139], v[16:19]
v_mfma_f32_16x16x32_bf16 v[36:39], v[224:227], v[136:139], v[36:39]
ds_read_b128 v[216:219], v248 offset:50176
v_mfma_f32_16x16x32_bf16 v[56:59], v[228:231], v[136:139], v[56:59]
s_waitcnt lgkmcnt(0)
s_barrier
v_mfma_f32_16x16x32_bf16 v[0:3], v[120:123], v[200:203], v[0:3]
v_lshlrev_b32 v242, 16, v183
v_and_b32 v243, s36, v183
ds_read_b64_tr_b16 v[220:221], v253 offset:0
ds_read_b64_tr_b16 v[222:223], v253 offset:2048
v_mfma_f32_16x16x32_bf16 v[20:23], v[124:127], v[200:203], v[20:23]
v_fma_f32 v242, v242, s35, v232
ds_read_b128 v[132:135], v251 offset:40960
v_mfma_f32_16x16x32_bf16 v[40:43], v[128:131], v[200:203], v[40:43]
v_fma_f32 v243, v243, s35, v232
v_mfma_f32_16x16x32_bf16 v[4:7], v[120:123], v[204:207], v[4:7]
v_exp_f32 v242, v242
ds_read_b64_tr_b16 v[224:225], v253 offset:4096
ds_read_b64_tr_b16 v[226:227], v253 offset:6144
v_mfma_f32_16x16x32_bf16 v[24:27], v[124:127], v[204:207], v[24:27]
v_exp_f32 v243, v243
ds_read_b128 v[136:139], v251 offset:43008
v_mfma_f32_16x16x32_bf16 v[44:47], v[128:131], v[204:207], v[44:47]
v_add_f32 v237, v237, v242
v_cvt_pk_bf16_f32 v183, v242, v243
v_mfma_f32_16x16x32_bf16 v[8:11], v[120:123], v[208:211], v[8:11]
v_add_f32 v237, v237, v243
ds_read_b64_tr_b16 v[228:229], v253 offset:8192
ds_read_b64_tr_b16 v[230:231], v253 offset:10240
v_mfma_f32_16x16x32_bf16 v[28:31], v[124:127], v[208:211], v[28:31]
v_lshlrev_b32 v244, 16, v184
ds_read_b128 v[200:203], v251 offset:45056
v_mfma_f32_16x16x32_bf16 v[48:51], v[128:131], v[208:211], v[48:51]
v_and_b32 v245, s36, v184
v_mfma_f32_16x16x32_bf16 v[12:15], v[120:123], v[212:215], v[12:15]
v_fma_f32 v244, v244, s35, v233
v_mfma_f32_16x16x32_bf16 v[32:35], v[124:127], v[212:215], v[32:35]
v_fma_f32 v245, v245, s35, v233
v_exp_f32 v244, v244
ds_read_b128 v[204:207], v251 offset:47104
v_mfma_f32_16x16x32_bf16 v[52:55], v[128:131], v[212:215], v[52:55]
v_exp_f32 v245, v245
v_mfma_f32_16x16x32_bf16 v[16:19], v[120:123], v[216:219], v[16:19]
v_add_f32 v238, v238, v244
v_mfma_f32_16x16x32_bf16 v[36:39], v[124:127], v[216:219], v[36:39]
v_cvt_pk_bf16_f32 v184, v244, v245
ds_read_b128 v[208:211], v251 offset:49152
v_mfma_f32_16x16x32_bf16 v[56:59], v[128:131], v[216:219], v[56:59]
v_add_f32 v238, v238, v245
s_waitcnt lgkmcnt(2)
v_mfma_f32_16x16x32_bf16 v[60:63], v[220:223], v[132:135], v[60:63]
ds_write_b128 v255, v[180:183] offset:0
v_lshlrev_b32 v242, 16, v185
ds_read_b64_tr_b16 v[120:121], v253 offset:12288
ds_read_b64_tr_b16 v[122:123], v253 offset:14336
v_mfma_f32_16x16x32_bf16 v[80:83], v[224:227], v[132:135], v[80:83]
v_and_b32 v243, s36, v185
v_fma_f32 v242, v242, s35, v233
ds_read_b128 v[212:215], v252 offset:40960
v_mfma_f32_16x16x32_bf16 v[100:103], v[228:231], v[132:135], v[100:103]
v_fma_f32 v243, v243, s35, v233
v_exp_f32 v242, v242
v_mfma_f32_16x16x32_bf16 v[64:67], v[220:223], v[136:139], v[64:67]
v_exp_f32 v243, v243
v_add_f32 v238, v238, v242
ds_read_b64_tr_b16 v[124:125], v253 offset:16384
ds_read_b64_tr_b16 v[126:127], v253 offset:18432
v_mfma_f32_16x16x32_bf16 v[84:87], v[224:227], v[136:139], v[84:87]
v_cvt_pk_bf16_f32 v185, v242, v243
v_add_f32 v238, v238, v243
ds_read_b128 v[216:219], v252 offset:43008
v_mfma_f32_16x16x32_bf16 v[104:107], v[228:231], v[136:139], v[104:107]
v_lshlrev_b32 v244, 16, v186
v_and_b32 v245, s36, v186
v_mfma_f32_16x16x32_bf16 v[68:71], v[220:223], v[200:203], v[68:71]
v_fma_f32 v244, v244, s35, v233
v_fma_f32 v245, v245, s35, v233
ds_read_b64_tr_b16 v[128:129], v253 offset:20480
ds_read_b64_tr_b16 v[130:131], v253 offset:22528
v_mfma_f32_16x16x32_bf16 v[88:91], v[224:227], v[200:203], v[88:91]
v_exp_f32 v244, v244
ds_read_b128 v[132:135], v252 offset:45056
v_mfma_f32_16x16x32_bf16 v[108:111], v[228:231], v[200:203], v[108:111]
v_exp_f32 v245, v245
v_add_f32 v238, v238, v244
s_waitcnt lgkmcnt(10)
v_mfma_f32_16x16x32_bf16 v[72:75], v[220:223], v[204:207], v[72:75]
v_cvt_pk_bf16_f32 v186, v244, v245
v_add_f32 v238, v238, v245
v_mfma_f32_16x16x32_bf16 v[92:95], v[224:227], v[204:207], v[92:95]
v_lshlrev_b32 v242, 16, v187
v_and_b32 v243, s36, v187
ds_read_b128 v[136:139], v252 offset:47104
v_mfma_f32_16x16x32_bf16 v[112:115], v[228:231], v[204:207], v[112:115]
v_fma_f32 v242, v242, s35, v233
v_fma_f32 v243, v243, s35, v233
v_mfma_f32_16x16x32_bf16 v[76:79], v[220:223], v[208:211], v[76:79]
v_exp_f32 v242, v242
v_exp_f32 v243, v243
v_mfma_f32_16x16x32_bf16 v[96:99], v[224:227], v[208:211], v[96:99]
v_add_f32 v238, v238, v242
v_cvt_pk_bf16_f32 v187, v242, v243
ds_read_b128 v[200:203], v252 offset:49152
v_mfma_f32_16x16x32_bf16 v[116:119], v[228:231], v[208:211], v[116:119]
v_add_f32 v238, v238, v243
s_waitcnt lgkmcnt(2)
v_mfma_f32_16x16x32_bf16 v[60:63], v[120:123], v[212:215], v[60:63]
ds_write_b128 v255, v[184:187] offset:1024
v_lshlrev_b32 v244, 16, v188
ds_read_b64_tr_b16 v[220:221], v253 offset:24576
ds_read_b64_tr_b16 v[222:223], v253 offset:26624
v_mfma_f32_16x16x32_bf16 v[80:83], v[124:127], v[212:215], v[80:83]
v_and_b32 v245, s36, v188
v_fma_f32 v244, v244, s35, v234
ds_read_b128 v[204:207], v251 offset:0
v_mfma_f32_16x16x32_bf16 v[100:103], v[128:131], v[212:215], v[100:103]
v_fma_f32 v245, v245, s35, v234
v_exp_f32 v244, v244
v_mfma_f32_16x16x32_bf16 v[64:67], v[120:123], v[216:219], v[64:67]
v_exp_f32 v245, v245
v_add_f32 v239, v239, v244
ds_read_b64_tr_b16 v[224:225], v253 offset:28672
ds_read_b64_tr_b16 v[226:227], v253 offset:30720
v_mfma_f32_16x16x32_bf16 v[84:87], v[124:127], v[216:219], v[84:87]
v_cvt_pk_bf16_f32 v188, v244, v245
v_add_f32 v239, v239, v245
ds_read_b128 v[208:211], v251 offset:2048
v_mfma_f32_16x16x32_bf16 v[104:107], v[128:131], v[216:219], v[104:107]
v_lshlrev_b32 v242, 16, v189
v_and_b32 v243, s36, v189
v_mfma_f32_16x16x32_bf16 v[68:71], v[120:123], v[132:135], v[68:71]
v_fma_f32 v242, v242, s35, v234
v_fma_f32 v243, v243, s35, v234
ds_read_b64_tr_b16 v[228:229], v253 offset:32768
ds_read_b64_tr_b16 v[230:231], v253 offset:34816
v_mfma_f32_16x16x32_bf16 v[88:91], v[124:127], v[132:135], v[88:91]
v_exp_f32 v242, v242
ds_read_b128 v[212:215], v251 offset:4096
v_mfma_f32_16x16x32_bf16 v[108:111], v[128:131], v[132:135], v[108:111]
v_exp_f32 v243, v243
v_add_f32 v239, v239, v242
s_waitcnt lgkmcnt(10)
v_mfma_f32_16x16x32_bf16 v[72:75], v[120:123], v[136:139], v[72:75]
v_cvt_pk_bf16_f32 v189, v242, v243
v_add_f32 v239, v239, v243
v_mfma_f32_16x16x32_bf16 v[92:95], v[124:127], v[136:139], v[92:95]
v_lshlrev_b32 v244, 16, v190
v_and_b32 v245, s36, v190
ds_read_b128 v[216:219], v251 offset:6144
v_mfma_f32_16x16x32_bf16 v[112:115], v[128:131], v[136:139], v[112:115]
v_fma_f32 v244, v244, s35, v234
v_fma_f32 v245, v245, s35, v234
v_mfma_f32_16x16x32_bf16 v[76:79], v[120:123], v[200:203], v[76:79]
v_exp_f32 v244, v244
v_exp_f32 v245, v245
v_mfma_f32_16x16x32_bf16 v[96:99], v[124:127], v[200:203], v[96:99]
v_add_f32 v239, v239, v244
v_cvt_pk_bf16_f32 v190, v244, v245
ds_read_b128 v[132:135], v251 offset:8192
v_mfma_f32_16x16x32_bf16 v[116:119], v[128:131], v[200:203], v[116:119]
v_add_f32 v239, v239, v245
s_waitcnt lgkmcnt(2)
v_mfma_f32_16x16x32_bf16 v[60:63], v[220:223], v[204:207], v[60:63]
v_lshlrev_b32 v242, 16, v191
v_and_b32 v243, s36, v191
ds_read_b64_tr_b16 v[120:121], v253 offset:36864
ds_read_b64_tr_b16 v[122:123], v253 offset:38912
v_mfma_f32_16x16x32_bf16 v[80:83], v[224:227], v[204:207], v[80:83]
v_fma_f32 v242, v242, s35, v234
v_fma_f32 v243, v243, s35, v234
ds_read_b128 v[136:139], v252 offset:0
v_mfma_f32_16x16x32_bf16 v[100:103], v[228:231], v[204:207], v[100:103]
v_exp_f32 v242, v242
v_exp_f32 v243, v243
v_mfma_f32_16x16x32_bf16 v[64:67], v[220:223], v[208:211], v[64:67]
v_add_f32 v239, v239, v242
v_cvt_pk_bf16_f32 v191, v242, v243
ds_read_b64_tr_b16 v[124:125], v253 offset:40960
ds_read_b64_tr_b16 v[126:127], v253 offset:43008
v_mfma_f32_16x16x32_bf16 v[84:87], v[224:227], v[208:211], v[84:87]
v_add_f32 v239, v239, v243
ds_write_b128 v255, v[188:191] offset:2048
ds_read_b128 v[200:203], v252 offset:2048
v_mfma_f32_16x16x32_bf16 v[104:107], v[228:231], v[208:211], v[104:107]
v_lshlrev_b32 v244, 16, v192
v_and_b32 v245, s36, v192
v_mfma_f32_16x16x32_bf16 v[68:71], v[220:223], v[212:215], v[68:71]
v_fma_f32 v244, v244, s35, v235
v_fma_f32 v245, v245, s35, v235
ds_read_b64_tr_b16 v[128:129], v253 offset:45056
ds_read_b64_tr_b16 v[130:131], v253 offset:47104
v_mfma_f32_16x16x32_bf16 v[88:91], v[224:227], v[212:215], v[88:91]
v_exp_f32 v244, v244
ds_read_b128 v[204:207], v252 offset:4096
v_mfma_f32_16x16x32_bf16 v[108:111], v[228:231], v[212:215], v[108:111]
v_exp_f32 v245, v245
v_add_f32 v240, v240, v244
s_waitcnt lgkmcnt(10)
v_mfma_f32_16x16x32_bf16 v[72:75], v[220:223], v[216:219], v[72:75]
v_cvt_pk_bf16_f32 v192, v244, v245
v_add_f32 v240, v240, v245
v_mfma_f32_16x16x32_bf16 v[92:95], v[224:227], v[216:219], v[92:95]
v_lshlrev_b32 v242, 16, v193
v_and_b32 v243, s36, v193
ds_read_b128 v[208:211], v252 offset:6144
v_mfma_f32_16x16x32_bf16 v[112:115], v[228:231], v[216:219], v[112:115]
v_fma_f32 v242, v242, s35, v235
v_fma_f32 v243, v243, s35, v235
v_mfma_f32_16x16x32_bf16 v[76:79], v[220:223], v[132:135], v[76:79]
v_exp_f32 v242, v242
v_exp_f32 v243, v243
v_mfma_f32_16x16x32_bf16 v[96:99], v[224:227], v[132:135], v[96:99]
v_add_f32 v240, v240, v242
v_cvt_pk_bf16_f32 v193, v242, v243
ds_read_b128 v[212:215], v252 offset:8192
v_mfma_f32_16x16x32_bf16 v[116:119], v[228:231], v[132:135], v[116:119]
v_add_f32 v240, v240, v243
s_waitcnt lgkmcnt(0)
s_barrier
v_mfma_f32_16x16x32_bf16 v[60:63], v[120:123], v[136:139], v[60:63]
v_lshlrev_b32 v242, 16, v194
v_and_b32 v243, s36, v194
ds_read_b64_tr_b16 v[220:221], v253 offset:49152
ds_read_b64_tr_b16 v[222:223], v253 offset:51200
v_mfma_f32_16x16x32_bf16 v[80:83], v[124:127], v[136:139], v[80:83]
v_fma_f32 v242, v242, s35, v235
v_fma_f32 v243, v243, s35, v235
ds_read_b128 v[216:219], v251 offset:10240
v_mfma_f32_16x16x32_bf16 v[100:103], v[128:131], v[136:139], v[100:103]
v_exp_f32 v242, v242
v_exp_f32 v243, v243
v_mfma_f32_16x16x32_bf16 v[64:67], v[120:123], v[200:203], v[64:67]
v_add_f32 v240, v240, v242
v_cvt_pk_bf16_f32 v194, v242, v243
ds_read_b64_tr_b16 v[224:225], v253 offset:53248
ds_read_b64_tr_b16 v[226:227], v253 offset:55296
v_mfma_f32_16x16x32_bf16 v[84:87], v[124:127], v[200:203], v[84:87]
v_add_f32 v240, v240, v243
v_lshlrev_b32 v244, 16, v195
ds_read_b128 v[132:135], v251 offset:12288
v_mfma_f32_16x16x32_bf16 v[104:107], v[128:131], v[200:203], v[104:107]
v_and_b32 v245, s36, v195
v_fma_f32 v244, v244, s35, v235
v_mfma_f32_16x16x32_bf16 v[68:71], v[120:123], v[204:207], v[68:71]
v_fma_f32 v245, v245, s35, v235
v_exp_f32 v244, v244
ds_read_b64_tr_b16 v[228:229], v253 offset:57344
ds_read_b64_tr_b16 v[230:231], v253 offset:59392
v_mfma_f32_16x16x32_bf16 v[88:91], v[124:127], v[204:207], v[88:91]
v_exp_f32 v245, v245
ds_read_b128 v[136:139], v251 offset:14336
v_mfma_f32_16x16x32_bf16 v[108:111], v[128:131], v[204:207], v[108:111]
v_add_f32 v240, v240, v244
v_cvt_pk_bf16_f32 v195, v244, v245
v_mfma_f32_16x16x32_bf16 v[72:75], v[120:123], v[208:211], v[72:75]
v_add_f32 v240, v240, v245
ds_write_b128 v255, v[192:195] offset:3072
v_mfma_f32_16x16x32_bf16 v[92:95], v[124:127], v[208:211], v[92:95]
v_lshlrev_b32 v242, 16, v196
v_and_b32 v243, s36, v196
ds_read_b128 v[200:203], v251 offset:16384
v_mfma_f32_16x16x32_bf16 v[112:115], v[128:131], v[208:211], v[112:115]
v_fma_f32 v242, v242, s35, v236
v_fma_f32 v243, v243, s35, v236
v_mfma_f32_16x16x32_bf16 v[76:79], v[120:123], v[212:215], v[76:79]
v_exp_f32 v242, v242
v_exp_f32 v243, v243
v_mfma_f32_16x16x32_bf16 v[96:99], v[124:127], v[212:215], v[96:99]
v_add_f32 v241, v241, v242
v_cvt_pk_bf16_f32 v196, v242, v243
ds_read_b128 v[204:207], v251 offset:18432
v_mfma_f32_16x16x32_bf16 v[116:119], v[128:131], v[212:215], v[116:119]
v_add_f32 v241, v241, v243
s_waitcnt lgkmcnt(3)
v_mfma_f32_16x16x32_bf16 v[60:63], v[220:223], v[216:219], v[60:63]
v_lshlrev_b32 v244, 16, v197
v_and_b32 v245, s36, v197
v_mfma_f32_16x16x32_bf16 v[80:83], v[224:227], v[216:219], v[80:83]
v_fma_f32 v244, v244, s35, v236
v_fma_f32 v245, v245, s35, v236
v_mfma_f32_16x16x32_bf16 v[100:103], v[228:231], v[216:219], v[100:103]
v_exp_f32 v244, v244
v_exp_f32 v245, v245
v_mfma_f32_16x16x32_bf16 v[64:67], v[220:223], v[132:135], v[64:67]
v_add_f32 v241, v241, v244
v_cvt_pk_bf16_f32 v197, v244, v245
v_mfma_f32_16x16x32_bf16 v[84:87], v[224:227], v[132:135], v[84:87]
v_add_f32 v241, v241, v245
v_lshlrev_b32 v242, 16, v198
v_mfma_f32_16x16x32_bf16 v[104:107], v[228:231], v[132:135], v[104:107]
v_and_b32 v243, s36, v198
v_fma_f32 v242, v242, s35, v236
v_mfma_f32_16x16x32_bf16 v[68:71], v[220:223], v[136:139], v[68:71]
v_fma_f32 v243, v243, s35, v236
v_exp_f32 v242, v242
v_mfma_f32_16x16x32_bf16 v[88:91], v[224:227], v[136:139], v[88:91]
v_exp_f32 v243, v243
v_mfma_f32_16x16x32_bf16 v[108:111], v[228:231], v[136:139], v[108:111]
v_add_f32 v241, v241, v242
v_cvt_pk_bf16_f32 v198, v242, v243
s_waitcnt lgkmcnt(0)
v_mfma_f32_16x16x32_bf16 v[72:75], v[220:223], v[200:203], v[72:75]
v_add_f32 v241, v241, v243
v_lshlrev_b32 v244, 16, v199
v_mfma_f32_16x16x32_bf16 v[92:95], v[224:227], v[200:203], v[92:95]
v_and_b32 v245, s36, v199
v_fma_f32 v244, v244, s35, v236
v_mfma_f32_16x16x32_bf16 v[112:115], v[228:231], v[200:203], v[112:115]
v_fma_f32 v245, v245, s35, v236
v_exp_f32 v244, v244
v_mfma_f32_16x16x32_bf16 v[76:79], v[220:223], v[204:207], v[76:79]
v_exp_f32 v245, v245
v_add_f32 v241, v241, v244
v_mfma_f32_16x16x32_bf16 v[96:99], v[224:227], v[204:207], v[96:99]
v_cvt_pk_bf16_f32 v199, v244, v245
v_add_f32 v241, v241, v245
v_mfma_f32_16x16x32_bf16 v[116:119], v[228:231], v[204:207], v[116:119]
ds_write_b128 v255, v[196:199] offset:4096
s_waitcnt lgkmcnt(0)
s_barrier
ds_read_b64_tr_b16 v[120:121], v246 offset:0
ds_read_b64_tr_b16 v[122:123], v246 offset:2048
ds_read_b128 v[208:211], v248 offset:30720
ds_read_b64_tr_b16 v[124:125], v246 offset:4096
ds_read_b64_tr_b16 v[126:127], v246 offset:6144
ds_read_b64_tr_b16 v[128:129], v246 offset:8192
ds_read_b64_tr_b16 v[130:131], v246 offset:10240
ds_read_b128 v[212:215], v248 offset:31744
ds_read_b128 v[216:219], v248 offset:32768
ds_read_b128 v[132:135], v248 offset:33792
ds_read_b128 v[136:139], v248 offset:34816
s_waitcnt lgkmcnt(8)
v_mfma_f32_16x16x32_bf16 v[0:3], v[120:123], v[208:211], v[0:3]
ds_read_b64_tr_b16 v[220:221], v246 offset:12288
ds_read_b64_tr_b16 v[222:223], v246 offset:14336
s_waitcnt lgkmcnt(8)
v_mfma_f32_16x16x32_bf16 v[20:23], v[124:127], v[208:211], v[20:23]
ds_read_b128 v[200:203], v248 offset:35840
s_waitcnt lgkmcnt(7)
v_mfma_f32_16x16x32_bf16 v[40:43], v[128:131], v[208:211], v[40:43]
s_waitcnt lgkmcnt(6)
v_mfma_f32_16x16x32_bf16 v[4:7], v[120:123], v[212:215], v[4:7]
ds_read_b64_tr_b16 v[224:225], v246 offset:16384
ds_read_b64_tr_b16 v[226:227], v246 offset:18432
v_mfma_f32_16x16x32_bf16 v[24:27], v[124:127], v[212:215], v[24:27]
ds_read_b128 v[204:207], v248 offset:36864
v_mfma_f32_16x16x32_bf16 v[44:47], v[128:131], v[212:215], v[44:47]
s_waitcnt lgkmcnt(8)
v_mfma_f32_16x16x32_bf16 v[8:11], v[120:123], v[216:219], v[8:11]
ds_read_b64_tr_b16 v[228:229], v246 offset:20480
ds_read_b64_tr_b16 v[230:231], v246 offset:22528
v_mfma_f32_16x16x32_bf16 v[28:31], v[124:127], v[216:219], v[28:31]
ds_read_b128 v[208:211], v248 offset:37888
v_mfma_f32_16x16x32_bf16 v[48:51], v[128:131], v[216:219], v[48:51]
s_waitcnt lgkmcnt(10)
v_mfma_f32_16x16x32_bf16 v[12:15], v[120:123], v[132:135], v[12:15]
v_mfma_f32_16x16x32_bf16 v[32:35], v[124:127], v[132:135], v[32:35]
ds_read_b128 v[212:215], v248 offset:38912
v_mfma_f32_16x16x32_bf16 v[52:55], v[128:131], v[132:135], v[52:55]
s_waitcnt lgkmcnt(10)
v_mfma_f32_16x16x32_bf16 v[16:19], v[120:123], v[136:139], v[16:19]
v_mfma_f32_16x16x32_bf16 v[36:39], v[124:127], v[136:139], v[36:39]
ds_read_b128 v[216:219], v248 offset:39936
v_mfma_f32_16x16x32_bf16 v[56:59], v[128:131], v[136:139], v[56:59]
s_waitcnt lgkmcnt(2)
v_mfma_f32_16x16x32_bf16 v[0:3], v[220:223], v[200:203], v[0:3]
v_mfma_f32_16x16x32_bf16 v[20:23], v[224:227], v[200:203], v[20:23]
ds_read_b128 v[132:135], v248 offset:40960
v_mfma_f32_16x16x32_bf16 v[40:43], v[228:231], v[200:203], v[40:43]
v_mfma_f32_16x16x32_bf16 v[4:7], v[220:223], v[204:207], v[4:7]
v_mfma_f32_16x16x32_bf16 v[24:27], v[224:227], v[204:207], v[24:27]
ds_read_b128 v[136:139], v248 offset:41984
v_mfma_f32_16x16x32_bf16 v[44:47], v[228:231], v[204:207], v[44:47]
v_mfma_f32_16x16x32_bf16 v[8:11], v[220:223], v[208:211], v[8:11]
v_mfma_f32_16x16x32_bf16 v[28:31], v[224:227], v[208:211], v[28:31]
ds_read_b128 v[200:203], v248 offset:43008
v_mfma_f32_16x16x32_bf16 v[48:51], v[228:231], v[208:211], v[48:51]
s_waitcnt lgkmcnt(3)
v_mfma_f32_16x16x32_bf16 v[12:15], v[220:223], v[212:215], v[12:15]
v_mfma_f32_16x16x32_bf16 v[32:35], v[224:227], v[212:215], v[32:35]
ds_read_b128 v[204:207], v248 offset:44032
v_mfma_f32_16x16x32_bf16 v[52:55], v[228:231], v[212:215], v[52:55]
v_mfma_f32_16x16x32_bf16 v[16:19], v[220:223], v[216:219], v[16:19]
v_mfma_f32_16x16x32_bf16 v[36:39], v[224:227], v[216:219], v[36:39]
ds_read_b128 v[208:211], v248 offset:45056
v_mfma_f32_16x16x32_bf16 v[56:59], v[228:231], v[216:219], v[56:59]
v_mov_b32 v140, v237
v_mov_b32 v141, v238
v_mov_b32 v142, v239
v_mov_b32 v143, v240
v_mov_b32 v144, v241
s_nop 1
v_permlane32_swap_b32 v237, v140
v_permlane32_swap_b32 v238, v141
v_permlane32_swap_b32 v239, v142
v_permlane32_swap_b32 v240, v143
v_permlane32_swap_b32 v241, v144
s_nop 1
v_add_f32 v237, v237, v140
v_add_f32 v238, v238, v141
v_add_f32 v239, v239, v142
v_add_f32 v240, v240, v143
v_add_f32 v241, v241, v144
v_mov_b32 v140, v237
v_mov_b32 v141, v238
v_mov_b32 v142, v239
v_mov_b32 v143, v240
v_mov_b32 v144, v241
s_nop 1
v_permlane16_swap_b32 v237, v140
v_permlane16_swap_b32 v238, v141
v_permlane16_swap_b32 v239, v142
v_permlane16_swap_b32 v240, v143
v_permlane16_swap_b32 v241, v144
s_nop 1
v_add_f32 v237, v237, v140
v_add_f32 v238, v238, v141
v_add_f32 v239, v239, v142
v_add_f32 v240, v240, v143
v_add_f32 v241, v241, v144
ds_write_b32 v250, v237 offset:0
ds_write_b32 v250, v238 offset:256
ds_write_b32 v250, v239 offset:512
ds_write_b32 v250, v240 offset:768
ds_write_b32 v250, v241 offset:1024
s_waitcnt lgkmcnt(0)
s_barrier
ds_read_b64_tr_b16 v[120:121], v246 offset:24576
ds_read_b64_tr_b16 v[122:123], v246 offset:26624
ds_read_b64_tr_b16 v[124:125], v246 offset:28672
ds_read_b64_tr_b16 v[126:127], v246 offset:30720
ds_read_b64_tr_b16 v[128:129], v246 offset:32768
ds_read_b64_tr_b16 v[130:131], v246 offset:34816
s_waitcnt lgkmcnt(4)
v_mfma_f32_16x16x32_bf16 v[0:3], v[120:123], v[132:135], v[0:3]
ds_read_b64_tr_b16 v[220:221], v246 offset:36864
ds_read_b64_tr_b16 v[222:223], v246 offset:38912
s_waitcnt lgkmcnt(4)
v_mfma_f32_16x16x32_bf16 v[20:23], v[124:127], v[132:135], v[20:23]
ds_read_b128 v[212:215], v248 offset:46080
s_waitcnt lgkmcnt(3)
v_mfma_f32_16x16x32_bf16 v[40:43], v[128:131], v[132:135], v[40:43]
v_mfma_f32_16x16x32_bf16 v[4:7], v[120:123], v[136:139], v[4:7]
ds_read_b64_tr_b16 v[224:225], v246 offset:40960
ds_read_b64_tr_b16 v[226:227], v246 offset:43008
v_mfma_f32_16x16x32_bf16 v[24:27], v[124:127], v[136:139], v[24:27]
ds_read_b128 v[216:219], v248 offset:47104
v_mfma_f32_16x16x32_bf16 v[44:47], v[128:131], v[136:139], v[44:47]
v_mfma_f32_16x16x32_bf16 v[8:11], v[120:123], v[200:203], v[8:11]
ds_read_b64_tr_b16 v[228:229], v246 offset:45056
ds_read_b64_tr_b16 v[230:231], v246 offset:47104
v_mfma_f32_16x16x32_bf16 v[28:31], v[124:127], v[200:203], v[28:31]
ds_read_b128 v[132:135], v248 offset:48128
v_mfma_f32_16x16x32_bf16 v[48:51], v[128:131], v[200:203], v[48:51]
v_mfma_f32_16x16x32_bf16 v[12:15], v[120:123], v[204:207], v[12:15]
v_mfma_f32_16x16x32_bf16 v[32:35], v[124:127], v[204:207], v[32:35]
ds_read_b128 v[136:139], v248 offset:49152
v_mfma_f32_16x16x32_bf16 v[52:55], v[128:131], v[204:207], v[52:55]
v_mfma_f32_16x16x32_bf16 v[16:19], v[120:123], v[208:211], v[16:19]
v_mfma_f32_16x16x32_bf16 v[36:39], v[124:127], v[208:211], v[36:39]
ds_read_b128 v[200:203], v248 offset:50176
v_mfma_f32_16x16x32_bf16 v[56:59], v[128:131], v[208:211], v[56:59]
s_waitcnt lgkmcnt(0)
s_barrier
v_mfma_f32_16x16x32_bf16 v[0:3], v[220:223], v[212:215], v[0:3]
ds_read_b64_tr_b16 v[120:121], v253 offset:0
ds_read_b64_tr_b16 v[122:123], v253 offset:2048
v_mfma_f32_16x16x32_bf16 v[20:23], v[224:227], v[212:215], v[20:23]
ds_read_b128 v[204:207], v252 offset:10240
v_mfma_f32_16x16x32_bf16 v[40:43], v[228:231], v[212:215], v[40:43]
v_mfma_f32_16x16x32_bf16 v[4:7], v[220:223], v[216:219], v[4:7]
ds_read_b64_tr_b16 v[124:125], v253 offset:4096
ds_read_b64_tr_b16 v[126:127], v253 offset:6144
v_mfma_f32_16x16x32_bf16 v[24:27], v[224:227], v[216:219], v[24:27]
ds_read_b128 v[208:211], v252 offset:12288
v_mfma_f32_16x16x32_bf16 v[44:47], v[228:231], v[216:219], v[44:47]
v_mfma_f32_16x16x32_bf16 v[8:11], v[220:223], v[132:135], v[8:11]
ds_read_b64_tr_b16 v[128:129], v253 offset:8192
ds_read_b64_tr_b16 v[130:131], v253 offset:10240
v_mfma_f32_16x16x32_bf16 v[28:31], v[224:227], v[132:135], v[28:31]
ds_read_b128 v[212:215], v252 offset:14336
v_mfma_f32_16x16x32_bf16 v[48:51], v[228:231], v[132:135], v[48:51]
v_mfma_f32_16x16x32_bf16 v[12:15], v[220:223], v[136:139], v[12:15]
v_mfma_f32_16x16x32_bf16 v[32:35], v[224:227], v[136:139], v[32:35]
ds_read_b128 v[216:219], v252 offset:16384
v_mfma_f32_16x16x32_bf16 v[52:55], v[228:231], v[136:139], v[52:55]
v_mfma_f32_16x16x32_bf16 v[16:19], v[220:223], v[200:203], v[16:19]
v_mfma_f32_16x16x32_bf16 v[36:39], v[224:227], v[200:203], v[36:39]
ds_read_b128 v[132:135], v252 offset:18432
v_mfma_f32_16x16x32_bf16 v[56:59], v[228:231], v[200:203], v[56:59]
v_and_b32 v242, -16, v250
ds_read_b128 v[140:143], v242 offset:0
ds_read_b128 v[144:147], v242 offset:256
ds_read_b128 v[148:151], v242 offset:512
ds_read_b128 v[152:155], v242 offset:768
s_waitcnt lgkmcnt(14)
ds_read_b128 v[156:159], v242 offset:1024
s_waitcnt lgkmcnt(4)
v_add_f32 v140, v140, v141
v_add_f32 v142, v142, v143
v_add_f32 v140, v140, v142
v_rcp_f32 v237, v140
s_waitcnt lgkmcnt(3)
v_add_f32 v144, v144, v145
v_add_f32 v146, v146, v147
v_add_f32 v144, v144, v146
v_rcp_f32 v238, v144
s_waitcnt lgkmcnt(2)
v_add_f32 v148, v148, v149
v_add_f32 v150, v150, v151
v_add_f32 v148, v148, v150
v_rcp_f32 v239, v148
s_waitcnt lgkmcnt(1)
v_add_f32 v152, v152, v153
v_add_f32 v154, v154, v155
v_add_f32 v152, v152, v154
v_rcp_f32 v240, v152
s_waitcnt lgkmcnt(0)
v_add_f32 v156, v156, v157
v_add_f32 v158, v158, v159
v_add_f32 v156, v156, v158
v_rcp_f32 v241, v156
s_nop 7
v_mfma_f32_16x16x32_bf16 v[60:63], v[120:123], v[204:207], v[60:63]
v_mul_f32 v0, v0, v237
v_mul_f32 v1, v1, v237
ds_read_b64_tr_b16 v[220:221], v253 offset:12288
ds_read_b64_tr_b16 v[222:223], v253 offset:14336
v_mfma_f32_16x16x32_bf16 v[80:83], v[124:127], v[204:207], v[80:83]
v_mul_f32 v2, v2, v237
v_mul_f32 v3, v3, v237
ds_read_b128 v[136:139], v251 offset:40960
v_mfma_f32_16x16x32_bf16 v[100:103], v[128:131], v[204:207], v[100:103]
v_cvt_pk_bf16_f32 v170, v0, v1
v_mfma_f32_16x16x32_bf16 v[64:67], v[120:123], v[208:211], v[64:67]
v_cvt_pk_bf16_f32 v171, v2, v3
ds_write_b64 v249, v[170:171] offset:30720
ds_read_b64_tr_b16 v[224:225], v253 offset:16384
ds_read_b64_tr_b16 v[226:227], v253 offset:18432
v_mfma_f32_16x16x32_bf16 v[84:87], v[124:127], v[208:211], v[84:87]
v_mul_f32 v4, v4, v238
ds_read_b128 v[200:203], v251 offset:43008
v_mfma_f32_16x16x32_bf16 v[104:107], v[128:131], v[208:211], v[104:107]
v_mul_f32 v5, v5, v238
v_mul_f32 v6, v6, v238
v_mfma_f32_16x16x32_bf16 v[68:71], v[120:123], v[212:215], v[68:71]
v_mul_f32 v7, v7, v238
ds_read_b64_tr_b16 v[228:229], v253 offset:20480
ds_read_b64_tr_b16 v[230:231], v253 offset:22528
v_mfma_f32_16x16x32_bf16 v[88:91], v[124:127], v[212:215], v[88:91]
v_cvt_pk_bf16_f32 v172, v4, v5
v_cvt_pk_bf16_f32 v173, v6, v7
ds_read_b128 v[204:207], v251 offset:45056
v_mfma_f32_16x16x32_bf16 v[108:111], v[128:131], v[212:215], v[108:111]
ds_write_b64 v249, v[172:173] offset:31744
v_mfma_f32_16x16x32_bf16 v[72:75], v[120:123], v[216:219], v[72:75]
v_mul_f32 v8, v8, v239
v_mul_f32 v9, v9, v239
v_mfma_f32_16x16x32_bf16 v[92:95], v[124:127], v[216:219], v[92:95]
v_mul_f32 v10, v10, v239
v_mul_f32 v11, v11, v239
ds_read_b128 v[208:211], v251 offset:47104
v_mfma_f32_16x16x32_bf16 v[112:115], v[128:131], v[216:219], v[112:115]
v_cvt_pk_bf16_f32 v174, v8, v9
v_mfma_f32_16x16x32_bf16 v[76:79], v[120:123], v[132:135], v[76:79]
v_cvt_pk_bf16_f32 v175, v10, v11
ds_write_b64 v249, v[174:175] offset:32768
v_mfma_f32_16x16x32_bf16 v[96:99], v[124:127], v[132:135], v[96:99]
v_mul_f32 v12, v12, v240
ds_read_b128 v[212:215], v251 offset:49152
v_mfma_f32_16x16x32_bf16 v[116:119], v[128:131], v[132:135], v[116:119]
v_mul_f32 v13, v13, v240
v_mul_f32 v14, v14, v240
s_waitcnt lgkmcnt(4)
v_mfma_f32_16x16x32_bf16 v[60:63], v[220:223], v[136:139], v[60:63]
v_mul_f32 v15, v15, v240
ds_read_b64_tr_b16 v[120:121], v253 offset:24576
ds_read_b64_tr_b16 v[122:123], v253 offset:26624
v_mfma_f32_16x16x32_bf16 v[80:83], v[224:227], v[136:139], v[80:83]
v_cvt_pk_bf16_f32 v176, v12, v13
v_cvt_pk_bf16_f32 v177, v14, v15
ds_read_b128 v[216:219], v252 offset:40960
v_mfma_f32_16x16x32_bf16 v[100:103], v[228:231], v[136:139], v[100:103]
ds_write_b64 v249, v[176:177] offset:33792
v_mfma_f32_16x16x32_bf16 v[64:67], v[220:223], v[200:203], v[64:67]
v_mul_f32 v16, v16, v241
v_mul_f32 v17, v17, v241
ds_read_b64_tr_b16 v[124:125], v253 offset:28672
ds_read_b64_tr_b16 v[126:127], v253 offset:30720
v_mfma_f32_16x16x32_bf16 v[84:87], v[224:227], v[200:203], v[84:87]
v_mul_f32 v18, v18, v241
v_mul_f32 v19, v19, v241
ds_read_b128 v[132:135], v252 offset:43008
v_mfma_f32_16x16x32_bf16 v[104:107], v[228:231], v[200:203], v[104:107]
v_cvt_pk_bf16_f32 v178, v16, v17
v_mfma_f32_16x16x32_bf16 v[68:71], v[220:223], v[204:207], v[68:71]
v_cvt_pk_bf16_f32 v179, v18, v19
ds_write_b64 v249, v[178:179] offset:34816
ds_read_b64_tr_b16 v[128:129], v253 offset:32768
ds_read_b64_tr_b16 v[130:131], v253 offset:34816
v_mfma_f32_16x16x32_bf16 v[88:91], v[224:227], v[204:207], v[88:91]
v_mul_f32 v20, v20, v237
ds_read_b128 v[136:139], v252 offset:45056
v_mfma_f32_16x16x32_bf16 v[108:111], v[228:231], v[204:207], v[108:111]
v_mul_f32 v21, v21, v237
v_mul_f32 v22, v22, v237
s_waitcnt lgkmcnt(11)
v_mfma_f32_16x16x32_bf16 v[72:75], v[220:223], v[208:211], v[72:75]
v_mul_f32 v23, v23, v237
v_mfma_f32_16x16x32_bf16 v[92:95], v[224:227], v[208:211], v[92:95]
v_cvt_pk_bf16_f32 v180, v20, v21
v_cvt_pk_bf16_f32 v181, v22, v23
ds_read_b128 v[200:203], v252 offset:47104
v_mfma_f32_16x16x32_bf16 v[112:115], v[228:231], v[208:211], v[112:115]
ds_write_b64 v249, v[180:181] offset:40960
v_mfma_f32_16x16x32_bf16 v[76:79], v[220:223], v[212:215], v[76:79]
v_mul_f32 v24, v24, v238
v_mul_f32 v25, v25, v238
v_mfma_f32_16x16x32_bf16 v[96:99], v[224:227], v[212:215], v[96:99]
v_mul_f32 v26, v26, v238
v_mul_f32 v27, v27, v238
ds_read_b128 v[204:207], v252 offset:49152
v_mfma_f32_16x16x32_bf16 v[116:119], v[228:231], v[212:215], v[116:119]
v_cvt_pk_bf16_f32 v182, v24, v25
s_waitcnt lgkmcnt(3)
v_mfma_f32_16x16x32_bf16 v[60:63], v[120:123], v[216:219], v[60:63]
v_cvt_pk_bf16_f32 v183, v26, v27
ds_write_b64 v249, v[182:183] offset:41984
ds_read_b64_tr_b16 v[220:221], v253 offset:36864
ds_read_b64_tr_b16 v[222:223], v253 offset:38912
v_mfma_f32_16x16x32_bf16 v[80:83], v[124:127], v[216:219], v[80:83]
v_mul_f32 v28, v28, v239
ds_read_b128 v[208:211], v251 offset:0
v_mfma_f32_16x16x32_bf16 v[100:103], v[128:131], v[216:219], v[100:103]
v_mul_f32 v29, v29, v239
v_mul_f32 v30, v30, v239
v_mfma_f32_16x16x32_bf16 v[64:67], v[120:123], v[132:135], v[64:67]
v_mul_f32 v31, v31, v239
ds_read_b64_tr_b16 v[224:225], v253 offset:40960
ds_read_b64_tr_b16 v[226:227], v253 offset:43008
v_mfma_f32_16x16x32_bf16 v[84:87], v[124:127], v[132:135], v[84:87]
v_cvt_pk_bf16_f32 v184, v28, v29
v_cvt_pk_bf16_f32 v185, v30, v31
ds_read_b128 v[212:215], v251 offset:2048
v_mfma_f32_16x16x32_bf16 v[104:107], v[128:131], v[132:135], v[104:107]
ds_write_b64 v249, v[184:185] offset:43008
v_mfma_f32_16x16x32_bf16 v[68:71], v[120:123], v[136:139], v[68:71]
v_mul_f32 v32, v32, v240
v_mul_f32 v33, v33, v240
ds_read_b64_tr_b16 v[228:229], v253 offset:45056
ds_read_b64_tr_b16 v[230:231], v253 offset:47104
v_mfma_f32_16x16x32_bf16 v[88:91], v[124:127], v[136:139], v[88:91]
v_mul_f32 v34, v34, v240
v_mul_f32 v35, v35, v240
ds_read_b128 v[216:219], v251 offset:4096
v_mfma_f32_16x16x32_bf16 v[108:111], v[128:131], v[136:139], v[108:111]
v_cvt_pk_bf16_f32 v186, v32, v33
s_waitcnt lgkmcnt(11)
v_mfma_f32_16x16x32_bf16 v[72:75], v[120:123], v[200:203], v[72:75]
v_cvt_pk_bf16_f32 v187, v34, v35
ds_write_b64 v249, v[186:187] offset:44032
v_mfma_f32_16x16x32_bf16 v[92:95], v[124:127], v[200:203], v[92:95]
v_mul_f32 v36, v36, v241
ds_read_b128 v[132:135], v251 offset:6144
v_mfma_f32_16x16x32_bf16 v[112:115], v[128:131], v[200:203], v[112:115]
v_mul_f32 v37, v37, v241
v_mul_f32 v38, v38, v241
v_mfma_f32_16x16x32_bf16 v[76:79], v[120:123], v[204:207], v[76:79]
v_mul_f32 v39, v39, v241
v_mfma_f32_16x16x32_bf16 v[96:99], v[124:127], v[204:207], v[96:99]
v_cvt_pk_bf16_f32 v188, v36, v37
v_cvt_pk_bf16_f32 v189, v38, v39
ds_read_b128 v[136:139], v251 offset:8192
v_mfma_f32_16x16x32_bf16 v[116:119], v[128:131], v[204:207], v[116:119]
ds_write_b64 v249, v[188:189] offset:45056
s_waitcnt lgkmcnt(0)
s_barrier
s_nop 7
v_mfma_f32_16x16x32_bf16 v[60:63], v[220:223], v[208:211], v[60:63]
v_mul_f32 v40, v40, v237
v_mul_f32 v41, v41, v237
v_mul_f32 v42, v42, v237
ds_read_b64_tr_b16 v[120:121], v253 offset:49152
ds_read_b64_tr_b16 v[122:123], v253 offset:51200
v_mfma_f32_16x16x32_bf16 v[80:83], v[224:227], v[208:211], v[80:83]
v_mul_f32 v43, v43, v237
v_cvt_pk_bf16_f32 v190, v40, v41
ds_read_b128 v[200:203], v252 offset:0
v_mfma_f32_16x16x32_bf16 v[100:103], v[228:231], v[208:211], v[100:103]
v_cvt_pk_bf16_f32 v191, v42, v43
ds_write_b64 v249, v[190:191] offset:51200
v_mfma_f32_16x16x32_bf16 v[64:67], v[220:223], v[212:215], v[64:67]
v_mul_f32 v44, v44, v238
v_mul_f32 v45, v45, v238
v_mul_f32 v46, v46, v238
ds_read_b64_tr_b16 v[124:125], v253 offset:53248
ds_read_b64_tr_b16 v[126:127], v253 offset:55296
v_mfma_f32_16x16x32_bf16 v[84:87], v[224:227], v[212:215], v[84:87]
v_mul_f32 v47, v47, v238
v_cvt_pk_bf16_f32 v192, v44, v45
ds_read_b128 v[204:207], v252 offset:2048
v_mfma_f32_16x16x32_bf16 v[104:107], v[228:231], v[212:215], v[104:107]
v_cvt_pk_bf16_f32 v193, v46, v47
ds_write_b64 v249, v[192:193] offset:52224
v_mfma_f32_16x16x32_bf16 v[68:71], v[220:223], v[216:219], v[68:71]
v_mul_f32 v48, v48, v239
v_mul_f32 v49, v49, v239
v_mul_f32 v50, v50, v239
ds_read_b64_tr_b16 v[128:129], v253 offset:57344
ds_read_b64_tr_b16 v[130:131], v253 offset:59392
v_mfma_f32_16x16x32_bf16 v[88:91], v[224:227], v[216:219], v[88:91]
v_mul_f32 v51, v51, v239
v_cvt_pk_bf16_f32 v194, v48, v49
ds_read_b128 v[208:211], v252 offset:4096
v_mfma_f32_16x16x32_bf16 v[108:111], v[228:231], v[216:219], v[108:111]
v_cvt_pk_bf16_f32 v195, v50, v51
ds_write_b64 v249, v[194:195] offset:53248
v_mfma_f32_16x16x32_bf16 v[72:75], v[220:223], v[132:135], v[72:75]
v_mul_f32 v52, v52, v240
v_mul_f32 v53, v53, v240
v_mul_f32 v54, v54, v240
v_mfma_f32_16x16x32_bf16 v[92:95], v[224:227], v[132:135], v[92:95]
v_mul_f32 v55, v55, v240
v_cvt_pk_bf16_f32 v196, v52, v53
ds_read_b128 v[212:215], v252 offset:6144
v_mfma_f32_16x16x32_bf16 v[112:115], v[228:231], v[132:135], v[112:115]
v_cvt_pk_bf16_f32 v197, v54, v55
ds_write_b64 v249, v[196:197] offset:54272
v_mfma_f32_16x16x32_bf16 v[76:79], v[220:223], v[136:139], v[76:79]
v_mul_f32 v56, v56, v241
v_mul_f32 v57, v57, v241
v_mul_f32 v58, v58, v241
v_mfma_f32_16x16x32_bf16 v[96:99], v[224:227], v[136:139], v[96:99]
v_mul_f32 v59, v59, v241
v_cvt_pk_bf16_f32 v198, v56, v57
ds_read_b128 v[216:219], v252 offset:8192
v_mfma_f32_16x16x32_bf16 v[116:119], v[228:231], v[136:139], v[116:119]
v_cvt_pk_bf16_f32 v199, v58, v59
s_waitcnt lgkmcnt(14)
ds_write_b64 v249, v[198:199] offset:55296
s_waitcnt lgkmcnt(1)
s_waitcnt lgkmcnt(0)
s_barrier
v_mfma_f32_16x16x32_bf16 v[60:63], v[120:123], v[200:203], v[60:63]
v_mfma_f32_16x16x32_bf16 v[80:83], v[124:127], v[200:203], v[80:83]
v_mfma_f32_16x16x32_bf16 v[100:103], v[128:131], v[200:203], v[100:103]
v_mfma_f32_16x16x32_bf16 v[64:67], v[120:123], v[204:207], v[64:67]
v_mfma_f32_16x16x32_bf16 v[84:87], v[124:127], v[204:207], v[84:87]
v_mfma_f32_16x16x32_bf16 v[104:107], v[128:131], v[204:207], v[104:107]
v_mfma_f32_16x16x32_bf16 v[68:71], v[120:123], v[208:211], v[68:71]
v_mfma_f32_16x16x32_bf16 v[88:91], v[124:127], v[208:211], v[88:91]
v_mfma_f32_16x16x32_bf16 v[108:111], v[128:131], v[208:211], v[108:111]
v_mfma_f32_16x16x32_bf16 v[72:75], v[120:123], v[212:215], v[72:75]
v_mfma_f32_16x16x32_bf16 v[92:95], v[124:127], v[212:215], v[92:95]
v_mfma_f32_16x16x32_bf16 v[112:115], v[128:131], v[212:215], v[112:115]
v_cvt_pk_bf16_f32 v140, v60, v61
v_cvt_pk_bf16_f32 v141, v62, v63
ds_write_b64 v249, v[140:141] offset:0
v_cvt_pk_bf16_f32 v150, v80, v81
v_cvt_pk_bf16_f32 v151, v82, v83
ds_write_b64 v249, v[150:151] offset:10240
v_cvt_pk_bf16_f32 v160, v100, v101
v_cvt_pk_bf16_f32 v161, v102, v103
ds_write_b64 v249, v[160:161] offset:20480
v_mfma_f32_16x16x32_bf16 v[76:79], v[120:123], v[216:219], v[76:79]
v_mfma_f32_16x16x32_bf16 v[96:99], v[124:127], v[216:219], v[96:99]
v_mfma_f32_16x16x32_bf16 v[116:119], v[128:131], v[216:219], v[116:119]
v_cvt_pk_bf16_f32 v142, v64, v65
v_cvt_pk_bf16_f32 v143, v66, v67
ds_write_b64 v249, v[142:143] offset:1024
v_cvt_pk_bf16_f32 v152, v84, v85
v_cvt_pk_bf16_f32 v153, v86, v87
ds_write_b64 v249, v[152:153] offset:11264
v_cvt_pk_bf16_f32 v162, v104, v105
v_cvt_pk_bf16_f32 v163, v106, v107
ds_write_b64 v249, v[162:163] offset:21504
v_cvt_pk_bf16_f32 v144, v68, v69
v_cvt_pk_bf16_f32 v145, v70, v71
ds_write_b64 v249, v[144:145] offset:2048
v_cvt_pk_bf16_f32 v154, v88, v89
v_cvt_pk_bf16_f32 v155, v90, v91
ds_write_b64 v249, v[154:155] offset:12288
v_cvt_pk_bf16_f32 v164, v108, v109
v_cvt_pk_bf16_f32 v165, v110, v111
ds_write_b64 v249, v[164:165] offset:22528
v_cvt_pk_bf16_f32 v146, v72, v73
v_cvt_pk_bf16_f32 v147, v74, v75
ds_write_b64 v249, v[146:147] offset:3072
v_cvt_pk_bf16_f32 v156, v92, v93
v_cvt_pk_bf16_f32 v157, v94, v95
ds_write_b64 v249, v[156:157] offset:13312
v_cvt_pk_bf16_f32 v166, v112, v113
v_cvt_pk_bf16_f32 v167, v114, v115
ds_write_b64 v249, v[166:167] offset:23552
v_cvt_pk_bf16_f32 v148, v76, v77
v_cvt_pk_bf16_f32 v149, v78, v79
ds_write_b64 v249, v[148:149] offset:4096
v_cvt_pk_bf16_f32 v158, v96, v97
v_cvt_pk_bf16_f32 v159, v98, v99
ds_write_b64 v249, v[158:159] offset:14336
v_cvt_pk_bf16_f32 v168, v116, v117
v_cvt_pk_bf16_f32 v169, v118, v119
ds_write_b64 v249, v[168:169] offset:24576
s_waitcnt lgkmcnt(0)
s_barrier
ds_read_b128 v[220:223], v247 offset:0
ds_read_b128 v[0:3], v248 offset:0
ds_read_b128 v[4:7], v248 offset:1024
ds_read_b128 v[8:11], v248 offset:2048
ds_read_b128 v[12:15], v248 offset:3072
ds_read_b128 v[16:19], v248 offset:4096
ds_read_b128 v[224:227], v254 offset:0
ds_read_b128 v[20:23], v248 offset:5120
ds_read_b128 v[24:27], v248 offset:6144
ds_read_b128 v[28:31], v248 offset:7168
ds_read_b128 v[32:35], v248 offset:8192
ds_read_b128 v[36:39], v248 offset:9216
ds_read_b128 v[228:231], v247 offset:8192
ds_read_b128 v[242:245], v254 offset:8192
v_mov_b32 v232, 0xff800000
v_mov_b32 v233, 0xff800000
v_mov_b32 v234, 0xff800000
v_mov_b32 v235, 0xff800000
v_mov_b32 v236, 0xff800000
s_waitcnt lgkmcnt(12)
v_mfma_f32_16x16x32_bf16 v[200:203], v[220:223], v[0:3], 0
s_waitcnt lgkmcnt(11)
v_mfma_f32_16x16x32_bf16 v[204:207], v[220:223], v[4:7], 0
s_waitcnt lgkmcnt(10)
v_mfma_f32_16x16x32_bf16 v[208:211], v[220:223], v[8:11], 0
s_waitcnt lgkmcnt(9)
v_mfma_f32_16x16x32_bf16 v[212:215], v[220:223], v[12:15], 0
s_waitcnt lgkmcnt(8)
v_mfma_f32_16x16x32_bf16 v[216:219], v[220:223], v[16:19], 0
ds_read_b128 v[220:223], v247 offset:16384
ds_read_b128 v[40:43], v248 offset:10240
ds_read_b128 v[44:47], v248 offset:11264
ds_read_b128 v[48:51], v248 offset:12288
ds_read_b128 v[52:55], v248 offset:13312
ds_read_b128 v[56:59], v248 offset:14336
s_waitcnt lgkmcnt(12)
v_mfma_f32_16x16x32_bf16 v[200:203], v[224:227], v[20:23], v[200:203]
s_waitcnt lgkmcnt(11)
v_mfma_f32_16x16x32_bf16 v[204:207], v[224:227], v[24:27], v[204:207]
s_waitcnt lgkmcnt(10)
v_mfma_f32_16x16x32_bf16 v[208:211], v[224:227], v[28:31], v[208:211]
s_waitcnt lgkmcnt(9)
v_mfma_f32_16x16x32_bf16 v[212:215], v[224:227], v[32:35], v[212:215]
s_waitcnt lgkmcnt(8)
v_mfma_f32_16x16x32_bf16 v[216:219], v[224:227], v[36:39], v[216:219]
ds_read_b128 v[224:227], v254 offset:16384
ds_read_b128 v[60:63], v248 offset:15360
ds_read_b128 v[64:67], v248 offset:16384
ds_read_b128 v[68:71], v248 offset:17408
ds_read_b128 v[72:75], v248 offset:18432
ds_read_b128 v[76:79], v248 offset:19456
s_waitcnt lgkmcnt(10)
v_mfma_f32_16x16x32_bf16 v[200:203], v[228:231], v[40:43], v[200:203]
s_waitcnt lgkmcnt(9)
v_mfma_f32_16x16x32_bf16 v[204:207], v[228:231], v[44:47], v[204:207]
s_waitcnt lgkmcnt(8)
v_mfma_f32_16x16x32_bf16 v[208:211], v[228:231], v[48:51], v[208:211]
s_waitcnt lgkmcnt(7)
v_mfma_f32_16x16x32_bf16 v[212:215], v[228:231], v[52:55], v[212:215]
s_waitcnt lgkmcnt(6)
v_mfma_f32_16x16x32_bf16 v[216:219], v[228:231], v[56:59], v[216:219]
ds_read_b128 v[80:83], v248 offset:20480
ds_read_b128 v[84:87], v248 offset:21504
ds_read_b128 v[88:91], v248 offset:22528
ds_read_b128 v[92:95], v248 offset:23552
ds_read_b128 v[96:99], v248 offset:24576
s_waitcnt lgkmcnt(9)
v_mfma_f32_16x16x32_bf16 v[200:203], v[242:245], v[60:63], v[200:203]
s_waitcnt lgkmcnt(8)
v_mfma_f32_16x16x32_bf16 v[204:207], v[242:245], v[64:67], v[204:207]
s_waitcnt lgkmcnt(7)
v_mfma_f32_16x16x32_bf16 v[208:211], v[242:245], v[68:71], v[208:211]
s_waitcnt lgkmcnt(6)
v_mfma_f32_16x16x32_bf16 v[212:215], v[242:245], v[72:75], v[212:215]
s_waitcnt lgkmcnt(5)
v_mfma_f32_16x16x32_bf16 v[216:219], v[242:245], v[76:79], v[216:219]
ds_read_b128 v[100:103], v248 offset:25600
ds_read_b128 v[104:107], v248 offset:26624
ds_read_b128 v[108:111], v248 offset:27648
ds_read_b128 v[112:115], v248 offset:28672
ds_read_b128 v[116:119], v248 offset:29696
s_waitcnt lgkmcnt(9)
v_mfma_f32_16x16x32_bf16 v[200:203], v[220:223], v[80:83], v[200:203]
s_waitcnt lgkmcnt(8)
v_mfma_f32_16x16x32_bf16 v[204:207], v[220:223], v[84:87], v[204:207]
s_waitcnt lgkmcnt(7)
v_mfma_f32_16x16x32_bf16 v[208:211], v[220:223], v[88:91], v[208:211]
s_waitcnt lgkmcnt(6)
v_mfma_f32_16x16x32_bf16 v[212:215], v[220:223], v[92:95], v[212:215]
s_waitcnt lgkmcnt(5)
v_mfma_f32_16x16x32_bf16 v[216:219], v[220:223], v[96:99], v[216:219]
s_waitcnt lgkmcnt(4)
v_mfma_f32_16x16x32_bf16 v[200:203], v[224:227], v[100:103], v[200:203]
s_waitcnt lgkmcnt(3)
v_mfma_f32_16x16x32_bf16 v[204:207], v[224:227], v[104:107], v[204:207]
s_waitcnt lgkmcnt(2)
v_mfma_f32_16x16x32_bf16 v[208:211], v[224:227], v[108:111], v[208:211]
s_waitcnt lgkmcnt(1)
v_mfma_f32_16x16x32_bf16 v[212:215], v[224:227], v[112:115], v[212:215]
s_waitcnt lgkmcnt(0)
v_mfma_f32_16x16x32_bf16 v[216:219], v[224:227], v[116:119], v[216:219]
s_nop 4
v_max3_f32 v232, v232, v200, v201
v_cvt_pk_bf16_f32 v120, v200, v201
v_max3_f32 v232, v232, v202, v203
v_cvt_pk_bf16_f32 v121, v202, v203
v_max3_f32 v233, v233, v204, v205
v_cvt_pk_bf16_f32 v124, v204, v205
v_max3_f32 v233, v233, v206, v207
v_cvt_pk_bf16_f32 v125, v206, v207
v_max3_f32 v234, v234, v208, v209
v_cvt_pk_bf16_f32 v128, v208, v209
v_max3_f32 v234, v234, v210, v211
v_cvt_pk_bf16_f32 v129, v210, v211
v_max3_f32 v235, v235, v212, v213
v_cvt_pk_bf16_f32 v132, v212, v213
v_max3_f32 v235, v235, v214, v215
v_cvt_pk_bf16_f32 v133, v214, v215
v_max3_f32 v236, v236, v216, v217
v_cvt_pk_bf16_f32 v136, v216, v217
v_max3_f32 v236, v236, v218, v219
v_cvt_pk_bf16_f32 v137, v218, v219
s_barrier
ds_read_b128 v[220:223], v247 offset:24576
ds_read_b128 v[224:227], v254 offset:24576
ds_read_b128 v[228:231], v247 offset:32768
ds_read_b128 v[242:245], v254 offset:32768
s_waitcnt lgkmcnt(3)
v_mfma_f32_16x16x32_bf16 v[200:203], v[220:223], v[0:3], 0
v_mfma_f32_16x16x32_bf16 v[204:207], v[220:223], v[4:7], 0
v_mfma_f32_16x16x32_bf16 v[208:211], v[220:223], v[8:11], 0
v_mfma_f32_16x16x32_bf16 v[212:215], v[220:223], v[12:15], 0
v_mfma_f32_16x16x32_bf16 v[216:219], v[220:223], v[16:19], 0
ds_read_b128 v[220:223], v247 offset:40960
s_waitcnt lgkmcnt(3)
v_mfma_f32_16x16x32_bf16 v[200:203], v[224:227], v[20:23], v[200:203]
v_mfma_f32_16x16x32_bf16 v[204:207], v[224:227], v[24:27], v[204:207]
v_mfma_f32_16x16x32_bf16 v[208:211], v[224:227], v[28:31], v[208:211]
v_mfma_f32_16x16x32_bf16 v[212:215], v[224:227], v[32:35], v[212:215]
v_mfma_f32_16x16x32_bf16 v[216:219], v[224:227], v[36:39], v[216:219]
ds_read_b128 v[224:227], v254 offset:40960
s_waitcnt lgkmcnt(3)
v_mfma_f32_16x16x32_bf16 v[200:203], v[228:231], v[40:43], v[200:203]
v_mfma_f32_16x16x32_bf16 v[204:207], v[228:231], v[44:47], v[204:207]
v_mfma_f32_16x16x32_bf16 v[208:211], v[228:231], v[48:51], v[208:211]
v_mfma_f32_16x16x32_bf16 v[212:215], v[228:231], v[52:55], v[212:215]
v_mfma_f32_16x16x32_bf16 v[216:219], v[228:231], v[56:59], v[216:219]
s_waitcnt lgkmcnt(0)
s_barrier
v_mfma_f32_16x16x32_bf16 v[200:203], v[242:245], v[60:63], v[200:203]
v_mfma_f32_16x16x32_bf16 v[204:207], v[242:245], v[64:67], v[204:207]
v_mfma_f32_16x16x32_bf16 v[208:211], v[242:245], v[68:71], v[208:211]
v_mfma_f32_16x16x32_bf16 v[212:215], v[242:245], v[72:75], v[212:215]
v_mfma_f32_16x16x32_bf16 v[216:219], v[242:245], v[76:79], v[216:219]
v_mfma_f32_16x16x32_bf16 v[200:203], v[220:223], v[80:83], v[200:203]
v_mfma_f32_16x16x32_bf16 v[204:207], v[220:223], v[84:87], v[204:207]
v_mfma_f32_16x16x32_bf16 v[208:211], v[220:223], v[88:91], v[208:211]
v_mfma_f32_16x16x32_bf16 v[212:215], v[220:223], v[92:95], v[212:215]
v_mfma_f32_16x16x32_bf16 v[216:219], v[220:223], v[96:99], v[216:219]
v_mfma_f32_16x16x32_bf16 v[200:203], v[224:227], v[100:103], v[200:203]
v_mfma_f32_16x16x32_bf16 v[204:207], v[224:227], v[104:107], v[204:207]
v_mfma_f32_16x16x32_bf16 v[208:211], v[224:227], v[108:111], v[208:211]
v_mfma_f32_16x16x32_bf16 v[212:215], v[224:227], v[112:115], v[212:215]
v_mfma_f32_16x16x32_bf16 v[216:219], v[224:227], v[116:119], v[216:219]
s_nop 4
v_max3_f32 v232, v232, v200, v201
v_cvt_pk_bf16_f32 v122, v200, v201
v_max3_f32 v232, v232, v202, v203
v_cvt_pk_bf16_f32 v123, v202, v203
v_max3_f32 v233, v233, v204, v205
v_cvt_pk_bf16_f32 v126, v204, v205
v_max3_f32 v233, v233, v206, v207
v_cvt_pk_bf16_f32 v127, v206, v207
v_max3_f32 v234, v234, v208, v209
v_cvt_pk_bf16_f32 v130, v208, v209
v_max3_f32 v234, v234, v210, v211
v_cvt_pk_bf16_f32 v131, v210, v211
v_max3_f32 v235, v235, v212, v213
v_cvt_pk_bf16_f32 v134, v212, v213
v_max3_f32 v235, v235, v214, v215
v_cvt_pk_bf16_f32 v135, v214, v215
v_max3_f32 v236, v236, v216, v217
v_cvt_pk_bf16_f32 v138, v216, v217
v_max3_f32 v236, v236, v218, v219
v_cvt_pk_bf16_f32 v139, v218, v219
s_barrier
s_barrier
ds_read_b128 v[220:223], v247 offset:0
ds_read_b128 v[224:227], v254 offset:0
ds_read_b128 v[228:231], v247 offset:8192
ds_read_b128 v[242:245], v254 offset:8192
s_waitcnt lgkmcnt(3)
v_mfma_f32_16x16x32_bf16 v[200:203], v[220:223], v[0:3], 0
v_mfma_f32_16x16x32_bf16 v[204:207], v[220:223], v[4:7], 0
v_mfma_f32_16x16x32_bf16 v[208:211], v[220:223], v[8:11], 0
v_mfma_f32_16x16x32_bf16 v[212:215], v[220:223], v[12:15], 0
v_mfma_f32_16x16x32_bf16 v[216:219], v[220:223], v[16:19], 0
ds_read_b128 v[220:223], v247 offset:16384
s_waitcnt lgkmcnt(3)
v_mfma_f32_16x16x32_bf16 v[200:203], v[224:227], v[20:23], v[200:203]
v_mfma_f32_16x16x32_bf16 v[204:207], v[224:227], v[24:27], v[204:207]
v_mfma_f32_16x16x32_bf16 v[208:211], v[224:227], v[28:31], v[208:211]
v_mfma_f32_16x16x32_bf16 v[212:215], v[224:227], v[32:35], v[212:215]
v_mfma_f32_16x16x32_bf16 v[216:219], v[224:227], v[36:39], v[216:219]
ds_read_b128 v[224:227], v254 offset:16384
s_waitcnt lgkmcnt(3)
v_mfma_f32_16x16x32_bf16 v[200:203], v[228:231], v[40:43], v[200:203]
v_mfma_f32_16x16x32_bf16 v[204:207], v[228:231], v[44:47], v[204:207]
v_mfma_f32_16x16x32_bf16 v[208:211], v[228:231], v[48:51], v[208:211]
v_mfma_f32_16x16x32_bf16 v[212:215], v[228:231], v[52:55], v[212:215]
v_mfma_f32_16x16x32_bf16 v[216:219], v[228:231], v[56:59], v[216:219]
s_waitcnt lgkmcnt(2)
v_mfma_f32_16x16x32_bf16 v[200:203], v[242:245], v[60:63], v[200:203]
v_mfma_f32_16x16x32_bf16 v[204:207], v[242:245], v[64:67], v[204:207]
v_mfma_f32_16x16x32_bf16 v[208:211], v[242:245], v[68:71], v[208:211]
v_mfma_f32_16x16x32_bf16 v[212:215], v[242:245], v[72:75], v[212:215]
v_mfma_f32_16x16x32_bf16 v[216:219], v[242:245], v[76:79], v[216:219]
s_waitcnt lgkmcnt(1)
v_mfma_f32_16x16x32_bf16 v[200:203], v[220:223], v[80:83], v[200:203]
v_mfma_f32_16x16x32_bf16 v[204:207], v[220:223], v[84:87], v[204:207]
v_mfma_f32_16x16x32_bf16 v[208:211], v[220:223], v[88:91], v[208:211]
v_mfma_f32_16x16x32_bf16 v[212:215], v[220:223], v[92:95], v[212:215]
v_mfma_f32_16x16x32_bf16 v[216:219], v[220:223], v[96:99], v[216:219]
s_waitcnt lgkmcnt(0)
v_mfma_f32_16x16x32_bf16 v[200:203], v[224:227], v[100:103], v[200:203]
v_mfma_f32_16x16x32_bf16 v[204:207], v[224:227], v[104:107], v[204:207]
v_mfma_f32_16x16x32_bf16 v[208:211], v[224:227], v[108:111], v[208:211]
v_mfma_f32_16x16x32_bf16 v[212:215], v[224:227], v[112:115], v[212:215]
v_mfma_f32_16x16x32_bf16 v[216:219], v[224:227], v[116:119], v[216:219]
s_nop 4
v_max3_f32 v232, v232, v200, v201
v_cvt_pk_bf16_f32 v140, v200, v201
v_max3_f32 v232, v232, v202, v203
v_cvt_pk_bf16_f32 v141, v202, v203
v_max3_f32 v233, v233, v204, v205
v_cvt_pk_bf16_f32 v144, v204, v205
v_max3_f32 v233, v233, v206, v207
v_cvt_pk_bf16_f32 v145, v206, v207
v_max3_f32 v234, v234, v208, v209
v_cvt_pk_bf16_f32 v148, v208, v209
v_max3_f32 v234, v234, v210, v211
v_cvt_pk_bf16_f32 v149, v210, v211
v_max3_f32 v235, v235, v212, v213
v_cvt_pk_bf16_f32 v152, v212, v213
v_max3_f32 v235, v235, v214, v215
v_cvt_pk_bf16_f32 v153, v214, v215
v_max3_f32 v236, v236, v216, v217
v_cvt_pk_bf16_f32 v156, v216, v217
v_max3_f32 v236, v236, v218, v219
v_cvt_pk_bf16_f32 v157, v218, v219
s_barrier
ds_read_b128 v[220:223], v247 offset:24576
ds_read_b128 v[224:227], v254 offset:24576
ds_read_b128 v[228:231], v247 offset:32768
ds_read_b128 v[242:245], v254 offset:32768
s_waitcnt lgkmcnt(3)
v_mfma_f32_16x16x32_bf16 v[200:203], v[220:223], v[0:3], 0
v_mfma_f32_16x16x32_bf16 v[204:207], v[220:223], v[4:7], 0
v_mfma_f32_16x16x32_bf16 v[208:211], v[220:223], v[8:11], 0
v_mfma_f32_16x16x32_bf16 v[212:215], v[220:223], v[12:15], 0
v_mfma_f32_16x16x32_bf16 v[216:219], v[220:223], v[16:19], 0
ds_read_b128 v[220:223], v247 offset:40960
s_waitcnt lgkmcnt(3)
v_mfma_f32_16x16x32_bf16 v[200:203], v[224:227], v[20:23], v[200:203]
v_mfma_f32_16x16x32_bf16 v[204:207], v[224:227], v[24:27], v[204:207]
v_mfma_f32_16x16x32_bf16 v[208:211], v[224:227], v[28:31], v[208:211]
v_mfma_f32_16x16x32_bf16 v[212:215], v[224:227], v[32:35], v[212:215]
v_mfma_f32_16x16x32_bf16 v[216:219], v[224:227], v[36:39], v[216:219]
ds_read_b128 v[224:227], v254 offset:40960
s_waitcnt lgkmcnt(3)
v_mfma_f32_16x16x32_bf16 v[200:203], v[228:231], v[40:43], v[200:203]
v_mfma_f32_16x16x32_bf16 v[204:207], v[228:231], v[44:47], v[204:207]
v_mfma_f32_16x16x32_bf16 v[208:211], v[228:231], v[48:51], v[208:211]
v_mfma_f32_16x16x32_bf16 v[212:215], v[228:231], v[52:55], v[212:215]
v_mfma_f32_16x16x32_bf16 v[216:219], v[228:231], v[56:59], v[216:219]
s_waitcnt lgkmcnt(0)
s_barrier
v_mfma_f32_16x16x32_bf16 v[200:203], v[242:245], v[60:63], v[200:203]
v_mfma_f32_16x16x32_bf16 v[204:207], v[242:245], v[64:67], v[204:207]
v_mfma_f32_16x16x32_bf16 v[208:211], v[242:245], v[68:71], v[208:211]
v_mfma_f32_16x16x32_bf16 v[212:215], v[242:245], v[72:75], v[212:215]
v_mfma_f32_16x16x32_bf16 v[216:219], v[242:245], v[76:79], v[216:219]
v_mfma_f32_16x16x32_bf16 v[200:203], v[220:223], v[80:83], v[200:203]
v_mfma_f32_16x16x32_bf16 v[204:207], v[220:223], v[84:87], v[204:207]
v_mfma_f32_16x16x32_bf16 v[208:211], v[220:223], v[88:91], v[208:211]
v_mfma_f32_16x16x32_bf16 v[212:215], v[220:223], v[92:95], v[212:215]
v_mfma_f32_16x16x32_bf16 v[216:219], v[220:223], v[96:99], v[216:219]
v_mfma_f32_16x16x32_bf16 v[200:203], v[224:227], v[100:103], v[200:203]
v_mfma_f32_16x16x32_bf16 v[204:207], v[224:227], v[104:107], v[204:207]
v_mfma_f32_16x16x32_bf16 v[208:211], v[224:227], v[108:111], v[208:211]
v_mfma_f32_16x16x32_bf16 v[212:215], v[224:227], v[112:115], v[212:215]
v_mfma_f32_16x16x32_bf16 v[216:219], v[224:227], v[116:119], v[216:219]
s_nop 4
v_max3_f32 v232, v232, v200, v201
v_cvt_pk_bf16_f32 v142, v200, v201
v_max3_f32 v232, v232, v202, v203
v_cvt_pk_bf16_f32 v143, v202, v203
v_max3_f32 v233, v233, v204, v205
v_cvt_pk_bf16_f32 v146, v204, v205
v_max3_f32 v233, v233, v206, v207
v_cvt_pk_bf16_f32 v147, v206, v207
v_max3_f32 v234, v234, v208, v209
v_cvt_pk_bf16_f32 v150, v208, v209
v_max3_f32 v234, v234, v210, v211
v_cvt_pk_bf16_f32 v151, v210, v211
v_max3_f32 v235, v235, v212, v213
v_cvt_pk_bf16_f32 v154, v212, v213
v_max3_f32 v235, v235, v214, v215
v_cvt_pk_bf16_f32 v155, v214, v215
v_max3_f32 v236, v236, v216, v217
v_cvt_pk_bf16_f32 v158, v216, v217
v_max3_f32 v236, v236, v218, v219
v_cvt_pk_bf16_f32 v159, v218, v219
s_barrier
s_barrier
ds_read_b128 v[220:223], v247 offset:0
ds_read_b128 v[224:227], v254 offset:0
ds_read_b128 v[228:231], v247 offset:8192
ds_read_b128 v[242:245], v254 offset:8192
s_waitcnt lgkmcnt(3)
v_mfma_f32_16x16x32_bf16 v[200:203], v[220:223], v[0:3], 0
v_mfma_f32_16x16x32_bf16 v[204:207], v[220:223], v[4:7], 0
v_mfma_f32_16x16x32_bf16 v[208:211], v[220:223], v[8:11], 0
v_mfma_f32_16x16x32_bf16 v[212:215], v[220:223], v[12:15], 0
v_mfma_f32_16x16x32_bf16 v[216:219], v[220:223], v[16:19], 0
ds_read_b128 v[220:223], v247 offset:16384
s_waitcnt lgkmcnt(3)
v_mfma_f32_16x16x32_bf16 v[200:203], v[224:227], v[20:23], v[200:203]
v_mfma_f32_16x16x32_bf16 v[204:207], v[224:227], v[24:27], v[204:207]
v_mfma_f32_16x16x32_bf16 v[208:211], v[224:227], v[28:31], v[208:211]
v_mfma_f32_16x16x32_bf16 v[212:215], v[224:227], v[32:35], v[212:215]
v_mfma_f32_16x16x32_bf16 v[216:219], v[224:227], v[36:39], v[216:219]
ds_read_b128 v[224:227], v254 offset:16384
s_waitcnt lgkmcnt(3)
v_mfma_f32_16x16x32_bf16 v[200:203], v[228:231], v[40:43], v[200:203]
v_mfma_f32_16x16x32_bf16 v[204:207], v[228:231], v[44:47], v[204:207]
v_mfma_f32_16x16x32_bf16 v[208:211], v[228:231], v[48:51], v[208:211]
v_mfma_f32_16x16x32_bf16 v[212:215], v[228:231], v[52:55], v[212:215]
v_mfma_f32_16x16x32_bf16 v[216:219], v[228:231], v[56:59], v[216:219]
s_waitcnt lgkmcnt(2)
v_mfma_f32_16x16x32_bf16 v[200:203], v[242:245], v[60:63], v[200:203]
v_mfma_f32_16x16x32_bf16 v[204:207], v[242:245], v[64:67], v[204:207]
v_mfma_f32_16x16x32_bf16 v[208:211], v[242:245], v[68:71], v[208:211]
v_mfma_f32_16x16x32_bf16 v[212:215], v[242:245], v[72:75], v[212:215]
v_mfma_f32_16x16x32_bf16 v[216:219], v[242:245], v[76:79], v[216:219]
s_waitcnt lgkmcnt(1)
v_mfma_f32_16x16x32_bf16 v[200:203], v[220:223], v[80:83], v[200:203]
v_mfma_f32_16x16x32_bf16 v[204:207], v[220:223], v[84:87], v[204:207]
v_mfma_f32_16x16x32_bf16 v[208:211], v[220:223], v[88:91], v[208:211]
v_mfma_f32_16x16x32_bf16 v[212:215], v[220:223], v[92:95], v[212:215]
v_mfma_f32_16x16x32_bf16 v[216:219], v[220:223], v[96:99], v[216:219]
s_waitcnt lgkmcnt(0)
v_mfma_f32_16x16x32_bf16 v[200:203], v[224:227], v[100:103], v[200:203]
v_mfma_f32_16x16x32_bf16 v[204:207], v[224:227], v[104:107], v[204:207]
v_mfma_f32_16x16x32_bf16 v[208:211], v[224:227], v[108:111], v[208:211]
v_mfma_f32_16x16x32_bf16 v[212:215], v[224:227], v[112:115], v[212:215]
v_mfma_f32_16x16x32_bf16 v[216:219], v[224:227], v[116:119], v[216:219]
s_nop 4
v_max3_f32 v232, v232, v200, v201
v_cvt_pk_bf16_f32 v160, v200, v201
v_max3_f32 v232, v232, v202, v203
v_cvt_pk_bf16_f32 v161, v202, v203
v_max3_f32 v233, v233, v204, v205
v_cvt_pk_bf16_f32 v164, v204, v205
v_max3_f32 v233, v233, v206, v207
v_cvt_pk_bf16_f32 v165, v206, v207
v_max3_f32 v234, v234, v208, v209
v_cvt_pk_bf16_f32 v168, v208, v209
v_max3_f32 v234, v234, v210, v211
v_cvt_pk_bf16_f32 v169, v210, v211
v_max3_f32 v235, v235, v212, v213
v_cvt_pk_bf16_f32 v172, v212, v213
v_max3_f32 v235, v235, v214, v215
v_cvt_pk_bf16_f32 v173, v214, v215
v_max3_f32 v236, v236, v216, v217
v_cvt_pk_bf16_f32 v176, v216, v217
v_max3_f32 v236, v236, v218, v219
v_cvt_pk_bf16_f32 v177, v218, v219
s_barrier
ds_read_b128 v[220:223], v247 offset:24576
ds_read_b128 v[224:227], v254 offset:24576
ds_read_b128 v[228:231], v247 offset:32768
ds_read_b128 v[242:245], v254 offset:32768
s_waitcnt lgkmcnt(3)
v_mfma_f32_16x16x32_bf16 v[200:203], v[220:223], v[0:3], 0
v_mfma_f32_16x16x32_bf16 v[204:207], v[220:223], v[4:7], 0
v_mfma_f32_16x16x32_bf16 v[208:211], v[220:223], v[8:11], 0
v_mfma_f32_16x16x32_bf16 v[212:215], v[220:223], v[12:15], 0
v_mfma_f32_16x16x32_bf16 v[216:219], v[220:223], v[16:19], 0
ds_read_b128 v[220:223], v247 offset:40960
s_waitcnt lgkmcnt(3)
v_mfma_f32_16x16x32_bf16 v[200:203], v[224:227], v[20:23], v[200:203]
v_mfma_f32_16x16x32_bf16 v[204:207], v[224:227], v[24:27], v[204:207]
v_mfma_f32_16x16x32_bf16 v[208:211], v[224:227], v[28:31], v[208:211]
v_mfma_f32_16x16x32_bf16 v[212:215], v[224:227], v[32:35], v[212:215]
v_mfma_f32_16x16x32_bf16 v[216:219], v[224:227], v[36:39], v[216:219]
ds_read_b128 v[224:227], v254 offset:40960
s_waitcnt lgkmcnt(3)
v_mfma_f32_16x16x32_bf16 v[200:203], v[228:231], v[40:43], v[200:203]
v_mfma_f32_16x16x32_bf16 v[204:207], v[228:231], v[44:47], v[204:207]
v_mfma_f32_16x16x32_bf16 v[208:211], v[228:231], v[48:51], v[208:211]
v_mfma_f32_16x16x32_bf16 v[212:215], v[228:231], v[52:55], v[212:215]
v_mfma_f32_16x16x32_bf16 v[216:219], v[228:231], v[56:59], v[216:219]
s_waitcnt lgkmcnt(0)
s_barrier
v_mfma_f32_16x16x32_bf16 v[200:203], v[242:245], v[60:63], v[200:203]
v_mfma_f32_16x16x32_bf16 v[204:207], v[242:245], v[64:67], v[204:207]
v_mfma_f32_16x16x32_bf16 v[208:211], v[242:245], v[68:71], v[208:211]
v_mfma_f32_16x16x32_bf16 v[212:215], v[242:245], v[72:75], v[212:215]
v_mfma_f32_16x16x32_bf16 v[216:219], v[242:245], v[76:79], v[216:219]
v_mfma_f32_16x16x32_bf16 v[200:203], v[220:223], v[80:83], v[200:203]
v_mfma_f32_16x16x32_bf16 v[204:207], v[220:223], v[84:87], v[204:207]
v_mfma_f32_16x16x32_bf16 v[208:211], v[220:223], v[88:91], v[208:211]
v_mfma_f32_16x16x32_bf16 v[212:215], v[220:223], v[92:95], v[212:215]
v_mfma_f32_16x16x32_bf16 v[216:219], v[220:223], v[96:99], v[216:219]
v_mfma_f32_16x16x32_bf16 v[200:203], v[224:227], v[100:103], v[200:203]
v_mfma_f32_16x16x32_bf16 v[204:207], v[224:227], v[104:107], v[204:207]
v_mfma_f32_16x16x32_bf16 v[208:211], v[224:227], v[108:111], v[208:211]
v_mfma_f32_16x16x32_bf16 v[212:215], v[224:227], v[112:115], v[212:215]
v_mfma_f32_16x16x32_bf16 v[216:219], v[224:227], v[116:119], v[216:219]
s_nop 4
v_max3_f32 v232, v232, v200, v201
v_cvt_pk_bf16_f32 v162, v200, v201
v_max3_f32 v232, v232, v202, v203
v_cvt_pk_bf16_f32 v163, v202, v203
v_max3_f32 v233, v233, v204, v205
v_cvt_pk_bf16_f32 v166, v204, v205
v_max3_f32 v233, v233, v206, v207
v_cvt_pk_bf16_f32 v167, v206, v207
v_max3_f32 v234, v234, v208, v209
v_cvt_pk_bf16_f32 v170, v208, v209
v_max3_f32 v234, v234, v210, v211
v_cvt_pk_bf16_f32 v171, v210, v211
v_max3_f32 v235, v235, v212, v213
v_cvt_pk_bf16_f32 v174, v212, v213
v_max3_f32 v235, v235, v214, v215
v_cvt_pk_bf16_f32 v175, v214, v215
v_max3_f32 v236, v236, v216, v217
v_cvt_pk_bf16_f32 v178, v216, v217
v_max3_f32 v236, v236, v218, v219
v_cvt_pk_bf16_f32 v179, v218, v219
s_barrier
s_barrier
ds_read_b128 v[220:223], v247 offset:0
ds_read_b128 v[224:227], v254 offset:0
ds_read_b128 v[228:231], v247 offset:8192
ds_read_b128 v[242:245], v254 offset:8192
s_waitcnt lgkmcnt(3)
v_mfma_f32_16x16x32_bf16 v[200:203], v[220:223], v[0:3], 0
v_mfma_f32_16x16x32_bf16 v[204:207], v[220:223], v[4:7], 0
v_mfma_f32_16x16x32_bf16 v[208:211], v[220:223], v[8:11], 0
v_mfma_f32_16x16x32_bf16 v[212:215], v[220:223], v[12:15], 0
v_mfma_f32_16x16x32_bf16 v[216:219], v[220:223], v[16:19], 0
ds_read_b128 v[220:223], v247 offset:16384
s_waitcnt lgkmcnt(3)
v_mfma_f32_16x16x32_bf16 v[200:203], v[224:227], v[20:23], v[200:203]
v_mfma_f32_16x16x32_bf16 v[204:207], v[224:227], v[24:27], v[204:207]
v_mfma_f32_16x16x32_bf16 v[208:211], v[224:227], v[28:31], v[208:211]
v_mfma_f32_16x16x32_bf16 v[212:215], v[224:227], v[32:35], v[212:215]
v_mfma_f32_16x16x32_bf16 v[216:219], v[224:227], v[36:39], v[216:219]
ds_read_b128 v[224:227], v254 offset:16384
s_waitcnt lgkmcnt(3)
v_mfma_f32_16x16x32_bf16 v[200:203], v[228:231], v[40:43], v[200:203]
v_mfma_f32_16x16x32_bf16 v[204:207], v[228:231], v[44:47], v[204:207]
v_mfma_f32_16x16x32_bf16 v[208:211], v[228:231], v[48:51], v[208:211]
v_mfma_f32_16x16x32_bf16 v[212:215], v[228:231], v[52:55], v[212:215]
v_mfma_f32_16x16x32_bf16 v[216:219], v[228:231], v[56:59], v[216:219]
s_waitcnt lgkmcnt(2)
v_mfma_f32_16x16x32_bf16 v[200:203], v[242:245], v[60:63], v[200:203]
v_mfma_f32_16x16x32_bf16 v[204:207], v[242:245], v[64:67], v[204:207]
v_mfma_f32_16x16x32_bf16 v[208:211], v[242:245], v[68:71], v[208:211]
v_mfma_f32_16x16x32_bf16 v[212:215], v[242:245], v[72:75], v[212:215]
v_mfma_f32_16x16x32_bf16 v[216:219], v[242:245], v[76:79], v[216:219]
s_waitcnt lgkmcnt(1)
v_mfma_f32_16x16x32_bf16 v[200:203], v[220:223], v[80:83], v[200:203]
v_mfma_f32_16x16x32_bf16 v[204:207], v[220:223], v[84:87], v[204:207]
v_mfma_f32_16x16x32_bf16 v[208:211], v[220:223], v[88:91], v[208:211]
v_mfma_f32_16x16x32_bf16 v[212:215], v[220:223], v[92:95], v[212:215]
v_mfma_f32_16x16x32_bf16 v[216:219], v[220:223], v[96:99], v[216:219]
s_waitcnt lgkmcnt(0)
v_mfma_f32_16x16x32_bf16 v[200:203], v[224:227], v[100:103], v[200:203]
v_mfma_f32_16x16x32_bf16 v[204:207], v[224:227], v[104:107], v[204:207]
v_mfma_f32_16x16x32_bf16 v[208:211], v[224:227], v[108:111], v[208:211]
v_mfma_f32_16x16x32_bf16 v[212:215], v[224:227], v[112:115], v[212:215]
v_mfma_f32_16x16x32_bf16 v[216:219], v[224:227], v[116:119], v[216:219]
s_nop 4
v_max3_f32 v232, v232, v200, v201
v_cvt_pk_bf16_f32 v180, v200, v201
v_max3_f32 v232, v232, v202, v203
v_cvt_pk_bf16_f32 v181, v202, v203
v_max3_f32 v233, v233, v204, v205
v_cvt_pk_bf16_f32 v184, v204, v205
v_max3_f32 v233, v233, v206, v207
v_cvt_pk_bf16_f32 v185, v206, v207
v_max3_f32 v234, v234, v208, v209
v_cvt_pk_bf16_f32 v188, v208, v209
v_max3_f32 v234, v234, v210, v211
v_cvt_pk_bf16_f32 v189, v210, v211
v_max3_f32 v235, v235, v212, v213
v_cvt_pk_bf16_f32 v192, v212, v213
v_max3_f32 v235, v235, v214, v215
v_cvt_pk_bf16_f32 v193, v214, v215
v_max3_f32 v236, v236, v216, v217
v_cvt_pk_bf16_f32 v196, v216, v217
v_max3_f32 v236, v236, v218, v219
v_cvt_pk_bf16_f32 v197, v218, v219
s_barrier
ds_read_b128 v[220:223], v247 offset:24576
ds_read_b128 v[224:227], v254 offset:24576
ds_read_b128 v[228:231], v247 offset:32768
ds_read_b128 v[242:245], v254 offset:32768
s_waitcnt lgkmcnt(3)
v_mfma_f32_16x16x32_bf16 v[200:203], v[220:223], v[0:3], 0
v_mfma_f32_16x16x32_bf16 v[204:207], v[220:223], v[4:7], 0
v_mfma_f32_16x16x32_bf16 v[208:211], v[220:223], v[8:11], 0
v_mfma_f32_16x16x32_bf16 v[212:215], v[220:223], v[12:15], 0
v_mfma_f32_16x16x32_bf16 v[216:219], v[220:223], v[16:19], 0
ds_read_b128 v[220:223], v247 offset:40960
s_waitcnt lgkmcnt(3)
v_mfma_f32_16x16x32_bf16 v[200:203], v[224:227], v[20:23], v[200:203]
v_mfma_f32_16x16x32_bf16 v[204:207], v[224:227], v[24:27], v[204:207]
v_mfma_f32_16x16x32_bf16 v[208:211], v[224:227], v[28:31], v[208:211]
v_mfma_f32_16x16x32_bf16 v[212:215], v[224:227], v[32:35], v[212:215]
v_mfma_f32_16x16x32_bf16 v[216:219], v[224:227], v[36:39], v[216:219]
ds_read_b128 v[224:227], v254 offset:40960
s_waitcnt lgkmcnt(3)
v_mfma_f32_16x16x32_bf16 v[200:203], v[228:231], v[40:43], v[200:203]
v_mfma_f32_16x16x32_bf16 v[204:207], v[228:231], v[44:47], v[204:207]
v_mfma_f32_16x16x32_bf16 v[208:211], v[228:231], v[48:51], v[208:211]
v_mfma_f32_16x16x32_bf16 v[212:215], v[228:231], v[52:55], v[212:215]
v_mfma_f32_16x16x32_bf16 v[216:219], v[228:231], v[56:59], v[216:219]
s_waitcnt lgkmcnt(0)
s_barrier
v_mfma_f32_16x16x32_bf16 v[200:203], v[242:245], v[60:63], v[200:203]
v_mfma_f32_16x16x32_bf16 v[204:207], v[242:245], v[64:67], v[204:207]
v_mfma_f32_16x16x32_bf16 v[208:211], v[242:245], v[68:71], v[208:211]
v_mfma_f32_16x16x32_bf16 v[212:215], v[242:245], v[72:75], v[212:215]
v_mfma_f32_16x16x32_bf16 v[216:219], v[242:245], v[76:79], v[216:219]
v_mfma_f32_16x16x32_bf16 v[200:203], v[220:223], v[80:83], v[200:203]
v_mfma_f32_16x16x32_bf16 v[204:207], v[220:223], v[84:87], v[204:207]
v_mfma_f32_16x16x32_bf16 v[208:211], v[220:223], v[88:91], v[208:211]
v_mfma_f32_16x16x32_bf16 v[212:215], v[220:223], v[92:95], v[212:215]
v_mfma_f32_16x16x32_bf16 v[216:219], v[220:223], v[96:99], v[216:219]
v_mfma_f32_16x16x32_bf16 v[200:203], v[224:227], v[100:103], v[200:203]
v_mfma_f32_16x16x32_bf16 v[204:207], v[224:227], v[104:107], v[204:207]
v_mfma_f32_16x16x32_bf16 v[208:211], v[224:227], v[108:111], v[208:211]
v_mfma_f32_16x16x32_bf16 v[212:215], v[224:227], v[112:115], v[212:215]
v_mfma_f32_16x16x32_bf16 v[216:219], v[224:227], v[116:119], v[216:219]
s_nop 4
v_max3_f32 v232, v232, v200, v201
v_cvt_pk_bf16_f32 v182, v200, v201
v_max3_f32 v232, v232, v202, v203
v_cvt_pk_bf16_f32 v183, v202, v203
v_max3_f32 v233, v233, v204, v205
v_cvt_pk_bf16_f32 v186, v204, v205
v_max3_f32 v233, v233, v206, v207
v_cvt_pk_bf16_f32 v187, v206, v207
v_max3_f32 v234, v234, v208, v209
v_cvt_pk_bf16_f32 v190, v208, v209
v_max3_f32 v234, v234, v210, v211
v_cvt_pk_bf16_f32 v191, v210, v211
v_max3_f32 v235, v235, v212, v213
v_cvt_pk_bf16_f32 v194, v212, v213
v_max3_f32 v235, v235, v214, v215
v_cvt_pk_bf16_f32 v195, v214, v215
v_max3_f32 v236, v236, v216, v217
v_cvt_pk_bf16_f32 v198, v216, v217
v_max3_f32 v236, v236, v218, v219
v_cvt_pk_bf16_f32 v199, v218, v219
v_mov_b32 v200, v232
v_mov_b32 v201, v233
v_mov_b32 v202, v234
v_mov_b32 v203, v235
v_mov_b32 v204, v236
s_nop 1
v_permlane32_swap_b32 v232, v200
v_permlane32_swap_b32 v233, v201
v_permlane32_swap_b32 v234, v202
v_permlane32_swap_b32 v235, v203
v_permlane32_swap_b32 v236, v204
s_nop 1
v_max_f32 v232, v232, v200
v_max_f32 v233, v233, v201
v_max_f32 v234, v234, v202
v_max_f32 v235, v235, v203
v_max_f32 v236, v236, v204
v_mov_b32 v200, v232
v_mov_b32 v201, v233
v_mov_b32 v202, v234
v_mov_b32 v203, v235
v_mov_b32 v204, v236
s_nop 1
v_permlane16_swap_b32 v232, v200
v_permlane16_swap_b32 v233, v201
v_permlane16_swap_b32 v234, v202
v_permlane16_swap_b32 v235, v203
v_permlane16_swap_b32 v236, v204
s_nop 1
v_max_f32 v232, v232, v200
v_max_f32 v233, v233, v201
v_max_f32 v234, v234, v202
v_max_f32 v235, v235, v203
v_max_f32 v236, v236, v204
ds_write_b32 v250, v232 offset:0
ds_write_b32 v250, v233 offset:256
ds_write_b32 v250, v234 offset:512
ds_write_b32 v250, v235 offset:768
ds_write_b32 v250, v236 offset:1024
s_waitcnt lgkmcnt(0)
s_barrier
v_and_b32 v242, -16, v250
ds_read_b128 v[200:203], v242 offset:0
ds_read_b128 v[204:207], v242 offset:256
ds_read_b128 v[208:211], v242 offset:512
ds_read_b128 v[212:215], v242 offset:768
ds_read_b128 v[216:219], v242 offset:1024
s_waitcnt lgkmcnt(4)
v_max3_f32 v200, v200, v201, v202
v_max_f32 v200, v200, v203
v_cvt_pk_bf16_f32 v200, v200, v200
v_and_b32 v200, s36, v200
v_mul_f32 v232, s35, -v200
v_mov_b32 v237, 0
s_waitcnt lgkmcnt(3)
v_max3_f32 v204, v204, v205, v206
v_max_f32 v204, v204, v207
v_cvt_pk_bf16_f32 v204, v204, v204
v_and_b32 v204, s36, v204
v_mul_f32 v233, s35, -v204
v_mov_b32 v238, 0
s_waitcnt lgkmcnt(2)
v_max3_f32 v208, v208, v209, v210
v_max_f32 v208, v208, v211
v_cvt_pk_bf16_f32 v208, v208, v208
v_and_b32 v208, s36, v208
v_mul_f32 v234, s35, -v208
v_mov_b32 v239, 0
s_waitcnt lgkmcnt(1)
v_max3_f32 v212, v212, v213, v214
v_max_f32 v212, v212, v215
v_cvt_pk_bf16_f32 v212, v212, v212
v_and_b32 v212, s36, v212
v_mul_f32 v235, s35, -v212
v_mov_b32 v240, 0
s_waitcnt lgkmcnt(0)
v_max3_f32 v216, v216, v217, v218
v_max_f32 v216, v216, v219
v_cvt_pk_bf16_f32 v216, v216, v216
v_and_b32 v216, s36, v216
v_mul_f32 v236, s35, -v216
v_mov_b32 v241, 0
v_lshlrev_b32 v242, 16, v120
v_and_b32 v243, s36, v120
v_fma_f32 v242, v242, s35, v232
v_fma_f32 v243, v243, s35, v232
v_exp_f32 v242, v242
v_exp_f32 v243, v243
v_add_f32 v237, v237, v242
v_cvt_pk_bf16_f32 v120, v242, v243
v_add_f32 v237, v237, v243
v_lshlrev_b32 v244, 16, v121
v_and_b32 v245, s36, v121
v_fma_f32 v244, v244, s35, v232
v_fma_f32 v245, v245, s35, v232
v_exp_f32 v244, v244
v_exp_f32 v245, v245
v_add_f32 v237, v237, v244
v_cvt_pk_bf16_f32 v121, v244, v245
v_add_f32 v237, v237, v245
v_lshlrev_b32 v242, 16, v122
v_and_b32 v243, s36, v122
v_fma_f32 v242, v242, s35, v232
v_fma_f32 v243, v243, s35, v232
v_exp_f32 v242, v242
v_exp_f32 v243, v243
v_add_f32 v237, v237, v242
v_cvt_pk_bf16_f32 v122, v242, v243
v_add_f32 v237, v237, v243
v_lshlrev_b32 v244, 16, v123
v_and_b32 v245, s36, v123
v_fma_f32 v244, v244, s35, v232
v_fma_f32 v245, v245, s35, v232
v_exp_f32 v244, v244
v_exp_f32 v245, v245
v_add_f32 v237, v237, v244
v_cvt_pk_bf16_f32 v123, v244, v245
v_add_f32 v237, v237, v245
ds_write_b128 v255, v[120:123] offset:0
v_lshlrev_b32 v242, 16, v124
v_and_b32 v243, s36, v124
v_fma_f32 v242, v242, s35, v233
v_fma_f32 v243, v243, s35, v233
v_exp_f32 v242, v242
v_exp_f32 v243, v243
v_add_f32 v238, v238, v242
v_cvt_pk_bf16_f32 v124, v242, v243
v_add_f32 v238, v238, v243
v_lshlrev_b32 v244, 16, v125
v_and_b32 v245, s36, v125
v_fma_f32 v244, v244, s35, v233
v_fma_f32 v245, v245, s35, v233
v_exp_f32 v244, v244
v_exp_f32 v245, v245
v_add_f32 v238, v238, v244
v_cvt_pk_bf16_f32 v125, v244, v245
v_add_f32 v238, v238, v245
v_lshlrev_b32 v242, 16, v126
v_and_b32 v243, s36, v126
v_fma_f32 v242, v242, s35, v233
v_fma_f32 v243, v243, s35, v233
v_exp_f32 v242, v242
v_exp_f32 v243, v243
v_add_f32 v238, v238, v242
v_cvt_pk_bf16_f32 v126, v242, v243
v_add_f32 v238, v238, v243
v_lshlrev_b32 v244, 16, v127
v_and_b32 v245, s36, v127
v_fma_f32 v244, v244, s35, v233
v_fma_f32 v245, v245, s35, v233
v_exp_f32 v244, v244
v_exp_f32 v245, v245
v_add_f32 v238, v238, v244
v_cvt_pk_bf16_f32 v127, v244, v245
v_add_f32 v238, v238, v245
ds_write_b128 v255, v[124:127] offset:1024
v_lshlrev_b32 v242, 16, v128
v_and_b32 v243, s36, v128
v_fma_f32 v242, v242, s35, v234
v_fma_f32 v243, v243, s35, v234
v_exp_f32 v242, v242
v_exp_f32 v243, v243
v_add_f32 v239, v239, v242
v_cvt_pk_bf16_f32 v128, v242, v243
v_add_f32 v239, v239, v243
s_waitcnt lgkmcnt(0)
s_barrier
v_lshlrev_b32 v242, 16, v129
v_and_b32 v243, s36, v129
v_fma_f32 v242, v242, s35, v234
v_fma_f32 v243, v243, s35, v234
v_exp_f32 v242, v242
v_exp_f32 v243, v243
v_add_f32 v239, v239, v242
v_cvt_pk_bf16_f32 v129, v242, v243
v_add_f32 v239, v239, v243
v_lshlrev_b32 v244, 16, v130
v_and_b32 v245, s36, v130
v_fma_f32 v244, v244, s35, v234
v_fma_f32 v245, v245, s35, v234
v_exp_f32 v244, v244
v_exp_f32 v245, v245
v_add_f32 v239, v239, v244
v_cvt_pk_bf16_f32 v130, v244, v245
v_add_f32 v239, v239, v245
v_lshlrev_b32 v242, 16, v131
v_and_b32 v243, s36, v131
v_fma_f32 v242, v242, s35, v234
v_fma_f32 v243, v243, s35, v234
v_exp_f32 v242, v242
v_exp_f32 v243, v243
v_add_f32 v239, v239, v242
v_cvt_pk_bf16_f32 v131, v242, v243
v_add_f32 v239, v239, v243
ds_write_b128 v255, v[128:131] offset:2048
v_lshlrev_b32 v244, 16, v132
v_and_b32 v245, s36, v132
v_fma_f32 v244, v244, s35, v235
v_fma_f32 v245, v245, s35, v235
v_exp_f32 v244, v244
v_exp_f32 v245, v245
v_add_f32 v240, v240, v244
v_cvt_pk_bf16_f32 v132, v244, v245
v_add_f32 v240, v240, v245
v_lshlrev_b32 v242, 16, v133
v_and_b32 v243, s36, v133
v_fma_f32 v242, v242, s35, v235
v_fma_f32 v243, v243, s35, v235
v_exp_f32 v242, v242
v_exp_f32 v243, v243
v_add_f32 v240, v240, v242
v_cvt_pk_bf16_f32 v133, v242, v243
v_add_f32 v240, v240, v243
v_lshlrev_b32 v244, 16, v134
v_and_b32 v245, s36, v134
v_fma_f32 v244, v244, s35, v235
v_fma_f32 v245, v245, s35, v235
v_exp_f32 v244, v244
v_exp_f32 v245, v245
v_add_f32 v240, v240, v244
v_cvt_pk_bf16_f32 v134, v244, v245
v_add_f32 v240, v240, v245
v_lshlrev_b32 v242, 16, v135
v_and_b32 v243, s36, v135
v_fma_f32 v242, v242, s35, v235
v_fma_f32 v243, v243, s35, v235
v_exp_f32 v242, v242
v_exp_f32 v243, v243
v_add_f32 v240, v240, v242
v_cvt_pk_bf16_f32 v135, v242, v243
v_add_f32 v240, v240, v243
ds_write_b128 v255, v[132:135] offset:3072
v_lshlrev_b32 v244, 16, v136
v_and_b32 v245, s36, v136
v_fma_f32 v244, v244, s35, v236
v_fma_f32 v245, v245, s35, v236
v_exp_f32 v244, v244
v_exp_f32 v245, v245
v_add_f32 v241, v241, v244
v_cvt_pk_bf16_f32 v136, v244, v245
v_add_f32 v241, v241, v245
v_lshlrev_b32 v242, 16, v137
v_and_b32 v243, s36, v137
v_fma_f32 v242, v242, s35, v236
v_fma_f32 v243, v243, s35, v236
v_exp_f32 v242, v242
v_exp_f32 v243, v243
v_add_f32 v241, v241, v242
v_cvt_pk_bf16_f32 v137, v242, v243
v_add_f32 v241, v241, v243
v_lshlrev_b32 v244, 16, v138
v_and_b32 v245, s36, v138
v_fma_f32 v244, v244, s35, v236
v_fma_f32 v245, v245, s35, v236
v_exp_f32 v244, v244
v_exp_f32 v245, v245
v_add_f32 v241, v241, v244
v_cvt_pk_bf16_f32 v138, v244, v245
v_add_f32 v241, v241, v245
v_lshlrev_b32 v242, 16, v139
v_and_b32 v243, s36, v139
v_fma_f32 v242, v242, s35, v236
v_fma_f32 v243, v243, s35, v236
v_exp_f32 v242, v242
v_exp_f32 v243, v243
v_add_f32 v241, v241, v242
v_cvt_pk_bf16_f32 v139, v242, v243
v_add_f32 v241, v241, v243
ds_write_b128 v255, v[136:139] offset:4096
s_waitcnt lgkmcnt(0)
s_add_u32 s28, s28, 196608
s_add_u32 s29, s29, 384
s_add_u32 s30, s30, 245760
s_add_u32 s38, s38, 245760
s_sub_u32 s33, s33, 1
s_cmp_lg_u32 s33, 0
s_cbranch_scc1 L_att_loop
s_barrier
ds_read_b64_tr_b16 v[220:221], v246 offset:0
ds_read_b64_tr_b16 v[222:223], v246 offset:2048
ds_read_b128 v[200:203], v248 offset:30720
ds_read_b64_tr_b16 v[224:225], v246 offset:4096
ds_read_b64_tr_b16 v[226:227], v246 offset:6144
ds_read_b64_tr_b16 v[228:229], v246 offset:8192
ds_read_b64_tr_b16 v[230:231], v246 offset:10240
ds_read_b128 v[204:207], v248 offset:31744
ds_read_b128 v[208:211], v248 offset:32768
ds_read_b128 v[212:215], v248 offset:33792
ds_read_b128 v[216:219], v248 offset:34816
s_waitcnt lgkmcnt(8)
v_mfma_f32_16x16x32_bf16 v[0:3], v[220:223], v[200:203], 0
v_lshlrev_b32 v242, 16, v140
v_and_b32 v243, s36, v140
ds_read_b64_tr_b16 v[120:121], v246 offset:12288
ds_read_b64_tr_b16 v[122:123], v246 offset:14336
s_waitcnt lgkmcnt(8)
v_mfma_f32_16x16x32_bf16 v[20:23], v[224:227], v[200:203], 0
v_fma_f32 v242, v242, s35, v232
ds_read_b128 v[132:135], v248 offset:35840
s_waitcnt lgkmcnt(7)
v_mfma_f32_16x16x32_bf16 v[40:43], v[228:231], v[200:203], 0
v_fma_f32 v243, v243, s35, v232
v_exp_f32 v242, v242
s_waitcnt lgkmcnt(6)
v_mfma_f32_16x16x32_bf16 v[4:7], v[220:223], v[204:207], 0
v_exp_f32 v243, v243
ds_read_b64_tr_b16 v[124:125], v246 offset:16384
ds_read_b64_tr_b16 v[126:127], v246 offset:18432
v_mfma_f32_16x16x32_bf16 v[24:27], v[224:227], v[204:207], 0
v_add_f32 v237, v237, v242
v_cvt_pk_bf16_f32 v140, v242, v243
ds_read_b128 v[136:139], v248 offset:36864
v_mfma_f32_16x16x32_bf16 v[44:47], v[228:231], v[204:207], 0
v_add_f32 v237, v237, v243
s_waitcnt lgkmcnt(8)
v_mfma_f32_16x16x32_bf16 v[8:11], v[220:223], v[208:211], 0
v_lshlrev_b32 v244, 16, v141
v_and_b32 v245, s36, v141
ds_read_b64_tr_b16 v[128:129], v246 offset:20480
ds_read_b64_tr_b16 v[130:131], v246 offset:22528
v_mfma_f32_16x16x32_bf16 v[28:31], v[224:227], v[208:211], 0
v_fma_f32 v244, v244, s35, v232
ds_read_b128 v[200:203], v248 offset:37888
v_mfma_f32_16x16x32_bf16 v[48:51], v[228:231], v[208:211], 0
v_fma_f32 v245, v245, s35, v232
v_exp_f32 v244, v244
s_waitcnt lgkmcnt(10)
v_mfma_f32_16x16x32_bf16 v[12:15], v[220:223], v[212:215], 0
v_exp_f32 v245, v245
v_mfma_f32_16x16x32_bf16 v[32:35], v[224:227], v[212:215], 0
v_add_f32 v237, v237, v244
v_cvt_pk_bf16_f32 v141, v244, v245
ds_read_b128 v[204:207], v248 offset:38912
v_mfma_f32_16x16x32_bf16 v[52:55], v[228:231], v[212:215], 0
v_add_f32 v237, v237, v245
s_waitcnt lgkmcnt(10)
v_mfma_f32_16x16x32_bf16 v[16:19], v[220:223], v[216:219], 0
v_lshlrev_b32 v242, 16, v142
v_and_b32 v243, s36, v142
v_mfma_f32_16x16x32_bf16 v[36:39], v[224:227], v[216:219], 0
v_fma_f32 v242, v242, s35, v232
ds_read_b128 v[208:211], v248 offset:39936
v_mfma_f32_16x16x32_bf16 v[56:59], v[228:231], v[216:219], 0
v_fma_f32 v243, v243, s35, v232
v_exp_f32 v242, v242
s_waitcnt lgkmcnt(2)
v_mfma_f32_16x16x32_bf16 v[0:3], v[120:123], v[132:135], v[0:3]
v_exp_f32 v243, v243
v_mfma_f32_16x16x32_bf16 v[20:23], v[124:127], v[132:135], v[20:23]
v_add_f32 v237, v237, v242
v_cvt_pk_bf16_f32 v142, v242, v243
ds_read_b128 v[212:215], v248 offset:40960
v_mfma_f32_16x16x32_bf16 v[40:43], v[128:131], v[132:135], v[40:43]
v_add_f32 v237, v237, v243
v_mfma_f32_16x16x32_bf16 v[4:7], v[120:123], v[136:139], v[4:7]
v_lshlrev_b32 v244, 16, v143
v_and_b32 v245, s36, v143
v_mfma_f32_16x16x32_bf16 v[24:27], v[124:127], v[136:139], v[24:27]
v_fma_f32 v244, v244, s35, v232
ds_read_b128 v[216:219], v248 offset:41984
v_mfma_f32_16x16x32_bf16 v[44:47], v[128:131], v[136:139], v[44:47]
v_fma_f32 v245, v245, s35, v232
v_exp_f32 v244, v244
v_mfma_f32_16x16x32_bf16 v[8:11], v[120:123], v[200:203], v[8:11]
v_exp_f32 v245, v245
v_mfma_f32_16x16x32_bf16 v[28:31], v[124:127], v[200:203], v[28:31]
v_add_f32 v237, v237, v244
v_cvt_pk_bf16_f32 v143, v244, v245
ds_read_b128 v[132:135], v248 offset:43008
v_mfma_f32_16x16x32_bf16 v[48:51], v[128:131], v[200:203], v[48:51]
v_add_f32 v237, v237, v245
s_waitcnt lgkmcnt(3)
v_mfma_f32_16x16x32_bf16 v[12:15], v[120:123], v[204:207], v[12:15]
v_lshlrev_b32 v242, 16, v144
v_and_b32 v243, s36, v144
v_mfma_f32_16x16x32_bf16 v[32:35], v[124:127], v[204:207], v[32:35]
v_fma_f32 v242, v242, s35, v233
ds_read_b128 v[136:139], v248 offset:44032
v_mfma_f32_16x16x32_bf16 v[52:55], v[128:131], v[204:207], v[52:55]
v_fma_f32 v243, v243, s35, v233
v_exp_f32 v242, v242
v_mfma_f32_16x16x32_bf16 v[16:19], v[120:123], v[208:211], v[16:19]
v_exp_f32 v243, v243
v_mfma_f32_16x16x32_bf16 v[36:39], v[124:127], v[208:211], v[36:39]
v_add_f32 v238, v238, v242
v_cvt_pk_bf16_f32 v144, v242, v243
ds_read_b128 v[200:203], v248 offset:45056
v_mfma_f32_16x16x32_bf16 v[56:59], v[128:131], v[208:211], v[56:59]
v_add_f32 v238, v238, v243
s_barrier
ds_read_b64_tr_b16 v[220:221], v246 offset:24576
ds_read_b64_tr_b16 v[222:223], v246 offset:26624
ds_read_b64_tr_b16 v[224:225], v246 offset:28672
ds_read_b64_tr_b16 v[226:227], v246 offset:30720
ds_read_b64_tr_b16 v[228:229], v246 offset:32768
ds_read_b64_tr_b16 v[230:231], v246 offset:34816
s_waitcnt lgkmcnt(4)
v_mfma_f32_16x16x32_bf16 v[0:3], v[220:223], v[212:215], v[0:3]
ds_read_b64_tr_b16 v[120:121], v246 offset:36864
ds_read_b64_tr_b16 v[122:123], v246 offset:38912
s_waitcnt lgkmcnt(4)
v_mfma_f32_16x16x32_bf16 v[20:23], v[224:227], v[212:215], v[20:23]
ds_read_b128 v[204:207], v248 offset:46080
s_waitcnt lgkmcnt(3)
v_mfma_f32_16x16x32_bf16 v[40:43], v[228:231], v[212:215], v[40:43]
v_mfma_f32_16x16x32_bf16 v[4:7], v[220:223], v[216:219], v[4:7]
ds_read_b64_tr_b16 v[124:125], v246 offset:40960
ds_read_b64_tr_b16 v[126:127], v246 offset:43008
v_mfma_f32_16x16x32_bf16 v[24:27], v[224:227], v[216:219], v[24:27]
ds_read_b128 v[208:211], v248 offset:47104
v_mfma_f32_16x16x32_bf16 v[44:47], v[228:231], v[216:219], v[44:47]
v_mfma_f32_16x16x32_bf16 v[8:11], v[220:223], v[132:135], v[8:11]
ds_read_b64_tr_b16 v[128:129], v246 offset:45056
ds_read_b64_tr_b16 v[130:131], v246 offset:47104
v_mfma_f32_16x16x32_bf16 v[28:31], v[224:227], v[132:135], v[28:31]
ds_read_b128 v[212:215], v248 offset:48128
v_mfma_f32_16x16x32_bf16 v[48:51], v[228:231], v[132:135], v[48:51]
v_mfma_f32_16x16x32_bf16 v[12:15], v[220:223], v[136:139], v[12:15]
v_mfma_f32_16x16x32_bf16 v[32:35], v[224:227], v[136:139], v[32:35]
ds_read_b128 v[216:219], v248 offset:49152
v_mfma_f32_16x16x32_bf16 v[52:55], v[228:231], v[136:139], v[52:55]
v_mfma_f32_16x16x32_bf16 v[16:19], v[220:223], v[200:203], v[16:19]
v_mfma_f32_16x16x32_bf16 v[36:39], v[224:227], v[200:203], v[36:39]
ds_read_b128 v[132:135], v248 offset:50176
v_mfma_f32_16x16x32_bf16 v[56:59], v[228:231], v[200:203], v[56:59]
s_waitcnt lgkmcnt(0)
s_barrier
v_mfma_f32_16x16x32_bf16 v[0:3], v[120:123], v[204:207], v[0:3]
v_lshlrev_b32 v242, 16, v145
v_and_b32 v243, s36, v145
v_fma_f32 v242, v242, s35, v233
v_mfma_f32_16x16x32_bf16 v[20:23], v[124:127], v[204:207], v[20:23]
v_fma_f32 v243, v243, s35, v233
v_exp_f32 v242, v242
v_exp_f32 v243, v243
v_mfma_f32_16x16x32_bf16 v[40:43], v[128:131], v[204:207], v[40:43]
v_add_f32 v238, v238, v242
v_cvt_pk_bf16_f32 v145, v242, v243
v_add_f32 v238, v238, v243
v_mfma_f32_16x16x32_bf16 v[4:7], v[120:123], v[208:211], v[4:7]
v_lshlrev_b32 v244, 16, v146
v_and_b32 v245, s36, v146
v_fma_f32 v244, v244, s35, v233
v_mfma_f32_16x16x32_bf16 v[24:27], v[124:127], v[208:211], v[24:27]
v_fma_f32 v245, v245, s35, v233
v_exp_f32 v244, v244
v_exp_f32 v245, v245
v_mfma_f32_16x16x32_bf16 v[44:47], v[128:131], v[208:211], v[44:47]
v_add_f32 v238, v238, v244
v_cvt_pk_bf16_f32 v146, v244, v245
v_add_f32 v238, v238, v245
v_mfma_f32_16x16x32_bf16 v[8:11], v[120:123], v[212:215], v[8:11]
v_lshlrev_b32 v242, 16, v147
v_and_b32 v243, s36, v147
v_fma_f32 v242, v242, s35, v233
v_mfma_f32_16x16x32_bf16 v[28:31], v[124:127], v[212:215], v[28:31]
v_fma_f32 v243, v243, s35, v233
v_exp_f32 v242, v242
v_exp_f32 v243, v243
v_mfma_f32_16x16x32_bf16 v[48:51], v[128:131], v[212:215], v[48:51]
v_add_f32 v238, v238, v242
v_cvt_pk_bf16_f32 v147, v242, v243
v_add_f32 v238, v238, v243
v_mfma_f32_16x16x32_bf16 v[12:15], v[120:123], v[216:219], v[12:15]
v_lshlrev_b32 v244, 16, v148
v_and_b32 v245, s36, v148
v_fma_f32 v244, v244, s35, v234
v_mfma_f32_16x16x32_bf16 v[32:35], v[124:127], v[216:219], v[32:35]
v_fma_f32 v245, v245, s35, v234
v_exp_f32 v244, v244
v_exp_f32 v245, v245
v_mfma_f32_16x16x32_bf16 v[52:55], v[128:131], v[216:219], v[52:55]
v_add_f32 v239, v239, v244
v_cvt_pk_bf16_f32 v148, v244, v245
v_add_f32 v239, v239, v245
v_mfma_f32_16x16x32_bf16 v[16:19], v[120:123], v[132:135], v[16:19]
v_lshlrev_b32 v242, 16, v149
v_and_b32 v243, s36, v149
v_fma_f32 v242, v242, s35, v234
v_mfma_f32_16x16x32_bf16 v[36:39], v[124:127], v[132:135], v[36:39]
v_fma_f32 v243, v243, s35, v234
v_exp_f32 v242, v242
v_exp_f32 v243, v243
v_mfma_f32_16x16x32_bf16 v[56:59], v[128:131], v[132:135], v[56:59]
v_add_f32 v239, v239, v242
v_cvt_pk_bf16_f32 v149, v242, v243
v_add_f32 v239, v239, v243
ds_write_b128 v255, v[140:143] offset:0
ds_write_b128 v255, v[144:147] offset:1024
v_lshlrev_b32 v242, 16, v150
v_and_b32 v243, s36, v150
v_fma_f32 v242, v242, s35, v234
v_fma_f32 v243, v243, s35, v234
v_exp_f32 v242, v242
v_exp_f32 v243, v243
v_add_f32 v239, v239, v242
v_cvt_pk_bf16_f32 v150, v242, v243
v_add_f32 v239, v239, v243
v_lshlrev_b32 v244, 16, v151
v_and_b32 v245, s36, v151
v_fma_f32 v244, v244, s35, v234
v_fma_f32 v245, v245, s35, v234
v_exp_f32 v244, v244
v_exp_f32 v245, v245
v_add_f32 v239, v239, v244
v_cvt_pk_bf16_f32 v151, v244, v245
v_add_f32 v239, v239, v245
ds_write_b128 v255, v[148:151] offset:2048
v_lshlrev_b32 v242, 16, v152
v_and_b32 v243, s36, v152
v_fma_f32 v242, v242, s35, v235
v_fma_f32 v243, v243, s35, v235
v_exp_f32 v242, v242
v_exp_f32 v243, v243
v_add_f32 v240, v240, v242
v_cvt_pk_bf16_f32 v152, v242, v243
v_add_f32 v240, v240, v243
v_lshlrev_b32 v244, 16, v153
v_and_b32 v245, s36, v153
v_fma_f32 v244, v244, s35, v235
v_fma_f32 v245, v245, s35, v235
v_exp_f32 v244, v244
v_exp_f32 v245, v245
v_add_f32 v240, v240, v244
v_cvt_pk_bf16_f32 v153, v244, v245
v_add_f32 v240, v240, v245
v_lshlrev_b32 v242, 16, v154
v_and_b32 v243, s36, v154
v_fma_f32 v242, v242, s35, v235
v_fma_f32 v243, v243, s35, v235
v_exp_f32 v242, v242
v_exp_f32 v243, v243
v_add_f32 v240, v240, v242
v_cvt_pk_bf16_f32 v154, v242, v243
v_add_f32 v240, v240, v243
v_lshlrev_b32 v244, 16, v155
v_and_b32 v245, s36, v155
v_fma_f32 v244, v244, s35, v235
v_fma_f32 v245, v245, s35, v235
v_exp_f32 v244, v244
v_exp_f32 v245, v245
v_add_f32 v240, v240, v244
v_cvt_pk_bf16_f32 v155, v244, v245
v_add_f32 v240, v240, v245
ds_write_b128 v255, v[152:155] offset:3072
v_lshlrev_b32 v242, 16, v156
v_and_b32 v243, s36, v156
v_fma_f32 v242, v242, s35, v236
v_fma_f32 v243, v243, s35, v236
v_exp_f32 v242, v242
v_exp_f32 v243, v243
v_add_f32 v241, v241, v242
v_cvt_pk_bf16_f32 v156, v242, v243
v_add_f32 v241, v241, v243
v_lshlrev_b32 v244, 16, v157
v_and_b32 v245, s36, v157
v_fma_f32 v244, v244, s35, v236
v_fma_f32 v245, v245, s35, v236
v_exp_f32 v244, v244
v_exp_f32 v245, v245
v_add_f32 v241, v241, v244
v_cvt_pk_bf16_f32 v157, v244, v245
v_add_f32 v241, v241, v245
v_lshlrev_b32 v242, 16, v158
v_and_b32 v243, s36, v158
v_fma_f32 v242, v242, s35, v236
v_fma_f32 v243, v243, s35, v236
v_exp_f32 v242, v242
v_exp_f32 v243, v243
v_add_f32 v241, v241, v242
v_cvt_pk_bf16_f32 v158, v242, v243
v_add_f32 v241, v241, v243
v_lshlrev_b32 v244, 16, v159
v_and_b32 v245, s36, v159
v_fma_f32 v244, v244, s35, v236
v_fma_f32 v245, v245, s35, v236
v_exp_f32 v244, v244
v_exp_f32 v245, v245
v_add_f32 v241, v241, v244
v_cvt_pk_bf16_f32 v159, v244, v245
v_add_f32 v241, v241, v245
ds_write_b128 v255, v[156:159] offset:4096
s_waitcnt lgkmcnt(0)
s_barrier
ds_read_b64_tr_b16 v[220:221], v253 offset:0
ds_read_b64_tr_b16 v[222:223], v253 offset:2048
ds_read_b128 v[136:139], v248 offset:30720
ds_read_b64_tr_b16 v[224:225], v253 offset:4096
ds_read_b64_tr_b16 v[226:227], v253 offset:6144
ds_read_b64_tr_b16 v[228:229], v253 offset:8192
ds_read_b64_tr_b16 v[230:231], v253 offset:10240
ds_read_b128 v[200:203], v248 offset:31744
ds_read_b128 v[204:207], v248 offset:32768
ds_read_b128 v[208:211], v248 offset:33792
ds_read_b128 v[212:215], v248 offset:34816
s_waitcnt lgkmcnt(8)
v_mfma_f32_16x16x32_bf16 v[0:3], v[220:223], v[136:139], v[0:3]
v_lshlrev_b32 v242, 16, v160
v_and_b32 v243, s36, v160
ds_read_b64_tr_b16 v[120:121], v253 offset:12288
ds_read_b64_tr_b16 v[122:123], v253 offset:14336
s_waitcnt lgkmcnt(8)
v_mfma_f32_16x16x32_bf16 v[20:23], v[224:227], v[136:139], v[20:23]
v_fma_f32 v242, v242, s35, v232
ds_read_b128 v[216:219], v248 offset:35840
s_waitcnt lgkmcnt(7)
v_mfma_f32_16x16x32_bf16 v[40:43], v[228:231], v[136:139], v[40:43]
v_fma_f32 v243, v243, s35, v232
v_exp_f32 v242, v242
s_waitcnt lgkmcnt(6)
v_mfma_f32_16x16x32_bf16 v[4:7], v[220:223], v[200:203], v[4:7]
v_exp_f32 v243, v243
ds_read_b64_tr_b16 v[124:125], v253 offset:16384
ds_read_b64_tr_b16 v[126:127], v253 offset:18432
v_mfma_f32_16x16x32_bf16 v[24:27], v[224:227], v[200:203], v[24:27]
v_add_f32 v237, v237, v242
v_cvt_pk_bf16_f32 v160, v242, v243
ds_read_b128 v[132:135], v248 offset:36864
v_mfma_f32_16x16x32_bf16 v[44:47], v[228:231], v[200:203], v[44:47]
v_add_f32 v237, v237, v243
s_waitcnt lgkmcnt(8)
v_mfma_f32_16x16x32_bf16 v[8:11], v[220:223], v[204:207], v[8:11]
v_lshlrev_b32 v244, 16, v161
v_and_b32 v245, s36, v161
ds_read_b64_tr_b16 v[128:129], v253 offset:20480
ds_read_b64_tr_b16 v[130:131], v253 offset:22528
v_mfma_f32_16x16x32_bf16 v[28:31], v[224:227], v[204:207], v[28:31]
v_fma_f32 v244, v244, s35, v232
ds_read_b128 v[136:139], v248 offset:37888
v_mfma_f32_16x16x32_bf16 v[48:51], v[228:231], v[204:207], v[48:51]
v_fma_f32 v245, v245, s35, v232
v_exp_f32 v244, v244
s_waitcnt lgkmcnt(10)
v_mfma_f32_16x16x32_bf16 v[12:15], v[220:223], v[208:211], v[12:15]
v_exp_f32 v245, v245
v_mfma_f32_16x16x32_bf16 v[32:35], v[224:227], v[208:211], v[32:35]
v_add_f32 v237, v237, v244
v_cvt_pk_bf16_f32 v161, v244, v245
ds_read_b128 v[200:203], v248 offset:38912
v_mfma_f32_16x16x32_bf16 v[52:55], v[228:231], v[208:211], v[52:55]
v_add_f32 v237, v237, v245
s_waitcnt lgkmcnt(10)
v_mfma_f32_16x16x32_bf16 v[16:19], v[220:223], v[212:215], v[16:19]
v_lshlrev_b32 v242, 16, v162
v_and_b32 v243, s36, v162
v_mfma_f32_16x16x32_bf16 v[36:39], v[224:227], v[212:215], v[36:39]
v_fma_f32 v242, v242, s35, v232
ds_read_b128 v[204:207], v248 offset:39936
v_mfma_f32_16x16x32_bf16 v[56:59], v[228:231], v[212:215], v[56:59]
v_fma_f32 v243, v243, s35, v232
v_exp_f32 v242, v242
s_waitcnt lgkmcnt(2)
v_mfma_f32_16x16x32_bf16 v[0:3], v[120:123], v[216:219], v[0:3]
v_exp_f32 v243, v243
v_mfma_f32_16x16x32_bf16 v[20:23], v[124:127], v[216:219], v[20:23]
v_add_f32 v237, v237, v242
v_cvt_pk_bf16_f32 v162, v242, v243
ds_read_b128 v[208:211], v248 offset:40960
v_mfma_f32_16x16x32_bf16 v[40:43], v[128:131], v[216:219], v[40:43]
v_add_f32 v237, v237, v243
v_mfma_f32_16x16x32_bf16 v[4:7], v[120:123], v[132:135], v[4:7]
v_lshlrev_b32 v244, 16, v163
v_and_b32 v245, s36, v163
v_mfma_f32_16x16x32_bf16 v[24:27], v[124:127], v[132:135], v[24:27]
v_fma_f32 v244, v244, s35, v232
ds_read_b128 v[212:215], v248 offset:41984
v_mfma_f32_16x16x32_bf16 v[44:47], v[128:131], v[132:135], v[44:47]
v_fma_f32 v245, v245, s35, v232
v_exp_f32 v244, v244
v_mfma_f32_16x16x32_bf16 v[8:11], v[120:123], v[136:139], v[8:11]
v_exp_f32 v245, v245
v_mfma_f32_16x16x32_bf16 v[28:31], v[124:127], v[136:139], v[28:31]
v_add_f32 v237, v237, v244
v_cvt_pk_bf16_f32 v163, v244, v245
ds_read_b128 v[216:219], v248 offset:43008
v_mfma_f32_16x16x32_bf16 v[48:51], v[128:131], v[136:139], v[48:51]
v_add_f32 v237, v237, v245
s_waitcnt lgkmcnt(3)
v_mfma_f32_16x16x32_bf16 v[12:15], v[120:123], v[200:203], v[12:15]
v_lshlrev_b32 v242, 16, v164
v_and_b32 v243, s36, v164
v_mfma_f32_16x16x32_bf16 v[32:35], v[124:127], v[200:203], v[32:35]
v_fma_f32 v242, v242, s35, v233
ds_read_b128 v[132:135], v248 offset:44032
v_mfma_f32_16x16x32_bf16 v[52:55], v[128:131], v[200:203], v[52:55]
v_fma_f32 v243, v243, s35, v233
v_exp_f32 v242, v242
v_mfma_f32_16x16x32_bf16 v[16:19], v[120:123], v[204:207], v[16:19]
v_exp_f32 v243, v243
v_mfma_f32_16x16x32_bf16 v[36:39], v[124:127], v[204:207], v[36:39]
v_add_f32 v238, v238, v242
v_cvt_pk_bf16_f32 v164, v242, v243
ds_read_b128 v[136:139], v248 offset:45056
v_mfma_f32_16x16x32_bf16 v[56:59], v[128:131], v[204:207], v[56:59]
v_add_f32 v238, v238, v243
s_barrier
ds_read_b64_tr_b16 v[220:221], v253 offset:24576
ds_read_b64_tr_b16 v[222:223], v253 offset:26624
ds_read_b64_tr_b16 v[224:225], v253 offset:28672
ds_read_b64_tr_b16 v[226:227], v253 offset:30720
ds_read_b64_tr_b16 v[228:229], v253 offset:32768
ds_read_b64_tr_b16 v[230:231], v253 offset:34816
s_waitcnt lgkmcnt(4)
v_mfma_f32_16x16x32_bf16 v[0:3], v[220:223], v[208:211], v[0:3]
ds_read_b64_tr_b16 v[120:121], v253 offset:36864
ds_read_b64_tr_b16 v[122:123], v253 offset:38912
s_waitcnt lgkmcnt(4)
v_mfma_f32_16x16x32_bf16 v[20:23], v[224:227], v[208:211], v[20:23]
ds_read_b128 v[200:203], v248 offset:46080
s_waitcnt lgkmcnt(3)
v_mfma_f32_16x16x32_bf16 v[40:43], v[228:231], v[208:211], v[40:43]
v_mfma_f32_16x16x32_bf16 v[4:7], v[220:223], v[212:215], v[4:7]
ds_read_b64_tr_b16 v[124:125], v253 offset:40960
ds_read_b64_tr_b16 v[126:127], v253 offset:43008
v_mfma_f32_16x16x32_bf16 v[24:27], v[224:227], v[212:215], v[24:27]
ds_read_b128 v[204:207], v248 offset:47104
v_mfma_f32_16x16x32_bf16 v[44:47], v[228:231], v[212:215], v[44:47]
v_mfma_f32_16x16x32_bf16 v[8:11], v[220:223], v[216:219], v[8:11]
ds_read_b64_tr_b16 v[128:129], v253 offset:45056
ds_read_b64_tr_b16 v[130:131], v253 offset:47104
v_mfma_f32_16x16x32_bf16 v[28:31], v[224:227], v[216:219], v[28:31]
ds_read_b128 v[208:211], v248 offset:48128
v_mfma_f32_16x16x32_bf16 v[48:51], v[228:231], v[216:219], v[48:51]
v_mfma_f32_16x16x32_bf16 v[12:15], v[220:223], v[132:135], v[12:15]
v_mfma_f32_16x16x32_bf16 v[32:35], v[224:227], v[132:135], v[32:35]
ds_read_b128 v[212:215], v248 offset:49152
v_mfma_f32_16x16x32_bf16 v[52:55], v[228:231], v[132:135], v[52:55]
v_mfma_f32_16x16x32_bf16 v[16:19], v[220:223], v[136:139], v[16:19]
v_mfma_f32_16x16x32_bf16 v[36:39], v[224:227], v[136:139], v[36:39]
ds_read_b128 v[216:219], v248 offset:50176
v_mfma_f32_16x16x32_bf16 v[56:59], v[228:231], v[136:139], v[56:59]
s_waitcnt lgkmcnt(0)
s_barrier
v_mfma_f32_16x16x32_bf16 v[0:3], v[120:123], v[200:203], v[0:3]
v_lshlrev_b32 v242, 16, v165
v_and_b32 v243, s36, v165
v_fma_f32 v242, v242, s35, v233
v_mfma_f32_16x16x32_bf16 v[20:23], v[124:127], v[200:203], v[20:23]
v_fma_f32 v243, v243, s35, v233
v_exp_f32 v242, v242
v_exp_f32 v243, v243
v_mfma_f32_16x16x32_bf16 v[40:43], v[128:131], v[200:203], v[40:43]
v_add_f32 v238, v238, v242
v_cvt_pk_bf16_f32 v165, v242, v243
v_add_f32 v238, v238, v243
v_mfma_f32_16x16x32_bf16 v[4:7], v[120:123], v[204:207], v[4:7]
v_lshlrev_b32 v244, 16, v166
v_and_b32 v245, s36, v166
v_fma_f32 v244, v244, s35, v233
v_mfma_f32_16x16x32_bf16 v[24:27], v[124:127], v[204:207], v[24:27]
v_fma_f32 v245, v245, s35, v233
v_exp_f32 v244, v244
v_exp_f32 v245, v245
v_mfma_f32_16x16x32_bf16 v[44:47], v[128:131], v[204:207], v[44:47]
v_add_f32 v238, v238, v244
v_cvt_pk_bf16_f32 v166, v244, v245
v_add_f32 v238, v238, v245
v_mfma_f32_16x16x32_bf16 v[8:11], v[120:123], v[208:211], v[8:11]
v_lshlrev_b32 v242, 16, v167
v_and_b32 v243, s36, v167
v_fma_f32 v242, v242, s35, v233
v_mfma_f32_16x16x32_bf16 v[28:31], v[124:127], v[208:211], v[28:31]
v_fma_f32 v243, v243, s35, v233
v_exp_f32 v242, v242
v_exp_f32 v243, v243
v_mfma_f32_16x16x32_bf16 v[48:51], v[128:131], v[208:211], v[48:51]
v_add_f32 v238, v238, v242
v_cvt_pk_bf16_f32 v167, v242, v243
v_add_f32 v238, v238, v243
v_mfma_f32_16x16x32_bf16 v[12:15], v[120:123], v[212:215], v[12:15]
v_lshlrev_b32 v244, 16, v168
v_and_b32 v245, s36, v168
v_fma_f32 v244, v244, s35, v234
v_mfma_f32_16x16x32_bf16 v[32:35], v[124:127], v[212:215], v[32:35]
v_fma_f32 v245, v245, s35, v234
v_exp_f32 v244, v244
v_exp_f32 v245, v245
v_mfma_f32_16x16x32_bf16 v[52:55], v[128:131], v[212:215], v[52:55]
v_add_f32 v239, v239, v244
v_cvt_pk_bf16_f32 v168, v244, v245
v_add_f32 v239, v239, v245
v_mfma_f32_16x16x32_bf16 v[16:19], v[120:123], v[216:219], v[16:19]
v_lshlrev_b32 v242, 16, v169
v_and_b32 v243, s36, v169
v_fma_f32 v242, v242, s35, v234
v_mfma_f32_16x16x32_bf16 v[36:39], v[124:127], v[216:219], v[36:39]
v_fma_f32 v243, v243, s35, v234
v_exp_f32 v242, v242
v_exp_f32 v243, v243
v_mfma_f32_16x16x32_bf16 v[56:59], v[128:131], v[216:219], v[56:59]
v_add_f32 v239, v239, v242
v_cvt_pk_bf16_f32 v169, v242, v243
v_add_f32 v239, v239, v243
ds_write_b128 v255, v[160:163] offset:0
ds_write_b128 v255, v[164:167] offset:1024
v_lshlrev_b32 v242, 16, v170
v_and_b32 v243, s36, v170
v_fma_f32 v242, v242, s35, v234
v_fma_f32 v243, v243, s35, v234
v_exp_f32 v242, v242
v_exp_f32 v243, v243
v_add_f32 v239, v239, v242
v_cvt_pk_bf16_f32 v170, v242, v243
v_add_f32 v239, v239, v243
v_lshlrev_b32 v244, 16, v171
v_and_b32 v245, s36, v171
v_fma_f32 v244, v244, s35, v234
v_fma_f32 v245, v245, s35, v234
v_exp_f32 v244, v244
v_exp_f32 v245, v245
v_add_f32 v239, v239, v244
v_cvt_pk_bf16_f32 v171, v244, v245
v_add_f32 v239, v239, v245
ds_write_b128 v255, v[168:171] offset:2048
v_lshlrev_b32 v242, 16, v172
v_and_b32 v243, s36, v172
v_fma_f32 v242, v242, s35, v235
v_fma_f32 v243, v243, s35, v235
v_exp_f32 v242, v242
v_exp_f32 v243, v243
v_add_f32 v240, v240, v242
v_cvt_pk_bf16_f32 v172, v242, v243
v_add_f32 v240, v240, v243
v_lshlrev_b32 v244, 16, v173
v_and_b32 v245, s36, v173
v_fma_f32 v244, v244, s35, v235
v_fma_f32 v245, v245, s35, v235
v_exp_f32 v244, v244
v_exp_f32 v245, v245
v_add_f32 v240, v240, v244
v_cvt_pk_bf16_f32 v173, v244, v245
v_add_f32 v240, v240, v245
v_lshlrev_b32 v242, 16, v174
v_and_b32 v243, s36, v174
v_fma_f32 v242, v242, s35, v235
v_fma_f32 v243, v243, s35, v235
v_exp_f32 v242, v242
v_exp_f32 v243, v243
v_add_f32 v240, v240, v242
v_cvt_pk_bf16_f32 v174, v242, v243
v_add_f32 v240, v240, v243
v_lshlrev_b32 v244, 16, v175
v_and_b32 v245, s36, v175
v_fma_f32 v244, v244, s35, v235
v_fma_f32 v245, v245, s35, v235
v_exp_f32 v244, v244
v_exp_f32 v245, v245
v_add_f32 v240, v240, v244
v_cvt_pk_bf16_f32 v175, v244, v245
v_add_f32 v240, v240, v245
ds_write_b128 v255, v[172:175] offset:3072
v_lshlrev_b32 v242, 16, v176
v_and_b32 v243, s36, v176
v_fma_f32 v242, v242, s35, v236
v_fma_f32 v243, v243, s35, v236
v_exp_f32 v242, v242
v_exp_f32 v243, v243
v_add_f32 v241, v241, v242
v_cvt_pk_bf16_f32 v176, v242, v243
v_add_f32 v241, v241, v243
v_lshlrev_b32 v244, 16, v177
v_and_b32 v245, s36, v177
v_fma_f32 v244, v244, s35, v236
v_fma_f32 v245, v245, s35, v236
v_exp_f32 v244, v244
v_exp_f32 v245, v245
v_add_f32 v241, v241, v244
v_cvt_pk_bf16_f32 v177, v244, v245
v_add_f32 v241, v241, v245
v_lshlrev_b32 v242, 16, v178
v_and_b32 v243, s36, v178
v_fma_f32 v242, v242, s35, v236
v_fma_f32 v243, v243, s35, v236
v_exp_f32 v242, v242
v_exp_f32 v243, v243
v_add_f32 v241, v241, v242
v_cvt_pk_bf16_f32 v178, v242, v243
v_add_f32 v241, v241, v243
v_lshlrev_b32 v244, 16, v179
v_and_b32 v245, s36, v179
v_fma_f32 v244, v244, s35, v236
v_fma_f32 v245, v245, s35, v236
v_exp_f32 v244, v244
v_exp_f32 v245, v245
v_add_f32 v241, v241, v244
v_cvt_pk_bf16_f32 v179, v244, v245
v_add_f32 v241, v241, v245
ds_write_b128 v255, v[176:179] offset:4096
s_waitcnt lgkmcnt(0)
s_barrier
ds_read_b64_tr_b16 v[220:221], v253 offset:49152
ds_read_b64_tr_b16 v[222:223], v253 offset:51200
ds_read_b128 v[132:135], v248 offset:30720
ds_read_b64_tr_b16 v[224:225], v253 offset:53248
ds_read_b64_tr_b16 v[226:227], v253 offset:55296
ds_read_b64_tr_b16 v[228:229], v253 offset:57344
ds_read_b64_tr_b16 v[230:231], v253 offset:59392
ds_read_b128 v[136:139], v248 offset:31744
ds_read_b128 v[200:203], v248 offset:32768
ds_read_b128 v[204:207], v248 offset:33792
ds_read_b128 v[208:211], v248 offset:34816
s_waitcnt lgkmcnt(8)
v_mfma_f32_16x16x32_bf16 v[0:3], v[220:223], v[132:135], v[0:3]
v_lshlrev_b32 v242, 16, v180
v_and_b32 v243, s36, v180
ds_read_b64_tr_b16 v[120:121], v246 offset:0
ds_read_b64_tr_b16 v[122:123], v246 offset:2048
s_waitcnt lgkmcnt(8)
v_mfma_f32_16x16x32_bf16 v[20:23], v[224:227], v[132:135], v[20:23]
v_fma_f32 v242, v242, s35, v232
ds_read_b128 v[212:215], v248 offset:35840
s_waitcnt lgkmcnt(7)
v_mfma_f32_16x16x32_bf16 v[40:43], v[228:231], v[132:135], v[40:43]
v_fma_f32 v243, v243, s35, v232
v_exp_f32 v242, v242
s_waitcnt lgkmcnt(6)
v_mfma_f32_16x16x32_bf16 v[4:7], v[220:223], v[136:139], v[4:7]
v_exp_f32 v243, v243
ds_read_b64_tr_b16 v[124:125], v246 offset:4096
ds_read_b64_tr_b16 v[126:127], v246 offset:6144
v_mfma_f32_16x16x32_bf16 v[24:27], v[224:227], v[136:139], v[24:27]
v_add_f32 v237, v237, v242
v_cvt_pk_bf16_f32 v180, v242, v243
ds_read_b128 v[216:219], v248 offset:36864
v_mfma_f32_16x16x32_bf16 v[44:47], v[228:231], v[136:139], v[44:47]
v_add_f32 v237, v237, v243
s_waitcnt lgkmcnt(8)
v_mfma_f32_16x16x32_bf16 v[8:11], v[220:223], v[200:203], v[8:11]
v_lshlrev_b32 v244, 16, v181
v_and_b32 v245, s36, v181
ds_read_b64_tr_b16 v[128:129], v246 offset:8192
ds_read_b64_tr_b16 v[130:131], v246 offset:10240
v_mfma_f32_16x16x32_bf16 v[28:31], v[224:227], v[200:203], v[28:31]
v_fma_f32 v244, v244, s35, v232
ds_read_b128 v[132:135], v248 offset:37888
v_mfma_f32_16x16x32_bf16 v[48:51], v[228:231], v[200:203], v[48:51]
v_fma_f32 v245, v245, s35, v232
v_exp_f32 v244, v244
s_waitcnt lgkmcnt(10)
v_mfma_f32_16x16x32_bf16 v[12:15], v[220:223], v[204:207], v[12:15]
v_exp_f32 v245, v245
v_mfma_f32_16x16x32_bf16 v[32:35], v[224:227], v[204:207], v[32:35]
v_add_f32 v237, v237, v244
v_cvt_pk_bf16_f32 v181, v244, v245
ds_read_b128 v[136:139], v248 offset:38912
v_mfma_f32_16x16x32_bf16 v[52:55], v[228:231], v[204:207], v[52:55]
v_add_f32 v237, v237, v245
s_waitcnt lgkmcnt(10)
v_mfma_f32_16x16x32_bf16 v[16:19], v[220:223], v[208:211], v[16:19]
v_lshlrev_b32 v242, 16, v182
v_and_b32 v243, s36, v182
v_mfma_f32_16x16x32_bf16 v[36:39], v[224:227], v[208:211], v[36:39]
v_fma_f32 v242, v242, s35, v232
ds_read_b128 v[200:203], v248 offset:39936
v_mfma_f32_16x16x32_bf16 v[56:59], v[228:231], v[208:211], v[56:59]
v_fma_f32 v243, v243, s35, v232
v_exp_f32 v242, v242
s_waitcnt lgkmcnt(2)
v_mfma_f32_16x16x32_bf16 v[0:3], v[120:123], v[212:215], v[0:3]
v_exp_f32 v243, v243
v_mfma_f32_16x16x32_bf16 v[20:23], v[124:127], v[212:215], v[20:23]
v_add_f32 v237, v237, v242
v_cvt_pk_bf16_f32 v182, v242, v243
ds_read_b128 v[204:207], v248 offset:40960
v_mfma_f32_16x16x32_bf16 v[40:43], v[128:131], v[212:215], v[40:43]
v_add_f32 v237, v237, v243
v_mfma_f32_16x16x32_bf16 v[4:7], v[120:123], v[216:219], v[4:7]
v_lshlrev_b32 v244, 16, v183
v_and_b32 v245, s36, v183
v_mfma_f32_16x16x32_bf16 v[24:27], v[124:127], v[216:219], v[24:27]
v_fma_f32 v244, v244, s35, v232
ds_read_b128 v[208:211], v248 offset:41984
v_mfma_f32_16x16x32_bf16 v[44:47], v[128:131], v[216:219], v[44:47]
v_fma_f32 v245, v245, s35, v232
v_exp_f32 v244, v244
v_mfma_f32_16x16x32_bf16 v[8:11], v[120:123], v[132:135], v[8:11]
v_exp_f32 v245, v245
v_mfma_f32_16x16x32_bf16 v[28:31], v[124:127], v[132:135], v[28:31]
v_add_f32 v237, v237, v244
v_cvt_pk_bf16_f32 v183, v244, v245
ds_read_b128 v[212:215], v248 offset:43008
v_mfma_f32_16x16x32_bf16 v[48:51], v[128:131], v[132:135], v[48:51]
v_add_f32 v237, v237, v245
s_waitcnt lgkmcnt(3)
v_mfma_f32_16x16x32_bf16 v[12:15], v[120:123], v[136:139], v[12:15]
v_lshlrev_b32 v242, 16, v184
v_and_b32 v243, s36, v184
v_mfma_f32_16x16x32_bf16 v[32:35], v[124:127], v[136:139], v[32:35]
v_fma_f32 v242, v242, s35, v233
ds_read_b128 v[216:219], v248 offset:44032
v_mfma_f32_16x16x32_bf16 v[52:55], v[128:131], v[136:139], v[52:55]
v_fma_f32 v243, v243, s35, v233
v_exp_f32 v242, v242
v_mfma_f32_16x16x32_bf16 v[16:19], v[120:123], v[200:203], v[16:19]
v_exp_f32 v243, v243
v_mfma_f32_16x16x32_bf16 v[36:39], v[124:127], v[200:203], v[36:39]
v_add_f32 v238, v238, v242
v_cvt_pk_bf16_f32 v184, v242, v243
ds_read_b128 v[132:135], v248 offset:45056
v_mfma_f32_16x16x32_bf16 v[56:59], v[128:131], v[200:203], v[56:59]
v_add_f32 v238, v238, v243
s_barrier
ds_read_b64_tr_b16 v[220:221], v246 offset:12288
ds_read_b64_tr_b16 v[222:223], v246 offset:14336
ds_read_b64_tr_b16 v[224:225], v246 offset:16384
ds_read_b64_tr_b16 v[226:227], v246 offset:18432
ds_read_b64_tr_b16 v[228:229], v246 offset:20480
ds_read_b64_tr_b16 v[230:231], v246 offset:22528
s_waitcnt lgkmcnt(4)
v_mfma_f32_16x16x32_bf16 v[0:3], v[220:223], v[204:207], v[0:3]
ds_read_b64_tr_b16 v[120:121], v246 offset:24576
ds_read_b64_tr_b16 v[122:123], v246 offset:26624
s_waitcnt lgkmcnt(4)
v_mfma_f32_16x16x32_bf16 v[20:23], v[224:227], v[204:207], v[20:23]
ds_read_b128 v[136:139], v248 offset:46080
s_waitcnt lgkmcnt(3)
v_mfma_f32_16x16x32_bf16 v[40:43], v[228:231], v[204:207], v[40:43]
v_mfma_f32_16x16x32_bf16 v[4:7], v[220:223], v[208:211], v[4:7]
ds_read_b64_tr_b16 v[124:125], v246 offset:28672
ds_read_b64_tr_b16 v[126:127], v246 offset:30720
v_mfma_f32_16x16x32_bf16 v[24:27], v[224:227], v[208:211], v[24:27]
ds_read_b128 v[200:203], v248 offset:47104
v_mfma_f32_16x16x32_bf16 v[44:47], v[228:231], v[208:211], v[44:47]
v_mfma_f32_16x16x32_bf16 v[8:11], v[220:223], v[212:215], v[8:11]
ds_read_b64_tr_b16 v[128:129], v246 offset:32768
ds_read_b64_tr_b16 v[130:131], v246 offset:34816
v_mfma_f32_16x16x32_bf16 v[28:31], v[224:227], v[212:215], v[28:31]
ds_read_b128 v[204:207], v248 offset:48128
v_mfma_f32_16x16x32_bf16 v[48:51], v[228:231], v[212:215], v[48:51]
v_mfma_f32_16x16x32_bf16 v[12:15], v[220:223], v[216:219], v[12:15]
v_mfma_f32_16x16x32_bf16 v[32:35], v[224:227], v[216:219], v[32:35]
ds_read_b128 v[208:211], v248 offset:49152
v_mfma_f32_16x16x32_bf16 v[52:55], v[228:231], v[216:219], v[52:55]
v_mfma_f32_16x16x32_bf16 v[16:19], v[220:223], v[132:135], v[16:19]
v_mfma_f32_16x16x32_bf16 v[36:39], v[224:227], v[132:135], v[36:39]
ds_read_b128 v[212:215], v248 offset:50176
v_mfma_f32_16x16x32_bf16 v[56:59], v[228:231], v[132:135], v[56:59]
s_waitcnt lgkmcnt(0)
s_barrier
v_mfma_f32_16x16x32_bf16 v[0:3], v[120:123], v[136:139], v[0:3]
v_lshlrev_b32 v242, 16, v185
v_and_b32 v243, s36, v185
v_fma_f32 v242, v242, s35, v233
v_mfma_f32_16x16x32_bf16 v[20:23], v[124:127], v[136:139], v[20:23]
v_fma_f32 v243, v243, s35, v233
v_exp_f32 v242, v242
v_exp_f32 v243, v243
v_mfma_f32_16x16x32_bf16 v[40:43], v[128:131], v[136:139], v[40:43]
v_add_f32 v238, v238, v242
v_cvt_pk_bf16_f32 v185, v242, v243
v_add_f32 v238, v238, v243
v_mfma_f32_16x16x32_bf16 v[4:7], v[120:123], v[200:203], v[4:7]
v_lshlrev_b32 v244, 16, v186
v_and_b32 v245, s36, v186
v_fma_f32 v244, v244, s35, v233
v_mfma_f32_16x16x32_bf16 v[24:27], v[124:127], v[200:203], v[24:27]
v_fma_f32 v245, v245, s35, v233
v_exp_f32 v244, v244
v_exp_f32 v245, v245
v_mfma_f32_16x16x32_bf16 v[44:47], v[128:131], v[200:203], v[44:47]
v_add_f32 v238, v238, v244
v_cvt_pk_bf16_f32 v186, v244, v245
v_add_f32 v238, v238, v245
v_mfma_f32_16x16x32_bf16 v[8:11], v[120:123], v[204:207], v[8:11]
v_lshlrev_b32 v242, 16, v187
v_and_b32 v243, s36, v187
v_fma_f32 v242, v242, s35, v233
v_mfma_f32_16x16x32_bf16 v[28:31], v[124:127], v[204:207], v[28:31]
v_fma_f32 v243, v243, s35, v233
v_exp_f32 v242, v242
v_exp_f32 v243, v243
v_mfma_f32_16x16x32_bf16 v[48:51], v[128:131], v[204:207], v[48:51]
v_add_f32 v238, v238, v242
v_cvt_pk_bf16_f32 v187, v242, v243
v_add_f32 v238, v238, v243
v_mfma_f32_16x16x32_bf16 v[12:15], v[120:123], v[208:211], v[12:15]
v_lshlrev_b32 v244, 16, v188
v_and_b32 v245, s36, v188
v_fma_f32 v244, v244, s35, v234
v_mfma_f32_16x16x32_bf16 v[32:35], v[124:127], v[208:211], v[32:35]
v_fma_f32 v245, v245, s35, v234
v_exp_f32 v244, v244
v_exp_f32 v245, v245
v_mfma_f32_16x16x32_bf16 v[52:55], v[128:131], v[208:211], v[52:55]
v_add_f32 v239, v239, v244
v_cvt_pk_bf16_f32 v188, v244, v245
v_add_f32 v239, v239, v245
v_mfma_f32_16x16x32_bf16 v[16:19], v[120:123], v[212:215], v[16:19]
v_lshlrev_b32 v242, 16, v189
v_and_b32 v243, s36, v189
v_fma_f32 v242, v242, s35, v234
v_mfma_f32_16x16x32_bf16 v[36:39], v[124:127], v[212:215], v[36:39]
v_fma_f32 v243, v243, s35, v234
v_exp_f32 v242, v242
v_exp_f32 v243, v243
v_mfma_f32_16x16x32_bf16 v[56:59], v[128:131], v[212:215], v[56:59]
v_add_f32 v239, v239, v242
v_cvt_pk_bf16_f32 v189, v242, v243
v_add_f32 v239, v239, v243
ds_write_b128 v255, v[180:183] offset:0
ds_write_b128 v255, v[184:187] offset:1024
v_lshlrev_b32 v242, 16, v190
v_and_b32 v243, s36, v190
v_fma_f32 v242, v242, s35, v234
v_fma_f32 v243, v243, s35, v234
v_exp_f32 v242, v242
v_exp_f32 v243, v243
v_add_f32 v239, v239, v242
v_cvt_pk_bf16_f32 v190, v242, v243
v_add_f32 v239, v239, v243
v_lshlrev_b32 v244, 16, v191
v_and_b32 v245, s36, v191
v_fma_f32 v244, v244, s35, v234
v_fma_f32 v245, v245, s35, v234
v_exp_f32 v244, v244
v_exp_f32 v245, v245
v_add_f32 v239, v239, v244
v_cvt_pk_bf16_f32 v191, v244, v245
v_add_f32 v239, v239, v245
ds_write_b128 v255, v[188:191] offset:2048
v_lshlrev_b32 v242, 16, v192
v_and_b32 v243, s36, v192
v_fma_f32 v242, v242, s35, v235
v_fma_f32 v243, v243, s35, v235
v_exp_f32 v242, v242
v_exp_f32 v243, v243
v_add_f32 v240, v240, v242
v_cvt_pk_bf16_f32 v192, v242, v243
v_add_f32 v240, v240, v243
v_lshlrev_b32 v244, 16, v193
v_and_b32 v245, s36, v193
v_fma_f32 v244, v244, s35, v235
v_fma_f32 v245, v245, s35, v235
v_exp_f32 v244, v244
v_exp_f32 v245, v245
v_add_f32 v240, v240, v244
v_cvt_pk_bf16_f32 v193, v244, v245
v_add_f32 v240, v240, v245
v_lshlrev_b32 v242, 16, v194
v_and_b32 v243, s36, v194
v_fma_f32 v242, v242, s35, v235
v_fma_f32 v243, v243, s35, v235
v_exp_f32 v242, v242
v_exp_f32 v243, v243
v_add_f32 v240, v240, v242
v_cvt_pk_bf16_f32 v194, v242, v243
v_add_f32 v240, v240, v243
v_lshlrev_b32 v244, 16, v195
v_and_b32 v245, s36, v195
v_fma_f32 v244, v244, s35, v235
v_fma_f32 v245, v245, s35, v235
v_exp_f32 v244, v244
v_exp_f32 v245, v245
v_add_f32 v240, v240, v244
v_cvt_pk_bf16_f32 v195, v244, v245
v_add_f32 v240, v240, v245
ds_write_b128 v255, v[192:195] offset:3072
v_lshlrev_b32 v242, 16, v196
v_and_b32 v243, s36, v196
v_fma_f32 v242, v242, s35, v236
v_fma_f32 v243, v243, s35, v236
v_exp_f32 v242, v242
v_exp_f32 v243, v243
v_add_f32 v241, v241, v242
v_cvt_pk_bf16_f32 v196, v242, v243
v_add_f32 v241, v241, v243
v_lshlrev_b32 v244, 16, v197
v_and_b32 v245, s36, v197
v_fma_f32 v244, v244, s35, v236
v_fma_f32 v245, v245, s35, v236
v_exp_f32 v244, v244
v_exp_f32 v245, v245
v_add_f32 v241, v241, v244
v_cvt_pk_bf16_f32 v197, v244, v245
v_add_f32 v241, v241, v245
v_lshlrev_b32 v242, 16, v198
v_and_b32 v243, s36, v198
v_fma_f32 v242, v242, s35, v236
v_fma_f32 v243, v243, s35, v236
v_exp_f32 v242, v242
v_exp_f32 v243, v243
v_add_f32 v241, v241, v242
v_cvt_pk_bf16_f32 v198, v242, v243
v_add_f32 v241, v241, v243
v_lshlrev_b32 v244, 16, v199
v_and_b32 v245, s36, v199
v_fma_f32 v244, v244, s35, v236
v_fma_f32 v245, v245, s35, v236
v_exp_f32 v244, v244
v_exp_f32 v245, v245
v_add_f32 v241, v241, v244
v_cvt_pk_bf16_f32 v199, v244, v245
v_add_f32 v241, v241, v245
ds_write_b128 v255, v[196:199] offset:4096
s_waitcnt lgkmcnt(0)
s_barrier
ds_read_b64_tr_b16 v[220:221], v246 offset:36864
ds_read_b64_tr_b16 v[222:223], v246 offset:38912
ds_read_b128 v[216:219], v248 offset:30720
ds_read_b64_tr_b16 v[224:225], v246 offset:40960
ds_read_b64_tr_b16 v[226:227], v246 offset:43008
ds_read_b64_tr_b16 v[228:229], v246 offset:45056
ds_read_b64_tr_b16 v[230:231], v246 offset:47104
ds_read_b128 v[132:135], v248 offset:31744
ds_read_b128 v[136:139], v248 offset:32768
ds_read_b128 v[200:203], v248 offset:33792
ds_read_b128 v[204:207], v248 offset:34816
s_waitcnt lgkmcnt(8)
v_mfma_f32_16x16x32_bf16 v[0:3], v[220:223], v[216:219], v[0:3]
ds_read_b64_tr_b16 v[120:121], v253 offset:0
ds_read_b64_tr_b16 v[122:123], v253 offset:2048
s_waitcnt lgkmcnt(8)
v_mfma_f32_16x16x32_bf16 v[20:23], v[224:227], v[216:219], v[20:23]
ds_read_b128 v[208:211], v248 offset:35840
s_waitcnt lgkmcnt(7)
v_mfma_f32_16x16x32_bf16 v[40:43], v[228:231], v[216:219], v[40:43]
s_waitcnt lgkmcnt(6)
v_mfma_f32_16x16x32_bf16 v[4:7], v[220:223], v[132:135], v[4:7]
ds_read_b64_tr_b16 v[124:125], v253 offset:4096
ds_read_b64_tr_b16 v[126:127], v253 offset:6144
v_mfma_f32_16x16x32_bf16 v[24:27], v[224:227], v[132:135], v[24:27]
ds_read_b128 v[212:215], v248 offset:36864
v_mfma_f32_16x16x32_bf16 v[44:47], v[228:231], v[132:135], v[44:47]
s_waitcnt lgkmcnt(8)
v_mfma_f32_16x16x32_bf16 v[8:11], v[220:223], v[136:139], v[8:11]
ds_read_b64_tr_b16 v[128:129], v253 offset:8192
ds_read_b64_tr_b16 v[130:131], v253 offset:10240
v_mfma_f32_16x16x32_bf16 v[28:31], v[224:227], v[136:139], v[28:31]
ds_read_b128 v[216:219], v248 offset:37888
v_mfma_f32_16x16x32_bf16 v[48:51], v[228:231], v[136:139], v[48:51]
s_waitcnt lgkmcnt(10)
v_mfma_f32_16x16x32_bf16 v[12:15], v[220:223], v[200:203], v[12:15]
v_mfma_f32_16x16x32_bf16 v[32:35], v[224:227], v[200:203], v[32:35]
ds_read_b128 v[132:135], v248 offset:38912
v_mfma_f32_16x16x32_bf16 v[52:55], v[228:231], v[200:203], v[52:55]
s_waitcnt lgkmcnt(10)
v_mfma_f32_16x16x32_bf16 v[16:19], v[220:223], v[204:207], v[16:19]
v_mfma_f32_16x16x32_bf16 v[36:39], v[224:227], v[204:207], v[36:39]
ds_read_b128 v[136:139], v248 offset:39936
v_mfma_f32_16x16x32_bf16 v[56:59], v[228:231], v[204:207], v[56:59]
s_waitcnt lgkmcnt(2)
v_mfma_f32_16x16x32_bf16 v[0:3], v[120:123], v[208:211], v[0:3]
v_mfma_f32_16x16x32_bf16 v[20:23], v[124:127], v[208:211], v[20:23]
ds_read_b128 v[200:203], v248 offset:40960
v_mfma_f32_16x16x32_bf16 v[40:43], v[128:131], v[208:211], v[40:43]
v_mfma_f32_16x16x32_bf16 v[4:7], v[120:123], v[212:215], v[4:7]
v_mfma_f32_16x16x32_bf16 v[24:27], v[124:127], v[212:215], v[24:27]
ds_read_b128 v[204:207], v248 offset:41984
v_mfma_f32_16x16x32_bf16 v[44:47], v[128:131], v[212:215], v[44:47]
v_mfma_f32_16x16x32_bf16 v[8:11], v[120:123], v[216:219], v[8:11]
v_mfma_f32_16x16x32_bf16 v[28:31], v[124:127], v[216:219], v[28:31]
ds_read_b128 v[208:211], v248 offset:43008
v_mfma_f32_16x16x32_bf16 v[48:51], v[128:131], v[216:219], v[48:51]
s_waitcnt lgkmcnt(3)
v_mfma_f32_16x16x32_bf16 v[12:15], v[120:123], v[132:135], v[12:15]
v_mfma_f32_16x16x32_bf16 v[32:35], v[124:127], v[132:135], v[32:35]
ds_read_b128 v[212:215], v248 offset:44032
v_mfma_f32_16x16x32_bf16 v[52:55], v[128:131], v[132:135], v[52:55]
v_mfma_f32_16x16x32_bf16 v[16:19], v[120:123], v[136:139], v[16:19]
v_mfma_f32_16x16x32_bf16 v[36:39], v[124:127], v[136:139], v[36:39]
ds_read_b128 v[216:219], v248 offset:45056
v_mfma_f32_16x16x32_bf16 v[56:59], v[128:131], v[136:139], v[56:59]
v_mov_b32 v140, v237
v_mov_b32 v141, v238
v_mov_b32 v142, v239
v_mov_b32 v143, v240
v_mov_b32 v144, v241
s_nop 1
v_permlane32_swap_b32 v237, v140
v_permlane32_swap_b32 v238, v141
v_permlane32_swap_b32 v239, v142
v_permlane32_swap_b32 v240, v143
v_permlane32_swap_b32 v241, v144
s_nop 1
v_add_f32 v237, v237, v140
v_add_f32 v238, v238, v141
v_add_f32 v239, v239, v142
v_add_f32 v240, v240, v143
v_add_f32 v241, v241, v144
v_mov_b32 v140, v237
v_mov_b32 v141, v238
v_mov_b32 v142, v239
v_mov_b32 v143, v240
v_mov_b32 v144, v241
s_nop 1
v_permlane16_swap_b32 v237, v140
v_permlane16_swap_b32 v238, v141
v_permlane16_swap_b32 v239, v142
v_permlane16_swap_b32 v240, v143
v_permlane16_swap_b32 v241, v144
s_nop 1
v_add_f32 v237, v237, v140
v_add_f32 v238, v238, v141
v_add_f32 v239, v239, v142
v_add_f32 v240, v240, v143
v_add_f32 v241, v241, v144
ds_write_b32 v250, v237 offset:0
ds_write_b32 v250, v238 offset:256
ds_write_b32 v250, v239 offset:512
ds_write_b32 v250, v240 offset:768
ds_write_b32 v250, v241 offset:1024
s_waitcnt lgkmcnt(0)
s_barrier
ds_read_b64_tr_b16 v[220:221], v253 offset:12288
ds_read_b64_tr_b16 v[222:223], v253 offset:14336
ds_read_b64_tr_b16 v[224:225], v253 offset:16384
ds_read_b64_tr_b16 v[226:227], v253 offset:18432
ds_read_b64_tr_b16 v[228:229], v253 offset:20480
ds_read_b64_tr_b16 v[230:231], v253 offset:22528
s_waitcnt lgkmcnt(4)
v_mfma_f32_16x16x32_bf16 v[0:3], v[220:223], v[200:203], v[0:3]
ds_read_b64_tr_b16 v[120:121], v253 offset:24576
ds_read_b64_tr_b16 v[122:123], v253 offset:26624
s_waitcnt lgkmcnt(4)
v_mfma_f32_16x16x32_bf16 v[20:23], v[224:227], v[200:203], v[20:23]
ds_read_b128 v[132:135], v248 offset:46080
s_waitcnt lgkmcnt(3)
v_mfma_f32_16x16x32_bf16 v[40:43], v[228:231], v[200:203], v[40:43]
v_mfma_f32_16x16x32_bf16 v[4:7], v[220:223], v[204:207], v[4:7]
ds_read_b64_tr_b16 v[124:125], v253 offset:28672
ds_read_b64_tr_b16 v[126:127], v253 offset:30720
v_mfma_f32_16x16x32_bf16 v[24:27], v[224:227], v[204:207], v[24:27]
ds_read_b128 v[136:139], v248 offset:47104
v_mfma_f32_16x16x32_bf16 v[44:47], v[228:231], v[204:207], v[44:47]
v_mfma_f32_16x16x32_bf16 v[8:11], v[220:223], v[208:211], v[8:11]
ds_read_b64_tr_b16 v[128:129], v253 offset:32768
ds_read_b64_tr_b16 v[130:131], v253 offset:34816
v_mfma_f32_16x16x32_bf16 v[28:31], v[224:227], v[208:211], v[28:31]
ds_read_b128 v[200:203], v248 offset:48128
v_mfma_f32_16x16x32_bf16 v[48:51], v[228:231], v[208:211], v[48:51]
v_mfma_f32_16x16x32_bf16 v[12:15], v[220:223], v[212:215], v[12:15]
v_mfma_f32_16x16x32_bf16 v[32:35], v[224:227], v[212:215], v[32:35]
ds_read_b128 v[204:207], v248 offset:49152
v_mfma_f32_16x16x32_bf16 v[52:55], v[228:231], v[212:215], v[52:55]
v_mfma_f32_16x16x32_bf16 v[16:19], v[220:223], v[216:219], v[16:19]
v_mfma_f32_16x16x32_bf16 v[36:39], v[224:227], v[216:219], v[36:39]
ds_read_b128 v[208:211], v248 offset:50176
v_mfma_f32_16x16x32_bf16 v[56:59], v[228:231], v[216:219], v[56:59]
s_waitcnt lgkmcnt(0)
s_barrier
v_mfma_f32_16x16x32_bf16 v[0:3], v[120:123], v[132:135], v[0:3]
v_mfma_f32_16x16x32_bf16 v[20:23], v[124:127], v[132:135], v[20:23]
v_mfma_f32_16x16x32_bf16 v[40:43], v[128:131], v[132:135], v[40:43]
v_mfma_f32_16x16x32_bf16 v[4:7], v[120:123], v[136:139], v[4:7]
v_mfma_f32_16x16x32_bf16 v[24:27], v[124:127], v[136:139], v[24:27]
v_mfma_f32_16x16x32_bf16 v[44:47], v[128:131], v[136:139], v[44:47]
v_mfma_f32_16x16x32_bf16 v[8:11], v[120:123], v[200:203], v[8:11]
v_mfma_f32_16x16x32_bf16 v[28:31], v[124:127], v[200:203], v[28:31]
v_mfma_f32_16x16x32_bf16 v[48:51], v[128:131], v[200:203], v[48:51]
v_mfma_f32_16x16x32_bf16 v[12:15], v[120:123], v[204:207], v[12:15]
v_mfma_f32_16x16x32_bf16 v[32:35], v[124:127], v[204:207], v[32:35]
v_mfma_f32_16x16x32_bf16 v[52:55], v[128:131], v[204:207], v[52:55]
v_mfma_f32_16x16x32_bf16 v[16:19], v[120:123], v[208:211], v[16:19]
v_mfma_f32_16x16x32_bf16 v[36:39], v[124:127], v[208:211], v[36:39]
v_mfma_f32_16x16x32_bf16 v[56:59], v[128:131], v[208:211], v[56:59]
v_and_b32 v242, -16, v250
ds_read_b128 v[140:143], v242 offset:0
ds_read_b128 v[144:147], v242 offset:256
ds_read_b128 v[148:151], v242 offset:512
ds_read_b128 v[152:155], v242 offset:768
ds_read_b128 v[156:159], v242 offset:1024
s_waitcnt lgkmcnt(4)
v_add_f32 v140, v140, v141
v_add_f32 v142, v142, v143
v_add_f32 v140, v140, v142
v_rcp_f32 v237, v140
s_waitcnt lgkmcnt(3)
v_add_f32 v144, v144, v145
v_add_f32 v146, v146, v147
v_add_f32 v144, v144, v146
v_rcp_f32 v238, v144
s_waitcnt lgkmcnt(2)
v_add_f32 v148, v148, v149
v_add_f32 v150, v150, v151
v_add_f32 v148, v148, v150
v_rcp_f32 v239, v148
s_waitcnt lgkmcnt(1)
v_add_f32 v152, v152, v153
v_add_f32 v154, v154, v155
v_add_f32 v152, v152, v154
v_rcp_f32 v240, v152
s_waitcnt lgkmcnt(0)
v_add_f32 v156, v156, v157
v_add_f32 v158, v158, v159
v_add_f32 v156, v156, v158
v_rcp_f32 v241, v156
s_nop 7
v_mul_f32 v0, v0, v237
v_mul_f32 v1, v1, v237
v_mul_f32 v2, v2, v237
v_mul_f32 v3, v3, v237
v_cvt_pk_bf16_f32 v170, v0, v1
v_cvt_pk_bf16_f32 v171, v2, v3
ds_write_b64 v249, v[170:171] offset:30720
v_mul_f32 v4, v4, v238
v_mul_f32 v5, v5, v238
v_mul_f32 v6, v6, v238
v_mul_f32 v7, v7, v238
v_cvt_pk_bf16_f32 v172, v4, v5
v_cvt_pk_bf16_f32 v173, v6, v7
ds_write_b64 v249, v[172:173] offset:31744
v_mul_f32 v8, v8, v239
v_mul_f32 v9, v9, v239
v_mul_f32 v10, v10, v239
v_mul_f32 v11, v11, v239
v_cvt_pk_bf16_f32 v174, v8, v9
v_cvt_pk_bf16_f32 v175, v10, v11
ds_write_b64 v249, v[174:175] offset:32768
v_mul_f32 v12, v12, v240
v_mul_f32 v13, v13, v240
v_mul_f32 v14, v14, v240
v_mul_f32 v15, v15, v240
v_cvt_pk_bf16_f32 v176, v12, v13
v_cvt_pk_bf16_f32 v177, v14, v15
ds_write_b64 v249, v[176:177] offset:33792
v_mul_f32 v16, v16, v241
v_mul_f32 v17, v17, v241
v_mul_f32 v18, v18, v241
v_mul_f32 v19, v19, v241
v_cvt_pk_bf16_f32 v178, v16, v17
v_cvt_pk_bf16_f32 v179, v18, v19
ds_write_b64 v249, v[178:179] offset:34816
v_mul_f32 v20, v20, v237
v_mul_f32 v21, v21, v237
v_mul_f32 v22, v22, v237
v_mul_f32 v23, v23, v237
v_cvt_pk_bf16_f32 v180, v20, v21
v_cvt_pk_bf16_f32 v181, v22, v23
ds_write_b64 v249, v[180:181] offset:40960
v_mul_f32 v24, v24, v238
v_mul_f32 v25, v25, v238
v_mul_f32 v26, v26, v238
v_mul_f32 v27, v27, v238
v_cvt_pk_bf16_f32 v182, v24, v25
v_cvt_pk_bf16_f32 v183, v26, v27
ds_write_b64 v249, v[182:183] offset:41984
v_mul_f32 v28, v28, v239
v_mul_f32 v29, v29, v239
v_mul_f32 v30, v30, v239
v_mul_f32 v31, v31, v239
v_cvt_pk_bf16_f32 v184, v28, v29
v_cvt_pk_bf16_f32 v185, v30, v31
ds_write_b64 v249, v[184:185] offset:43008
v_mul_f32 v32, v32, v240
v_mul_f32 v33, v33, v240
v_mul_f32 v34, v34, v240
v_mul_f32 v35, v35, v240
v_cvt_pk_bf16_f32 v186, v32, v33
v_cvt_pk_bf16_f32 v187, v34, v35
ds_write_b64 v249, v[186:187] offset:44032
v_mul_f32 v36, v36, v241
v_mul_f32 v37, v37, v241
v_mul_f32 v38, v38, v241
v_mul_f32 v39, v39, v241
v_cvt_pk_bf16_f32 v188, v36, v37
v_cvt_pk_bf16_f32 v189, v38, v39
ds_write_b64 v249, v[188:189] offset:45056
v_mul_f32 v40, v40, v237
v_mul_f32 v41, v41, v237
v_mul_f32 v42, v42, v237
v_mul_f32 v43, v43, v237
v_cvt_pk_bf16_f32 v190, v40, v41
v_cvt_pk_bf16_f32 v191, v42, v43
ds_write_b64 v249, v[190:191] offset:51200
v_mul_f32 v44, v44, v238
v_mul_f32 v45, v45, v238
v_mul_f32 v46, v46, v238
v_mul_f32 v47, v47, v238
v_cvt_pk_bf16_f32 v192, v44, v45
v_cvt_pk_bf16_f32 v193, v46, v47
ds_write_b64 v249, v[192:193] offset:52224
v_mul_f32 v48, v48, v239
v_mul_f32 v49, v49, v239
v_mul_f32 v50, v50, v239
v_mul_f32 v51, v51, v239
v_cvt_pk_bf16_f32 v194, v48, v49
v_cvt_pk_bf16_f32 v195, v50, v51
ds_write_b64 v249, v[194:195] offset:53248
v_mul_f32 v52, v52, v240
v_mul_f32 v53, v53, v240
v_mul_f32 v54, v54, v240
v_mul_f32 v55, v55, v240
v_cvt_pk_bf16_f32 v196, v52, v53
v_cvt_pk_bf16_f32 v197, v54, v55
ds_write_b64 v249, v[196:197] offset:54272
v_mul_f32 v56, v56, v241
v_mul_f32 v57, v57, v241
v_mul_f32 v58, v58, v241
v_mul_f32 v59, v59, v241
v_cvt_pk_bf16_f32 v198, v56, v57
v_cvt_pk_bf16_f32 v199, v58, v59
ds_write_b64 v249, v[198:199] offset:55296
s_waitcnt lgkmcnt(0)
v_subrev_u32 v0, 100352, v248
v_lshrrev_b32 v0, 4, v0
v_lshrrev_b32 v8, 3, v0
v_and_b32 v5, 7, v0
v_and_b32 v6, 6, v8
v_xor_b32 v9, v5, v6
v_lshlrev_b32 v9, 4, v9
s_lshl_b32 s47, s75, 10
s_and_b32 s78, s75, 1
s_lshl_b32 s78, s78, 4
s_and_b32 s79, s75, 2
s_lshl_b32 s79, s79, 1
s_add_u32 s78, s78, s79
v_and_b32 v12, 4, v8
v_add_u32 v12, v12, v8
v_add_u32 v12, s78, v12
v_mul_u32_u24 v11, 1280, v12
v_add_u32 v236, v11, v9
s_barrier
s_barrier
s_add_u32 m0, s47, 0x15000
s_add_u32 s32, s30, 0xfffce280
buffer_load_dwordx4 v236, s[16:19], s32 offen lds
s_add_u32 m0, s47, 0x16000
s_add_u32 s32, s30, 0xfffd8200
buffer_load_dwordx4 v236, s[16:19], s32 offen lds
s_add_u32 m0, s47, 0x17000
s_add_u32 s32, s30, 0xfffd8280
buffer_load_dwordx4 v236, s[16:19], s32 offen lds
s_add_u32 m0, s47, 0x18000
s_add_u32 s32, s30, 0xfffe2200
buffer_load_dwordx4 v236, s[16:19], s32 offen lds
s_add_u32 m0, s47, 0x19000
s_add_u32 s32, s30, 0xfffe2280
buffer_load_dwordx4 v236, s[16:19], s32 offen lds
s_add_u32 m0, s47, 0x1a000
s_add_u32 s32, s30, 0xfffec200
buffer_load_dwordx4 v236, s[16:19], s32 offen lds
s_barrier
s_add_u32 m0, s47, 0x0
s_add_u32 s32, s30, 0xfffec280
buffer_load_dwordx4 v236, s[16:19], s32 offen lds
s_add_u32 m0, s47, 0x1000
s_add_u32 s32, s30, 0xffff6200
buffer_load_dwordx4 v236, s[16:19], s32 offen lds
s_add_u32 m0, s47, 0x2000
s_add_u32 s32, s30, 0xffff6280
buffer_load_dwordx4 v236, s[16:19], s32 offen lds
s_add_u32 m0, s47, 0x3000
s_add_u32 s32, s30, 0xfffc4300
buffer_load_dwordx4 v236, s[16:19], s32 offen lds
s_add_u32 m0, s47, 0x4000
s_add_u32 s32, s30, 0xfffc4380
buffer_load_dwordx4 v236, s[16:19], s32 offen lds
s_add_u32 m0, s47, 0x5000
s_add_u32 s32, s30, 0xfffce300
buffer_load_dwordx4 v236, s[16:19], s32 offen lds
s_barrier
s_add_u32 m0, s47, 0x6000
s_add_u32 s32, s30, 0xfffce380
buffer_load_dwordx4 v236, s[16:19], s32 offen lds
s_add_u32 m0, s47, 0x7000
s_add_u32 s32, s30, 0xfffd8300
buffer_load_dwordx4 v236, s[16:19], s32 offen lds
s_add_u32 m0, s47, 0x8000
s_add_u32 s32, s30, 0xfffd8380
buffer_load_dwordx4 v236, s[16:19], s32 offen lds
s_add_u32 m0, s47, 0x9000
s_add_u32 s32, s30, 0xfffe2300
buffer_load_dwordx4 v236, s[16:19], s32 offen lds
s_add_u32 m0, s47, 0xa000
s_add_u32 s32, s30, 0xfffe2380
buffer_load_dwordx4 v236, s[16:19], s32 offen lds
s_add_u32 m0, s47, 0xb000
s_add_u32 s32, s30, 0xfffec300
buffer_load_dwordx4 v236, s[16:19], s32 offen lds
s_waitcnt vmcnt(12)
s_barrier
s_add_u32 m0, s47, 0xc000
s_add_u32 s32, s30, 0xfffec380
buffer_load_dwordx4 v236, s[16:19], s32 offen lds
s_add_u32 m0, s47, 0xd000
s_add_u32 s32, s30, 0xffff6300
buffer_load_dwordx4 v236, s[16:19], s32 offen lds
s_add_u32 m0, s47, 0xe000
s_add_u32 s32, s30, 0xffff6380
buffer_load_dwordx4 v236, s[16:19], s32 offen lds
s_add_u32 m0, s47, 0xf000
s_add_u32 s32, s30, 0xfffc4400
buffer_load_dwordx4 v236, s[16:19], s32 offen lds
s_add_u32 m0, s47, 0x10000
s_add_u32 s32, s30, 0xfffc4480
buffer_load_dwordx4 v236, s[16:19], s32 offen lds
s_add_u32 m0, s47, 0x11000
s_add_u32 s32, s30, 0xfffce400
buffer_load_dwordx4 v236, s[16:19], s32 offen lds
s_waitcnt vmcnt(12)
s_barrier
s_add_u32 m0, s47, 0x12000
s_add_u32 s32, s30, 0xfffce480
buffer_load_dwordx4 v236, s[16:19], s32 offen lds
s_add_u32 m0, s47, 0x13000
s_add_u32 s32, s30, 0xfffd8400
buffer_load_dwordx4 v236, s[16:19], s32 offen lds
s_add_u32 m0, s47, 0x14000
s_add_u32 s32, s30, 0xfffd8480
buffer_load_dwordx4 v236, s[16:19], s32 offen lds
s_add_u32 m0, s47, 0x15000
s_add_u32 s32, s30, 0xfffe2400
buffer_load_dwordx4 v236, s[16:19], s32 offen lds
s_add_u32 m0, s47, 0x16000
s_add_u32 s32, s30, 0xfffe2480
buffer_load_dwordx4 v236, s[16:19], s32 offen lds
s_add_u32 m0, s47, 0x17000
s_add_u32 s32, s30, 0xfffec400
buffer_load_dwordx4 v236, s[16:19], s32 offen lds
s_waitcnt vmcnt(12)
s_barrier
s_add_u32 m0, s47, 0x18000
s_add_u32 s32, s30, 0xfffec480
buffer_load_dwordx4 v236, s[16:19], s32 offen lds
s_add_u32 m0, s47, 0x19000
s_add_u32 s32, s30, 0xffff6400
buffer_load_dwordx4 v236, s[16:19], s32 offen lds
s_add_u32 m0, s47, 0x1a000
s_add_u32 s32, s30, 0xffff6480
buffer_load_dwordx4 v236, s[16:19], s32 offen lds
s_waitcnt vmcnt(9)
s_barrier
s_waitcnt vmcnt(3)
s_barrier
s_waitcnt vmcnt(0)
s_barrier
s_branch L_fin
L_loader:
s_setprio 1
v_add_u32 v238, 49152, v4
v_mov_b32 v239, v7
s_lshl_b32 s47, s75, 10
s_lshl_b32 s46, s75, 9
s_and_b32 s76, s75, 1
s_lshr_b32 s77, s75, 1
v_lshrrev_b32 v8, 3, v0
v_and_b32 v5, 7, v0
v_and_b32 v6, 6, v8
v_xor_b32 v9, v5, v6
v_lshlrev_b32 v9, 4, v9
s_lshl_b32 s78, s76, 3
v_add_u32 v11, s78, v8
v_lshrrev_b32 v6, 1, v11
v_xor_b32 v10, v5, v6
v_lshlrev_b32 v10, 4, v10
s_lshl_b32 s78, s77, 5
v_add_u32 v11, s78, v11
v_mul_u32_u24 v11, 384, v11
v_add_u32 v232, v11, v10
s_lshl_b32 s78, s75, 3
v_add_u32 v11, s78, v8
v_mul_u32_u24 v12, 384, v11
v_add_u32 v233, v12, v9
v_mul_u32_u24 v12, 1280, v11
v_add_u32 v235, v12, v10
s_lshl_b32 s78, s76, 4
s_lshl_b32 s79, s77, 2
s_add_u32 s78, s78, s79
v_and_b32 v12, 4, v8
v_add_u32 v12, v12, v8
v_add_u32 v12, s78, v12
v_mul_u32_u24 v11, 12288, v12
v_add_u32 v234, v11, v9
v_mul_u32_u24 v11, 1280, v12
v_add_u32 v236, v11, v9
s_lshl_b32 s78, s75, 2
v_and_b32 v11, 3, v8
v_add_u32 v11, s78, v11
v_lshrrev_b32 v6, 1, v11
v_xor_b32 v6, v5, v6
v_lshlrev_b32 v6, 4, v6
v_add_u32 v11, 64, v11
v_mul_u32_u24 v11, 1280, v11
v_add_u32 v237, v11, v6
v_min_u32 v13, 29, v0
v_mul_u32_u24 v5, 86, v13
v_lshrrev_b32 v5, 8, v5
v_mul_u32_u24 v6, 3, v5
v_sub_u32 v6, v13, v6
v_lshlrev_b32 v6, 7, v6
s_mul_i32 s78, s71, 40
s_mul_i32 s79, s75, 10
s_add_u32 s78, s78, s79
v_add_u32 v5, s78, v5
v_mul_u32_u24 v5, 12288, v5
v_add_u32 v242, v5, v6
v_lshlrev_b32 v5, 7, v13
s_mul_i32 s78, s75, 3840
v_add_u32 v241, s78, v5
v_lshlrev_b32 v5, 6, v3
v_lshlrev_b32 v6, 4, v2
v_add_u32 v5, v5, v6
s_lshl_b32 s78, s75, 10
v_add_u32 v240, s78, v5
s_add_u32 m0, s47, 0xc000
s_add_u32 s32, s29, 0x0
buffer_load_dwordx4 v234, s[12:15], s32 offen lds
s_add_u32 m0, s47, 0xd000
s_add_u32 s32, s29, 0x80
buffer_load_dwordx4 v234, s[12:15], s32 offen lds
s_add_u32 m0, s47, 0xe000
s_add_u32 s32, s29, 0x100
buffer_load_dwordx4 v234, s[12:15], s32 offen lds
s_add_u32 m0, s47, 0xf000
s_add_u32 s32, s29, 0x60000
buffer_load_dwordx4 v234, s[12:15], s32 offen lds
s_add_u32 m0, s47, 0x10000
s_add_u32 s32, s29, 0x60080
buffer_load_dwordx4 v234, s[12:15], s32 offen lds
s_add_u32 m0, s47, 0x11000
s_add_u32 s32, s29, 0x60100
buffer_load_dwordx4 v234, s[12:15], s32 offen lds
s_add_u32 m0, s47, 0x1b000
s_add_u32 s32, s31, 0x0
buffer_load_dwordx4 v235, s[20:23], s32 offen lds
s_add_u32 m0, s47, 0x1c000
s_add_u32 s32, s31, 0xa000
buffer_load_dwordx4 v235, s[20:23], s32 offen lds
s_mov_b32 exec_hi, 0
s_add_u32 m0, s46, 0x1d000
s_add_u32 s32, s31, 0x0
buffer_load_dwordx4 v237, s[20:23], s32 offen lds
s_mov_b32 exec_hi, -1
s_add_u32 m0, s47, 0x12000
s_add_u32 s32, s29, 0xc0000
buffer_load_dwordx4 v234, s[12:15], s32 offen lds
s_add_u32 m0, s47, 0x13000
s_add_u32 s32, s29, 0xc0080
buffer_load_dwordx4 v234, s[12:15], s32 offen lds
s_add_u32 m0, s47, 0x14000
s_add_u32 s32, s29, 0xc0100
buffer_load_dwordx4 v234, s[12:15], s32 offen lds
s_add_u32 m0, s47, 0x15000
s_add_u32 s32, s29, 0x120000
buffer_load_dwordx4 v234, s[12:15], s32 offen lds
s_add_u32 m0, s47, 0x16000
s_add_u32 s32, s29, 0x120080
buffer_load_dwordx4 v234, s[12:15], s32 offen lds
s_add_u32 m0, s47, 0x17000
s_add_u32 s32, s29, 0x120100
buffer_load_dwordx4 v234, s[12:15], s32 offen lds
s_add_u32 m0, s47, 0x1d800
s_add_u32 s32, s31, 0x80
buffer_load_dwordx4 v235, s[20:23], s32 offen lds
s_add_u32 m0, s47, 0x1e800
s_add_u32 s32, s31, 0xa080
buffer_load_dwordx4 v235, s[20:23], s32 offen lds
s_mov_b32 exec_hi, 0
s_add_u32 m0, s46, 0x1f800
s_add_u32 s32, s31, 0x80
buffer_load_dwordx4 v237, s[20:23], s32 offen lds
s_mov_b32 exec_hi, -1
s_waitcnt vmcnt(9)
s_barrier
s_add_u32 m0, s47, 0x18000
s_add_u32 s32, s29, 0x180000
buffer_load_dwordx4 v234, s[12:15], s32 offen lds
s_add_u32 m0, s47, 0x19000
s_add_u32 s32, s29, 0x180080
buffer_load_dwordx4 v234, s[12:15], s32 offen lds
s_add_u32 m0, s47, 0x1a000
s_add_u32 s32, s29, 0x180100
buffer_load_dwordx4 v234, s[12:15], s32 offen lds
s_add_u32 m0, s47, 0x25000
s_add_u32 s32, s31, 0x100
buffer_load_dwordx4 v235, s[20:23], s32 offen lds
s_add_u32 m0, s47, 0x26000
s_add_u32 s32, s31, 0xa100
buffer_load_dwordx4 v235, s[20:23], s32 offen lds
s_mov_b32 exec_hi, 0
s_add_u32 m0, s46, 0x27000
s_add_u32 s32, s31, 0x100
buffer_load_dwordx4 v237, s[20:23], s32 offen lds
s_mov_b32 exec_hi, -1
s_waitcnt vmcnt(6)
s_barrier
s_add_u32 m0, s47, 0xc000
s_add_u32 s32, s29, 0x1e0000
buffer_load_dwordx4 v234, s[12:15], s32 offen lds
s_add_u32 m0, s47, 0xd000
s_add_u32 s32, s29, 0x1e0080
buffer_load_dwordx4 v234, s[12:15], s32 offen lds
s_add_u32 m0, s47, 0xe000
s_add_u32 s32, s29, 0x1e0100
buffer_load_dwordx4 v234, s[12:15], s32 offen lds
s_add_u32 m0, s47, 0xf000
s_add_u32 s32, s29, 0x240000
buffer_load_dwordx4 v234, s[12:15], s32 offen lds
s_add_u32 m0, s47, 0x10000
s_add_u32 s32, s29, 0x240080
buffer_load_dwordx4 v234, s[12:15], s32 offen lds
s_add_u32 m0, s47, 0x11000
s_add_u32 s32, s29, 0x240100
buffer_load_dwordx4 v234, s[12:15], s32 offen lds
s_add_u32 m0, s47, 0x1b000
s_add_u32 s32, s31, 0x180
buffer_load_dwordx4 v235, s[20:23], s32 offen lds
s_add_u32 m0, s47, 0x1c000
s_add_u32 s32, s31, 0xa180
buffer_load_dwordx4 v235, s[20:23], s32 offen lds
s_mov_b32 exec_hi, 0
s_add_u32 m0, s46, 0x1d000
s_add_u32 s32, s31, 0x180
buffer_load_dwordx4 v237, s[20:23], s32 offen lds
s_mov_b32 exec_hi, -1
s_waitcnt vmcnt(6)
s_barrier
s_add_u32 m0, s47, 0x12000
s_add_u32 s32, s29, 0x2a0000
buffer_load_dwordx4 v234, s[12:15], s32 offen lds
s_add_u32 m0, s47, 0x13000
s_add_u32 s32, s29, 0x2a0080
buffer_load_dwordx4 v234, s[12:15], s32 offen lds
s_add_u32 m0, s47, 0x14000
s_add_u32 s32, s29, 0x2a0100
buffer_load_dwordx4 v234, s[12:15], s32 offen lds
s_add_u32 m0, s47, 0x15000
s_add_u32 s32, s29, 0x300000
buffer_load_dwordx4 v234, s[12:15], s32 offen lds
s_add_u32 m0, s47, 0x16000
s_add_u32 s32, s29, 0x300080
buffer_load_dwordx4 v234, s[12:15], s32 offen lds
s_add_u32 m0, s47, 0x17000
s_add_u32 s32, s29, 0x300100
buffer_load_dwordx4 v234, s[12:15], s32 offen lds
s_add_u32 m0, s47, 0x1d800
s_add_u32 s32, s31, 0x200
buffer_load_dwordx4 v235, s[20:23], s32 offen lds
s_add_u32 m0, s47, 0x1e800
s_add_u32 s32, s31, 0xa200
buffer_load_dwordx4 v235, s[20:23], s32 offen lds
s_mov_b32 exec_hi, 0
s_add_u32 m0, s46, 0x1f800
s_add_u32 s32, s31, 0x200
buffer_load_dwordx4 v237, s[20:23], s32 offen lds
s_mov_b32 exec_hi, -1
s_waitcnt vmcnt(6)
s_barrier
s_add_u32 m0, s47, 0x18000
s_add_u32 s32, s29, 0x360000
buffer_load_dwordx4 v234, s[12:15], s32 offen lds
s_add_u32 m0, s47, 0x19000
s_add_u32 s32, s29, 0x360080
buffer_load_dwordx4 v234, s[12:15], s32 offen lds
s_add_u32 m0, s47, 0x1a000
s_add_u32 s32, s29, 0x360100
buffer_load_dwordx4 v234, s[12:15], s32 offen lds
s_add_u32 m0, s47, 0xc000
s_add_u32 s32, s29, 0x3c0000
buffer_load_dwordx4 v234, s[12:15], s32 offen lds
s_add_u32 m0, s47, 0xd000
s_add_u32 s32, s29, 0x3c0080
buffer_load_dwordx4 v234, s[12:15], s32 offen lds
s_add_u32 m0, s47, 0xe000
s_add_u32 s32, s29, 0x3c0100
buffer_load_dwordx4 v234, s[12:15], s32 offen lds
s_add_u32 m0, s47, 0x25000
s_add_u32 s32, s31, 0x280
buffer_load_dwordx4 v235, s[20:23], s32 offen lds
s_add_u32 m0, s47, 0x26000
s_add_u32 s32, s31, 0xa280
buffer_load_dwordx4 v235, s[20:23], s32 offen lds
s_mov_b32 exec_hi, 0
s_add_u32 m0, s46, 0x27000
s_add_u32 s32, s31, 0x280
buffer_load_dwordx4 v237, s[20:23], s32 offen lds
s_mov_b32 exec_hi, -1
s_add_u32 m0, s47, 0x0
s_add_u32 s32, s28, 0x0
buffer_load_dwordx4 v232, s[4:7], s32 offen nt lds
s_add_u32 m0, s47, 0x2000
s_add_u32 s32, s28, 0x80
buffer_load_dwordx4 v232, s[4:7], s32 offen nt lds
s_add_u32 m0, s47, 0x4000
s_add_u32 s32, s28, 0x100
buffer_load_dwordx4 v232, s[4:7], s32 offen nt lds
s_add_u32 m0, s47, 0x1000
s_add_u32 s32, s28, 0x6000
buffer_load_dwordx4 v232, s[4:7], s32 offen nt lds
s_add_u32 m0, s47, 0x3000
s_add_u32 s32, s28, 0x6080
buffer_load_dwordx4 v232, s[4:7], s32 offen nt lds
s_add_u32 m0, s47, 0x5000
s_add_u32 s32, s28, 0x6100
buffer_load_dwordx4 v232, s[4:7], s32 offen nt lds
s_waitcnt vmcnt(12)
s_barrier
s_add_u32 m0, s47, 0xf000
s_add_u32 s32, s29, 0x420000
buffer_load_dwordx4 v234, s[12:15], s32 offen lds
s_add_u32 m0, s47, 0x10000
s_add_u32 s32, s29, 0x420080
buffer_load_dwordx4 v234, s[12:15], s32 offen lds
s_add_u32 m0, s47, 0x11000
s_add_u32 s32, s29, 0x420100
buffer_load_dwordx4 v234, s[12:15], s32 offen lds
s_add_u32 m0, s47, 0x12000
s_add_u32 s32, s29, 0x480000
buffer_load_dwordx4 v234, s[12:15], s32 offen lds
s_add_u32 m0, s47, 0x13000
s_add_u32 s32, s29, 0x480080
buffer_load_dwordx4 v234, s[12:15], s32 offen lds
s_add_u32 m0, s47, 0x14000
s_add_u32 s32, s29, 0x480100
buffer_load_dwordx4 v234, s[12:15], s32 offen lds
s_add_u32 m0, s47, 0x1b000
s_add_u32 s32, s31, 0x300
buffer_load_dwordx4 v235, s[20:23], s32 offen lds
s_add_u32 m0, s47, 0x1c000
s_add_u32 s32, s31, 0xa300
buffer_load_dwordx4 v235, s[20:23], s32 offen lds
s_mov_b32 exec_hi, 0
s_add_u32 m0, s46, 0x1d000
s_add_u32 s32, s31, 0x300
buffer_load_dwordx4 v237, s[20:23], s32 offen lds
s_mov_b32 exec_hi, -1
s_waitcnt vmcnt(6)
s_barrier
s_add_u32 m0, s47, 0x15000
s_add_u32 s32, s29, 0x4e0000
buffer_load_dwordx4 v234, s[12:15], s32 offen lds
s_add_u32 m0, s47, 0x16000
s_add_u32 s32, s29, 0x4e0080
buffer_load_dwordx4 v234, s[12:15], s32 offen lds
s_add_u32 m0, s47, 0x17000
s_add_u32 s32, s29, 0x4e0100
buffer_load_dwordx4 v234, s[12:15], s32 offen lds
s_add_u32 m0, s47, 0x18000
s_add_u32 s32, s29, 0x540000
buffer_load_dwordx4 v234, s[12:15], s32 offen lds
s_add_u32 m0, s47, 0x19000
s_add_u32 s32, s29, 0x540080
buffer_load_dwordx4 v234, s[12:15], s32 offen lds
s_add_u32 m0, s47, 0x1a000
s_add_u32 s32, s29, 0x540100
buffer_load_dwordx4 v234, s[12:15], s32 offen lds
s_add_u32 m0, s47, 0x1d800
s_add_u32 s32, s31, 0x380
buffer_load_dwordx4 v235, s[20:23], s32 offen lds
s_add_u32 m0, s47, 0x1e800
s_add_u32 s32, s31, 0xa380
buffer_load_dwordx4 v235, s[20:23], s32 offen lds
s_mov_b32 exec_hi, 0
s_add_u32 m0, s46, 0x1f800
s_add_u32 s32, s31, 0x380
buffer_load_dwordx4 v237, s[20:23], s32 offen lds
s_mov_b32 exec_hi, -1
s_waitcnt vmcnt(6)
s_barrier
s_add_u32 m0, s47, 0xc000
s_add_u32 s32, s29, 0x5a0000
buffer_load_dwordx4 v234, s[12:15], s32 offen lds
s_add_u32 m0, s47, 0xd000
s_add_u32 s32, s29, 0x5a0080
buffer_load_dwordx4 v234, s[12:15], s32 offen lds
s_add_u32 m0, s47, 0xe000
s_add_u32 s32, s29, 0x5a0100
buffer_load_dwordx4 v234, s[12:15], s32 offen lds
s_add_u32 m0, s47, 0xf000
s_add_u32 s32, s29, 0x600000
buffer_load_dwordx4 v234, s[12:15], s32 offen lds
s_add_u32 m0, s47, 0x10000
s_add_u32 s32, s29, 0x600080
buffer_load_dwordx4 v234, s[12:15], s32 offen lds
s_add_u32 m0, s47, 0x11000
s_add_u32 s32, s29, 0x600100
buffer_load_dwordx4 v234, s[12:15], s32 offen lds
s_add_u32 m0, s47, 0x25000
s_add_u32 s32, s31, 0x400
buffer_load_dwordx4 v235, s[20:23], s32 offen lds
s_add_u32 m0, s47, 0x26000
s_add_u32 s32, s31, 0xa400
buffer_load_dwordx4 v235, s[20:23], s32 offen lds
s_mov_b32 exec_hi, 0
s_add_u32 m0, s46, 0x27000
s_add_u32 s32, s31, 0x400
buffer_load_dwordx4 v237, s[20:23], s32 offen lds
s_mov_b32 exec_hi, -1
s_add_u32 m0, s47, 0x6000
s_add_u32 s32, s28, 0x1800
buffer_load_dwordx4 v232, s[4:7], s32 offen nt lds
s_add_u32 m0, s47, 0x8000
s_add_u32 s32, s28, 0x1880
buffer_load_dwordx4 v232, s[4:7], s32 offen nt lds
s_add_u32 m0, s47, 0xa000
s_add_u32 s32, s28, 0x1900
buffer_load_dwordx4 v232, s[4:7], s32 offen nt lds
s_add_u32 m0, s47, 0x7000
s_add_u32 s32, s28, 0x7800
buffer_load_dwordx4 v232, s[4:7], s32 offen nt lds
s_add_u32 m0, s47, 0x9000
s_add_u32 s32, s28, 0x7880
buffer_load_dwordx4 v232, s[4:7], s32 offen nt lds
s_add_u32 m0, s47, 0xb000
s_add_u32 s32, s28, 0x7900
buffer_load_dwordx4 v232, s[4:7], s32 offen nt lds
s_waitcnt vmcnt(12)
s_barrier
s_add_u32 m0, s47, 0x12000
s_add_u32 s32, s29, 0x660000
buffer_load_dwordx4 v234, s[12:15], s32 offen lds
s_add_u32 m0, s47, 0x13000
s_add_u32 s32, s29, 0x660080
buffer_load_dwordx4 v234, s[12:15], s32 offen lds
s_add_u32 m0, s47, 0x14000
s_add_u32 s32, s29, 0x660100
buffer_load_dwordx4 v234, s[12:15], s32 offen lds
s_add_u32 m0, s47, 0x15000
s_add_u32 s32, s29, 0x6c0000
buffer_load_dwordx4 v234, s[12:15], s32 offen lds
s_add_u32 m0, s47, 0x16000
s_add_u32 s32, s29, 0x6c0080
buffer_load_dwordx4 v234, s[12:15], s32 offen lds
s_add_u32 m0, s47, 0x17000
s_add_u32 s32, s29, 0x6c0100
buffer_load_dwordx4 v234, s[12:15], s32 offen lds
s_add_u32 m0, s47, 0x1b000
s_add_u32 s32, s31, 0x480
buffer_load_dwordx4 v235, s[20:23], s32 offen lds
s_add_u32 m0, s47, 0x1c000
s_add_u32 s32, s31, 0xa480
buffer_load_dwordx4 v235, s[20:23], s32 offen lds
s_mov_b32 exec_hi, 0
s_add_u32 m0, s46, 0x1d000
s_add_u32 s32, s31, 0x480
buffer_load_dwordx4 v237, s[20:23], s32 offen lds
s_mov_b32 exec_hi, -1
s_waitcnt vmcnt(6)
s_barrier
s_add_u32 m0, s47, 0x18000
s_add_u32 s32, s29, 0x720000
buffer_load_dwordx4 v234, s[12:15], s32 offen lds
s_add_u32 m0, s47, 0x19000
s_add_u32 s32, s29, 0x720080
buffer_load_dwordx4 v234, s[12:15], s32 offen lds
s_add_u32 m0, s47, 0x1a000
s_add_u32 s32, s29, 0x720100
buffer_load_dwordx4 v234, s[12:15], s32 offen lds
s_waitcnt vmcnt(0)
s_barrier
s_add_u32 m0, s47, 0xc000
s_add_u32 s32, s28, 0xc000
buffer_load_dwordx4 v232, s[4:7], s32 offen nt lds
s_add_u32 m0, s47, 0xe000
s_add_u32 s32, s28, 0xc080
buffer_load_dwordx4 v232, s[4:7], s32 offen nt lds
s_add_u32 m0, s47, 0x10000
s_add_u32 s32, s28, 0xc100
buffer_load_dwordx4 v232, s[4:7], s32 offen nt lds
s_add_u32 m0, s47, 0xd000
s_add_u32 s32, s28, 0x12000
buffer_load_dwordx4 v232, s[4:7], s32 offen nt lds
s_add_u32 m0, s47, 0xf000
s_add_u32 s32, s28, 0x12080
buffer_load_dwordx4 v232, s[4:7], s32 offen nt lds
s_add_u32 m0, s47, 0x11000
s_add_u32 s32, s28, 0x12100
buffer_load_dwordx4 v232, s[4:7], s32 offen nt lds
s_barrier
s_add_u32 m0, s47, 0x12000
s_add_u32 s32, s28, 0xd800
buffer_load_dwordx4 v232, s[4:7], s32 offen nt lds
s_add_u32 m0, s47, 0x14000
s_add_u32 s32, s28, 0xd880
buffer_load_dwordx4 v232, s[4:7], s32 offen nt lds
s_add_u32 m0, s47, 0x16000
s_add_u32 s32, s28, 0xd900
buffer_load_dwordx4 v232, s[4:7], s32 offen nt lds
s_add_u32 m0, s47, 0x13000
s_add_u32 s32, s28, 0x13800
buffer_load_dwordx4 v232, s[4:7], s32 offen nt lds
s_add_u32 m0, s47, 0x15000
s_add_u32 s32, s28, 0x13880
buffer_load_dwordx4 v232, s[4:7], s32 offen nt lds
s_add_u32 m0, s47, 0x17000
s_add_u32 s32, s28, 0x13900
buffer_load_dwordx4 v232, s[4:7], s32 offen nt lds
s_barrier
s_barrier
s_add_u32 m0, s47, 0x0
s_add_u32 s32, s28, 0x18000
buffer_load_dwordx4 v232, s[4:7], s32 offen nt lds
s_add_u32 m0, s47, 0x2000
s_add_u32 s32, s28, 0x18080
buffer_load_dwordx4 v232, s[4:7], s32 offen nt lds
s_add_u32 m0, s47, 0x4000
s_add_u32 s32, s28, 0x18100
buffer_load_dwordx4 v232, s[4:7], s32 offen nt lds
s_add_u32 m0, s47, 0x1000
s_add_u32 s32, s28, 0x1e000
buffer_load_dwordx4 v232, s[4:7], s32 offen nt lds
s_add_u32 m0, s47, 0x3000
s_add_u32 s32, s28, 0x1e080
buffer_load_dwordx4 v232, s[4:7], s32 offen nt lds
s_add_u32 m0, s47, 0x5000
s_add_u32 s32, s28, 0x1e100
buffer_load_dwordx4 v232, s[4:7], s32 offen nt lds
v_mov_b32 v0, 0
v_mov_b32 v1, 0
v_mov_b32 v2, 0
v_mov_b32 v3, 0
v_mov_b32 v4, 0
v_mov_b32 v5, 0
v_mov_b32 v6, 0
v_mov_b32 v7, 0
v_mov_b32 v8, 0
v_mov_b32 v9, 0
v_mov_b32 v10, 0
v_mov_b32 v11, 0
v_mov_b32 v12, 0
v_mov_b32 v13, 0
v_mov_b32 v14, 0
v_mov_b32 v15, 0
v_mov_b32 v16, 0
v_mov_b32 v17, 0
v_mov_b32 v18, 0
v_mov_b32 v19, 0
v_mov_b32 v20, 0
v_mov_b32 v21, 0
v_mov_b32 v22, 0
v_mov_b32 v23, 0
v_mov_b32 v24, 0
v_mov_b32 v25, 0
v_mov_b32 v26, 0
v_mov_b32 v27, 0
v_mov_b32 v28, 0
v_mov_b32 v29, 0
v_mov_b32 v30, 0
v_mov_b32 v31, 0
v_mov_b32 v32, 0
v_mov_b32 v33, 0
v_mov_b32 v34, 0
v_mov_b32 v35, 0
v_mov_b32 v36, 0
v_mov_b32 v37, 0
v_mov_b32 v38, 0
v_mov_b32 v39, 0
v_mov_b32 v40, 0
v_mov_b32 v41, 0
v_mov_b32 v42, 0
v_mov_b32 v43, 0
v_mov_b32 v44, 0
v_mov_b32 v45, 0
v_mov_b32 v46, 0
v_mov_b32 v47, 0
v_mov_b32 v48, 0
v_mov_b32 v49, 0
v_mov_b32 v50, 0
v_mov_b32 v51, 0
v_mov_b32 v52, 0
v_mov_b32 v53, 0
v_mov_b32 v54, 0
v_mov_b32 v55, 0
v_mov_b32 v56, 0
v_mov_b32 v57, 0
v_mov_b32 v58, 0
v_mov_b32 v59, 0
v_mov_b32 v60, 0
v_mov_b32 v61, 0
v_mov_b32 v62, 0
v_mov_b32 v63, 0
v_mov_b32 v64, 0
v_mov_b32 v65, 0
v_mov_b32 v66, 0
v_mov_b32 v67, 0
v_mov_b32 v68, 0
v_mov_b32 v69, 0
v_mov_b32 v70, 0
v_mov_b32 v71, 0
v_mov_b32 v72, 0
v_mov_b32 v73, 0
v_mov_b32 v74, 0
v_mov_b32 v75, 0
v_mov_b32 v76, 0
v_mov_b32 v77, 0
v_mov_b32 v78, 0
v_mov_b32 v79, 0
v_mov_b32 v80, 0
v_mov_b32 v81, 0
v_mov_b32 v82, 0
v_mov_b32 v83, 0
v_mov_b32 v84, 0
v_mov_b32 v85, 0
v_mov_b32 v86, 0
v_mov_b32 v87, 0
v_mov_b32 v88, 0
v_mov_b32 v89, 0
v_mov_b32 v90, 0
v_mov_b32 v91, 0
v_mov_b32 v92, 0
v_mov_b32 v93, 0
v_mov_b32 v94, 0
v_mov_b32 v95, 0
v_mov_b32 v96, 0
v_mov_b32 v97, 0
v_mov_b32 v98, 0
v_mov_b32 v99, 0
v_mov_b32 v100, 0
v_mov_b32 v101, 0
v_mov_b32 v102, 0
v_mov_b32 v103, 0
v_mov_b32 v104, 0
v_mov_b32 v105, 0
v_mov_b32 v106, 0
v_mov_b32 v107, 0
v_mov_b32 v108, 0
v_mov_b32 v109, 0
v_mov_b32 v110, 0
v_mov_b32 v111, 0
v_mov_b32 v112, 0
v_mov_b32 v113, 0
v_mov_b32 v114, 0
v_mov_b32 v115, 0
v_mov_b32 v116, 0
v_mov_b32 v117, 0
v_mov_b32 v118, 0
v_mov_b32 v119, 0
v_mov_b32 v120, 0
v_mov_b32 v121, 0
v_mov_b32 v122, 0
v_mov_b32 v123, 0
v_mov_b32 v124, 0
v_mov_b32 v125, 0
v_mov_b32 v126, 0
v_mov_b32 v127, 0
v_mov_b32 v128, 0
v_mov_b32 v129, 0
v_mov_b32 v130, 0
v_mov_b32 v131, 0
v_mov_b32 v132, 0
v_mov_b32 v133, 0
v_mov_b32 v134, 0
v_mov_b32 v135, 0
v_mov_b32 v136, 0
v_mov_b32 v137, 0
v_mov_b32 v138, 0
v_mov_b32 v139, 0
v_mov_b32 v140, 0
v_mov_b32 v141, 0
v_mov_b32 v142, 0
v_mov_b32 v143, 0
v_mov_b32 v144, 0
v_mov_b32 v145, 0
v_mov_b32 v146, 0
v_mov_b32 v147, 0
v_mov_b32 v148, 0
v_mov_b32 v149, 0
v_mov_b32 v150, 0
v_mov_b32 v151, 0
v_mov_b32 v152, 0
v_mov_b32 v153, 0
v_mov_b32 v154, 0
v_mov_b32 v155, 0
v_mov_b32 v156, 0
v_mov_b32 v157, 0
v_mov_b32 v158, 0
v_mov_b32 v159, 0
v_mov_b32 v160, 0
v_mov_b32 v161, 0
v_mov_b32 v162, 0
v_mov_b32 v163, 0
v_mov_b32 v164, 0
v_mov_b32 v165, 0
v_mov_b32 v166, 0
v_mov_b32 v167, 0
v_mov_b32 v168, 0
v_mov_b32 v169, 0
v_mov_b32 v170, 0
v_mov_b32 v171, 0
v_mov_b32 v172, 0
v_mov_b32 v173, 0
v_mov_b32 v174, 0
v_mov_b32 v175, 0
v_mov_b32 v176, 0
v_mov_b32 v177, 0
v_mov_b32 v178, 0
v_mov_b32 v179, 0
v_mov_b32 v180, 0
v_mov_b32 v181, 0
v_mov_b32 v182, 0
v_mov_b32 v183, 0
v_mov_b32 v184, 0
v_mov_b32 v185, 0
v_mov_b32 v186, 0
v_mov_b32 v187, 0
v_mov_b32 v188, 0
v_mov_b32 v189, 0
v_mov_b32 v190, 0
v_mov_b32 v191, 0
v_mov_b32 v192, 0
v_mov_b32 v193, 0
v_mov_b32 v194, 0
v_mov_b32 v195, 0
v_mov_b32 v196, 0
v_mov_b32 v197, 0
v_mov_b32 v198, 0
v_mov_b32 v199, 0
s_waitcnt vmcnt(12)
s_barrier
s_add_u32 m0, s47, 0x6000
s_add_u32 s32, s28, 0x19800
buffer_load_dwordx4 v232, s[4:7], s32 offen nt lds
s_add_u32 m0, s47, 0x8000
s_add_u32 s32, s28, 0x19880
buffer_load_dwordx4 v232, s[4:7], s32 offen nt lds
s_add_u32 m0, s47, 0xa000
s_add_u32 s32, s28, 0x19900
buffer_load_dwordx4 v232, s[4:7], s32 offen nt lds
s_add_u32 m0, s47, 0x7000
s_add_u32 s32, s28, 0x1f800
buffer_load_dwordx4 v232, s[4:7], s32 offen nt lds
s_add_u32 m0, s47, 0x9000
s_add_u32 s32, s28, 0x1f880
buffer_load_dwordx4 v232, s[4:7], s32 offen nt lds
s_add_u32 m0, s47, 0xb000
s_add_u32 s32, s28, 0x1f900
buffer_load_dwordx4 v232, s[4:7], s32 offen nt lds
s_add_u32 s32, s29, 0x180
buffer_load_dword v244, v242, s[12:15], s32 offen
s_waitcnt vmcnt(13)
s_barrier
s_add_u32 m0, s47, 0xc000
s_add_u32 s32, s28, 0x24000
buffer_load_dwordx4 v232, s[4:7], s32 offen nt lds
s_add_u32 m0, s47, 0xe000
s_add_u32 s32, s28, 0x24080
buffer_load_dwordx4 v232, s[4:7], s32 offen nt lds
s_add_u32 m0, s47, 0x10000
s_add_u32 s32, s28, 0x24100
buffer_load_dwordx4 v232, s[4:7], s32 offen nt lds
s_add_u32 m0, s47, 0xd000
s_add_u32 s32, s28, 0x2a000
buffer_load_dwordx4 v232, s[4:7], s32 offen nt lds
s_add_u32 m0, s47, 0xf000
s_add_u32 s32, s28, 0x2a080
buffer_load_dwordx4 v232, s[4:7], s32 offen nt lds
s_add_u32 m0, s47, 0x11000
s_add_u32 s32, s28, 0x2a100
buffer_load_dwordx4 v232, s[4:7], s32 offen nt lds
s_waitcnt vmcnt(13)
s_barrier
s_add_u32 m0, s47, 0x12000
s_add_u32 s32, s28, 0x25800
buffer_load_dwordx4 v232, s[4:7], s32 offen nt lds
s_add_u32 m0, s47, 0x14000
s_add_u32 s32, s28, 0x25880
buffer_load_dwordx4 v232, s[4:7], s32 offen nt lds
s_add_u32 m0, s47, 0x16000
s_add_u32 s32, s28, 0x25900
buffer_load_dwordx4 v232, s[4:7], s32 offen nt lds
s_add_u32 m0, s47, 0x13000
s_add_u32 s32, s28, 0x2b800
buffer_load_dwordx4 v232, s[4:7], s32 offen nt lds
s_add_u32 m0, s47, 0x15000
s_add_u32 s32, s28, 0x2b880
buffer_load_dwordx4 v232, s[4:7], s32 offen nt lds
s_add_u32 m0, s47, 0x17000
s_add_u32 s32, s28, 0x2b900
buffer_load_dwordx4 v232, s[4:7], s32 offen nt lds
s_waitcnt vmcnt(13)
s_barrier
s_add_u32 m0, s47, 0x0
s_add_u32 s32, s28, 0x0
buffer_load_dwordx4 v233, s[8:11], s32 offen nt lds
s_add_u32 m0, s47, 0x1000
s_add_u32 s32, s28, 0x80
buffer_load_dwordx4 v233, s[8:11], s32 offen nt lds
s_add_u32 m0, s47, 0x2000
s_add_u32 s32, s28, 0x100
buffer_load_dwordx4 v233, s[8:11], s32 offen nt lds
s_add_u32 m0, s47, 0x3000
s_add_u32 s32, s28, 0x3000
buffer_load_dwordx4 v233, s[8:11], s32 offen nt lds
s_add_u32 m0, s47, 0x4000
s_add_u32 s32, s28, 0x3080
buffer_load_dwordx4 v233, s[8:11], s32 offen nt lds
s_add_u32 m0, s47, 0x5000
s_add_u32 s32, s28, 0x3100
buffer_load_dwordx4 v233, s[8:11], s32 offen nt lds
s_waitcnt vmcnt(12)
s_barrier
s_add_u32 m0, s47, 0x6000
s_add_u32 s32, s28, 0x6000
buffer_load_dwordx4 v233, s[8:11], s32 offen nt lds
s_add_u32 m0, s47, 0x7000
s_add_u32 s32, s28, 0x6080
buffer_load_dwordx4 v233, s[8:11], s32 offen nt lds
s_add_u32 m0, s47, 0x8000
s_add_u32 s32, s28, 0x6100
buffer_load_dwordx4 v233, s[8:11], s32 offen nt lds
s_add_u32 m0, s47, 0x9000
s_add_u32 s32, s28, 0x9000
buffer_load_dwordx4 v233, s[8:11], s32 offen nt lds
s_add_u32 m0, s47, 0xa000
s_add_u32 s32, s28, 0x9080
buffer_load_dwordx4 v233, s[8:11], s32 offen nt lds
s_add_u32 m0, s47, 0xb000
s_add_u32 s32, s28, 0x9100
buffer_load_dwordx4 v233, s[8:11], s32 offen nt lds
s_waitcnt vmcnt(12)
s_barrier
s_barrier
s_barrier
s_add_u32 m0, s47, 0xc000
s_add_u32 s32, s29, 0x180
buffer_load_dwordx4 v234, s[12:15], s32 offen lds
s_add_u32 m0, s47, 0xd000
s_add_u32 s32, s29, 0x200
buffer_load_dwordx4 v234, s[12:15], s32 offen lds
s_add_u32 m0, s47, 0xe000
s_add_u32 s32, s29, 0x280
buffer_load_dwordx4 v234, s[12:15], s32 offen lds
s_add_u32 m0, s47, 0x1b000
s_add_u32 s32, s31, 0x0
buffer_load_dwordx4 v235, s[20:23], s32 offen lds
s_add_u32 m0, s47, 0x1c000
s_add_u32 s32, s31, 0xa000
buffer_load_dwordx4 v235, s[20:23], s32 offen lds
s_mov_b32 exec_hi, 0
s_add_u32 m0, s46, 0x1d000
s_add_u32 s32, s31, 0x0
buffer_load_dwordx4 v237, s[20:23], s32 offen lds
s_mov_b32 exec_hi, -1
s_add_u32 s28, s28, 196608
s_add_u32 s29, s29, 384
s_add_u32 s30, s30, 245760
s_add_u32 s38, s38, 245760
s_mov_b32 s33, 3
L_ld_loop:
s_waitcnt vmcnt(12)
s_barrier
s_add_u32 m0, s47, 0xf000
s_add_u32 s32, s29, 0x60000
buffer_load_dwordx4 v234, s[12:15], s32 offen lds
s_add_u32 m0, s47, 0x10000
s_add_u32 s32, s29, 0x60080
buffer_load_dwordx4 v234, s[12:15], s32 offen lds
s_add_u32 m0, s47, 0x11000
s_add_u32 s32, s29, 0x60100
buffer_load_dwordx4 v234, s[12:15], s32 offen lds
s_add_u32 m0, s47, 0x12000
s_add_u32 s32, s29, 0xc0000
buffer_load_dwordx4 v234, s[12:15], s32 offen lds
s_add_u32 m0, s47, 0x13000
s_add_u32 s32, s29, 0xc0080
buffer_load_dwordx4 v234, s[12:15], s32 offen lds
s_add_u32 m0, s47, 0x14000
s_add_u32 s32, s29, 0xc0100
buffer_load_dwordx4 v234, s[12:15], s32 offen lds
s_add_u32 m0, s47, 0x15000
s_add_u32 s32, s29, 0x120000
buffer_load_dwordx4 v234, s[12:15], s32 offen lds
s_add_u32 m0, s47, 0x16000
s_add_u32 s32, s29, 0x120080
buffer_load_dwordx4 v234, s[12:15], s32 offen lds
s_add_u32 m0, s47, 0x17000
s_add_u32 s32, s29, 0x120100
buffer_load_dwordx4 v234, s[12:15], s32 offen lds
s_add_u32 m0, s47, 0x1d800
s_add_u32 s32, s31, 0x80
buffer_load_dwordx4 v235, s[20:23], s32 offen lds
s_add_u32 m0, s47, 0x1e800
s_add_u32 s32, s31, 0xa080
buffer_load_dwordx4 v235, s[20:23], s32 offen lds
s_mov_b32 exec_hi, 0
s_add_u32 m0, s46, 0x1f800
s_add_u32 s32, s31, 0x80
buffer_load_dwordx4 v237, s[20:23], s32 offen lds
s_mov_b32 exec_hi, -1
s_add_u32 m0, s47, 0x18000
s_add_u32 s32, s29, 0x180000
buffer_load_dwordx4 v234, s[12:15], s32 offen lds
s_add_u32 m0, s47, 0x19000
s_add_u32 s32, s29, 0x180080
buffer_load_dwordx4 v234, s[12:15], s32 offen lds
s_add_u32 m0, s47, 0x1a000
s_add_u32 s32, s29, 0x180100
buffer_load_dwordx4 v234, s[12:15], s32 offen lds
s_add_u32 m0, s47, 0x25000
s_add_u32 s32, s31, 0x100
buffer_load_dwordx4 v235, s[20:23], s32 offen lds
s_add_u32 m0, s47, 0x26000
s_add_u32 s32, s31, 0xa100
buffer_load_dwordx4 v235, s[20:23], s32 offen lds
s_mov_b32 exec_hi, 0
s_add_u32 m0, s46, 0x27000
s_add_u32 s32, s31, 0x100
buffer_load_dwordx4 v237, s[20:23], s32 offen lds
s_mov_b32 exec_hi, -1
s_waitcnt vmcnt(24)
s_barrier
s_add_u32 m0, s47, 0x0
s_add_u32 s32, s28, 0xfffdc000
buffer_load_dwordx4 v233, s[8:11], s32 offen nt lds
s_add_u32 m0, s47, 0x1000
s_add_u32 s32, s28, 0xfffdc080
buffer_load_dwordx4 v233, s[8:11], s32 offen nt lds
s_add_u32 m0, s47, 0x2000
s_add_u32 s32, s28, 0xfffdc100
buffer_load_dwordx4 v233, s[8:11], s32 offen nt lds
s_add_u32 m0, s47, 0x3000
s_add_u32 s32, s28, 0xfffdf000
buffer_load_dwordx4 v233, s[8:11], s32 offen nt lds
s_add_u32 m0, s47, 0x4000
s_add_u32 s32, s28, 0xfffdf080
buffer_load_dwordx4 v233, s[8:11], s32 offen nt lds
s_add_u32 m0, s47, 0x5000
s_add_u32 s32, s28, 0xfffdf100
buffer_load_dwordx4 v233, s[8:11], s32 offen nt lds
s_waitcnt vmcnt(12)
s_barrier
s_add_u32 m0, s47, 0x6000
s_add_u32 s32, s28, 0xfffe2000
buffer_load_dwordx4 v233, s[8:11], s32 offen nt lds
s_add_u32 m0, s47, 0x7000
s_add_u32 s32, s28, 0xfffe2080
buffer_load_dwordx4 v233, s[8:11], s32 offen nt lds
s_add_u32 m0, s47, 0x8000
s_add_u32 s32, s28, 0xfffe2100
buffer_load_dwordx4 v233, s[8:11], s32 offen nt lds
s_add_u32 m0, s47, 0x9000
s_add_u32 s32, s28, 0xfffe5000
buffer_load_dwordx4 v233, s[8:11], s32 offen nt lds
s_add_u32 m0, s47, 0xa000
s_add_u32 s32, s28, 0xfffe5080
buffer_load_dwordx4 v233, s[8:11], s32 offen nt lds
s_add_u32 m0, s47, 0xb000
s_add_u32 s32, s28, 0xfffe5100
buffer_load_dwordx4 v233, s[8:11], s32 offen nt lds
s_waitcnt vmcnt(12)
s_barrier
s_add_u32 m0, s47, 0xc000
s_add_u32 s32, s29, 0x1e0000
buffer_load_dwordx4 v234, s[12:15], s32 offen lds
s_add_u32 m0, s47, 0xd000
s_add_u32 s32, s29, 0x1e0080
buffer_load_dwordx4 v234, s[12:15], s32 offen lds
s_add_u32 m0, s47, 0xe000
s_add_u32 s32, s29, 0x1e0100
buffer_load_dwordx4 v234, s[12:15], s32 offen lds
s_add_u32 m0, s47, 0x1b000
s_add_u32 s32, s31, 0x180
buffer_load_dwordx4 v235, s[20:23], s32 offen lds
s_add_u32 m0, s47, 0x1c000
s_add_u32 s32, s31, 0xa180
buffer_load_dwordx4 v235, s[20:23], s32 offen lds
s_mov_b32 exec_hi, 0
s_add_u32 m0, s46, 0x1d000
s_add_u32 s32, s31, 0x180
buffer_load_dwordx4 v237, s[20:23], s32 offen lds
s_mov_b32 exec_hi, -1
s_waitcnt vmcnt(12)
s_barrier
s_add_u32 m0, s47, 0xf000
s_add_u32 s32, s29, 0x240000
buffer_load_dwordx4 v234, s[12:15], s32 offen lds
s_add_u32 m0, s47, 0x10000
s_add_u32 s32, s29, 0x240080
buffer_load_dwordx4 v234, s[12:15], s32 offen lds
s_add_u32 m0, s47, 0x11000
s_add_u32 s32, s29, 0x240100
buffer_load_dwordx4 v234, s[12:15], s32 offen lds
s_add_u32 m0, s47, 0x12000
s_add_u32 s32, s29, 0x2a0000
buffer_load_dwordx4 v234, s[12:15], s32 offen lds
s_add_u32 m0, s47, 0x13000
s_add_u32 s32, s29, 0x2a0080
buffer_load_dwordx4 v234, s[12:15], s32 offen lds
s_add_u32 m0, s47, 0x14000
s_add_u32 s32, s29, 0x2a0100
buffer_load_dwordx4 v234, s[12:15], s32 offen lds
s_add_u32 m0, s47, 0x15000
s_add_u32 s32, s29, 0x300000
buffer_load_dwordx4 v234, s[12:15], s32 offen lds
s_add_u32 m0, s47, 0x16000
s_add_u32 s32, s29, 0x300080
buffer_load_dwordx4 v234, s[12:15], s32 offen lds
s_add_u32 m0, s47, 0x17000
s_add_u32 s32, s29, 0x300100
buffer_load_dwordx4 v234, s[12:15], s32 offen lds
s_add_u32 m0, s47, 0x1d800
s_add_u32 s32, s31, 0x200
buffer_load_dwordx4 v235, s[20:23], s32 offen lds
s_add_u32 m0, s47, 0x1e800
s_add_u32 s32, s31, 0xa200
buffer_load_dwordx4 v235, s[20:23], s32 offen lds
s_mov_b32 exec_hi, 0
s_add_u32 m0, s46, 0x1f800
s_add_u32 s32, s31, 0x200
buffer_load_dwordx4 v237, s[20:23], s32 offen lds
s_mov_b32 exec_hi, -1
s_add_u32 m0, s47, 0x18000
s_add_u32 s32, s29, 0x360000
buffer_load_dwordx4 v234, s[12:15], s32 offen lds
s_add_u32 m0, s47, 0x19000
s_add_u32 s32, s29, 0x360080
buffer_load_dwordx4 v234, s[12:15], s32 offen lds
s_add_u32 m0, s47, 0x1a000
s_add_u32 s32, s29, 0x360100
buffer_load_dwordx4 v234, s[12:15], s32 offen lds
s_waitcnt vmcnt(21)
s_barrier
s_add_u32 m0, s47, 0x0
s_add_u32 s32, s28, 0xfffe8000
buffer_load_dwordx4 v233, s[8:11], s32 offen nt lds
s_add_u32 m0, s47, 0x1000
s_add_u32 s32, s28, 0xfffe8080
buffer_load_dwordx4 v233, s[8:11], s32 offen nt lds
s_add_u32 m0, s47, 0x2000
s_add_u32 s32, s28, 0xfffe8100
buffer_load_dwordx4 v233, s[8:11], s32 offen nt lds
s_add_u32 m0, s47, 0x3000
s_add_u32 s32, s28, 0xfffeb000
buffer_load_dwordx4 v233, s[8:11], s32 offen nt lds
s_add_u32 m0, s47, 0x4000
s_add_u32 s32, s28, 0xfffeb080
buffer_load_dwordx4 v233, s[8:11], s32 offen nt lds
s_add_u32 m0, s47, 0x5000
s_add_u32 s32, s28, 0xfffeb100
buffer_load_dwordx4 v233, s[8:11], s32 offen nt lds
s_waitcnt vmcnt(9)
s_barrier
s_add_u32 m0, s47, 0x6000
s_add_u32 s32, s28, 0xfffee000
buffer_load_dwordx4 v233, s[8:11], s32 offen nt lds
s_add_u32 m0, s47, 0x7000
s_add_u32 s32, s28, 0xfffee080
buffer_load_dwordx4 v233, s[8:11], s32 offen nt lds
s_add_u32 m0, s47, 0x8000
s_add_u32 s32, s28, 0xfffee100
buffer_load_dwordx4 v233, s[8:11], s32 offen nt lds
s_add_u32 m0, s47, 0x9000
s_add_u32 s32, s28, 0xffff1000
buffer_load_dwordx4 v233, s[8:11], s32 offen nt lds
s_add_u32 m0, s47, 0xa000
s_add_u32 s32, s28, 0xffff1080
buffer_load_dwordx4 v233, s[8:11], s32 offen nt lds
s_add_u32 m0, s47, 0xb000
s_add_u32 s32, s28, 0xffff1100
buffer_load_dwordx4 v233, s[8:11], s32 offen nt lds
s_add_u32 s32, s38, 0xfffc4000
buffer_load_dword v244, v241, s[16:19], s32 offen
s_waitcnt vmcnt(13)
s_barrier
s_add_u32 m0, s47, 0xc000
s_add_u32 s32, s29, 0x3c0000
buffer_load_dwordx4 v234, s[12:15], s32 offen lds
s_add_u32 m0, s47, 0xd000
s_add_u32 s32, s29, 0x3c0080
buffer_load_dwordx4 v234, s[12:15], s32 offen lds
s_add_u32 m0, s47, 0xe000
s_add_u32 s32, s29, 0x3c0100
buffer_load_dwordx4 v234, s[12:15], s32 offen lds
s_add_u32 m0, s47, 0x25000
s_add_u32 s32, s31, 0x280
buffer_load_dwordx4 v235, s[20:23], s32 offen lds
s_add_u32 m0, s47, 0x26000
s_add_u32 s32, s31, 0xa280
buffer_load_dwordx4 v235, s[20:23], s32 offen lds
s_mov_b32 exec_hi, 0
s_add_u32 m0, s46, 0x27000
s_add_u32 s32, s31, 0x280
buffer_load_dwordx4 v237, s[20:23], s32 offen lds
s_mov_b32 exec_hi, -1
s_waitcnt vmcnt(13)
s_barrier
s_add_u32 m0, s47, 0xf000
s_add_u32 s32, s29, 0x420000
buffer_load_dwordx4 v234, s[12:15], s32 offen lds
s_add_u32 m0, s47, 0x10000
s_add_u32 s32, s29, 0x420080
buffer_load_dwordx4 v234, s[12:15], s32 offen lds
s_add_u32 m0, s47, 0x11000
s_add_u32 s32, s29, 0x420100
buffer_load_dwordx4 v234, s[12:15], s32 offen lds
s_add_u32 m0, s47, 0x12000
s_add_u32 s32, s29, 0x480000
buffer_load_dwordx4 v234, s[12:15], s32 offen lds
s_add_u32 m0, s47, 0x13000
s_add_u32 s32, s29, 0x480080
buffer_load_dwordx4 v234, s[12:15], s32 offen lds
s_add_u32 m0, s47, 0x14000
s_add_u32 s32, s29, 0x480100
buffer_load_dwordx4 v234, s[12:15], s32 offen lds
s_add_u32 m0, s47, 0x15000
s_add_u32 s32, s29, 0x4e0000
buffer_load_dwordx4 v234, s[12:15], s32 offen lds
s_add_u32 m0, s47, 0x16000
s_add_u32 s32, s29, 0x4e0080
buffer_load_dwordx4 v234, s[12:15], s32 offen lds
s_add_u32 m0, s47, 0x17000
s_add_u32 s32, s29, 0x4e0100
buffer_load_dwordx4 v234, s[12:15], s32 offen lds
s_add_u32 m0, s47, 0x1b000
s_add_u32 s32, s31, 0x300
buffer_load_dwordx4 v235, s[20:23], s32 offen lds
s_add_u32 m0, s47, 0x1c000
s_add_u32 s32, s31, 0xa300
buffer_load_dwordx4 v235, s[20:23], s32 offen lds
s_mov_b32 exec_hi, 0
s_add_u32 m0, s46, 0x1d000
s_add_u32 s32, s31, 0x300
buffer_load_dwordx4 v237, s[20:23], s32 offen lds
s_mov_b32 exec_hi, -1
s_add_u32 m0, s47, 0x18000
s_add_u32 s32, s29, 0x540000
buffer_load_dwordx4 v234, s[12:15], s32 offen lds
s_add_u32 m0, s47, 0x19000
s_add_u32 s32, s29, 0x540080
buffer_load_dwordx4 v234, s[12:15], s32 offen lds
s_add_u32 m0, s47, 0x1a000
s_add_u32 s32, s29, 0x540100
buffer_load_dwordx4 v234, s[12:15], s32 offen lds
s_add_u32 m0, s47, 0x1d800
s_add_u32 s32, s31, 0x380
buffer_load_dwordx4 v235, s[20:23], s32 offen lds
s_add_u32 m0, s47, 0x1e800
s_add_u32 s32, s31, 0xa380
buffer_load_dwordx4 v235, s[20:23], s32 offen lds
s_mov_b32 exec_hi, 0
s_add_u32 m0, s46, 0x1f800
s_add_u32 s32, s31, 0x380
buffer_load_dwordx4 v237, s[20:23], s32 offen lds
s_mov_b32 exec_hi, -1
s_waitcnt vmcnt(25)
s_barrier
s_add_u32 m0, s47, 0x0
s_add_u32 s32, s28, 0xffff4000
buffer_load_dwordx4 v233, s[8:11], s32 offen nt lds
s_add_u32 m0, s47, 0x1000
s_add_u32 s32, s28, 0xffff4080
buffer_load_dwordx4 v233, s[8:11], s32 offen nt lds
s_add_u32 m0, s47, 0x2000
s_add_u32 s32, s28, 0xffff4100
buffer_load_dwordx4 v233, s[8:11], s32 offen nt lds
s_add_u32 m0, s47, 0x3000
s_add_u32 s32, s28, 0xffff7000
buffer_load_dwordx4 v233, s[8:11], s32 offen nt lds
s_add_u32 m0, s47, 0x4000
s_add_u32 s32, s28, 0xffff7080
buffer_load_dwordx4 v233, s[8:11], s32 offen nt lds
s_add_u32 m0, s47, 0x5000
s_add_u32 s32, s28, 0xffff7100
buffer_load_dwordx4 v233, s[8:11], s32 offen nt lds
s_waitcnt vmcnt(12)
s_barrier
s_add_u32 m0, s47, 0x6000
s_add_u32 s32, s28, 0xffffa000
buffer_load_dwordx4 v233, s[8:11], s32 offen nt lds
s_add_u32 m0, s47, 0x7000
s_add_u32 s32, s28, 0xffffa080
buffer_load_dwordx4 v233, s[8:11], s32 offen nt lds
s_add_u32 m0, s47, 0x8000
s_add_u32 s32, s28, 0xffffa100
buffer_load_dwordx4 v233, s[8:11], s32 offen nt lds
s_add_u32 m0, s47, 0x9000
s_add_u32 s32, s28, 0xffffd000
buffer_load_dwordx4 v233, s[8:11], s32 offen nt lds
s_add_u32 m0, s47, 0xa000
s_add_u32 s32, s28, 0xffffd080
buffer_load_dwordx4 v233, s[8:11], s32 offen nt lds
s_add_u32 m0, s47, 0xb000
s_add_u32 s32, s28, 0xffffd100
buffer_load_dwordx4 v233, s[8:11], s32 offen nt lds
s_waitcnt vmcnt(12)
s_barrier
s_add_u32 m0, s47, 0xc000
s_add_u32 s32, s29, 0x5a0000
buffer_load_dwordx4 v234, s[12:15], s32 offen lds
s_add_u32 m0, s47, 0xd000
s_add_u32 s32, s29, 0x5a0080
buffer_load_dwordx4 v234, s[12:15], s32 offen lds
s_add_u32 m0, s47, 0xe000
s_add_u32 s32, s29, 0x5a0100
buffer_load_dwordx4 v234, s[12:15], s32 offen lds
s_add_u32 m0, s47, 0x25000
s_add_u32 s32, s31, 0x400
buffer_load_dwordx4 v235, s[20:23], s32 offen lds
s_add_u32 m0, s47, 0x26000
s_add_u32 s32, s31, 0xa400
buffer_load_dwordx4 v235, s[20:23], s32 offen lds
s_mov_b32 exec_hi, 0
s_add_u32 m0, s46, 0x27000
s_add_u32 s32, s31, 0x400
buffer_load_dwordx4 v237, s[20:23], s32 offen lds
s_mov_b32 exec_hi, -1
s_waitcnt vmcnt(12)
s_barrier
s_add_u32 m0, s47, 0xf000
s_add_u32 s32, s29, 0x600000
buffer_load_dwordx4 v234, s[12:15], s32 offen lds
s_add_u32 m0, s47, 0x10000
s_add_u32 s32, s29, 0x600080
buffer_load_dwordx4 v234, s[12:15], s32 offen lds
s_add_u32 m0, s47, 0x11000
s_add_u32 s32, s29, 0x600100
buffer_load_dwordx4 v234, s[12:15], s32 offen lds
s_add_u32 m0, s47, 0x12000
s_add_u32 s32, s29, 0x660000
buffer_load_dwordx4 v234, s[12:15], s32 offen lds
s_add_u32 m0, s47, 0x13000
s_add_u32 s32, s29, 0x660080
buffer_load_dwordx4 v234, s[12:15], s32 offen lds
s_add_u32 m0, s47, 0x14000
s_add_u32 s32, s29, 0x660100
buffer_load_dwordx4 v234, s[12:15], s32 offen lds
s_add_u32 m0, s47, 0x15000
s_add_u32 s32, s29, 0x6c0000
buffer_load_dwordx4 v234, s[12:15], s32 offen lds
s_add_u32 m0, s47, 0x16000
s_add_u32 s32, s29, 0x6c0080
buffer_load_dwordx4 v234, s[12:15], s32 offen lds
s_add_u32 m0, s47, 0x17000
s_add_u32 s32, s29, 0x6c0100
buffer_load_dwordx4 v234, s[12:15], s32 offen lds
s_add_u32 m0, s47, 0x1b000
s_add_u32 s32, s31, 0x480
buffer_load_dwordx4 v235, s[20:23], s32 offen lds
s_add_u32 m0, s47, 0x1c000
s_add_u32 s32, s31, 0xa480
buffer_load_dwordx4 v235, s[20:23], s32 offen lds
s_mov_b32 exec_hi, 0
s_add_u32 m0, s46, 0x1d000
s_add_u32 s32, s31, 0x480
buffer_load_dwordx4 v237, s[20:23], s32 offen lds
s_mov_b32 exec_hi, -1
s_add_u32 m0, s47, 0x18000
s_add_u32 s32, s29, 0x720000
buffer_load_dwordx4 v234, s[12:15], s32 offen lds
s_add_u32 m0, s47, 0x19000
s_add_u32 s32, s29, 0x720080
buffer_load_dwordx4 v234, s[12:15], s32 offen lds
s_add_u32 m0, s47, 0x1a000
s_add_u32 s32, s29, 0x720100
buffer_load_dwordx4 v234, s[12:15], s32 offen lds
s_waitcnt vmcnt(21)
s_barrier
s_add_u32 m0, s47, 0x0
s_add_u32 s32, s28, 0x0
buffer_load_dwordx4 v232, s[4:7], s32 offen nt lds
s_add_u32 m0, s47, 0x2000
s_add_u32 s32, s28, 0x80
buffer_load_dwordx4 v232, s[4:7], s32 offen nt lds
s_add_u32 m0, s47, 0x4000
s_add_u32 s32, s28, 0x100
buffer_load_dwordx4 v232, s[4:7], s32 offen nt lds
s_add_u32 m0, s47, 0x1000
s_add_u32 s32, s28, 0x6000
buffer_load_dwordx4 v232, s[4:7], s32 offen nt lds
s_add_u32 m0, s47, 0x3000
s_add_u32 s32, s28, 0x6080
buffer_load_dwordx4 v232, s[4:7], s32 offen nt lds
s_add_u32 m0, s47, 0x5000
s_add_u32 s32, s28, 0x6100
buffer_load_dwordx4 v232, s[4:7], s32 offen nt lds
s_waitcnt vmcnt(9)
s_barrier
s_add_u32 m0, s47, 0x6000
s_add_u32 s32, s28, 0x1800
buffer_load_dwordx4 v232, s[4:7], s32 offen nt lds
s_add_u32 m0, s47, 0x8000
s_add_u32 s32, s28, 0x1880
buffer_load_dwordx4 v232, s[4:7], s32 offen nt lds
s_add_u32 m0, s47, 0xa000
s_add_u32 s32, s28, 0x1900
buffer_load_dwordx4 v232, s[4:7], s32 offen nt lds
s_add_u32 m0, s47, 0x7000
s_add_u32 s32, s28, 0x7800
buffer_load_dwordx4 v232, s[4:7], s32 offen nt lds
s_add_u32 m0, s47, 0x9000
s_add_u32 s32, s28, 0x7880
buffer_load_dwordx4 v232, s[4:7], s32 offen nt lds
s_add_u32 m0, s47, 0xb000
s_add_u32 s32, s28, 0x7900
buffer_load_dwordx4 v232, s[4:7], s32 offen nt lds
s_waitcnt vmcnt(12)
s_barrier
s_add_u32 m0, s47, 0xc000
s_add_u32 s32, s30, 0xfffc4000
buffer_load_dwordx4 v236, s[16:19], s32 offen lds
s_add_u32 m0, s47, 0xd000
s_add_u32 s32, s30, 0xfffc4080
buffer_load_dwordx4 v236, s[16:19], s32 offen lds
s_add_u32 m0, s47, 0xe000
s_add_u32 s32, s30, 0xfffc4100
buffer_load_dwordx4 v236, s[16:19], s32 offen lds
s_barrier
s_add_u32 m0, s47, 0xf000
s_add_u32 s32, s30, 0xfffc4180
buffer_load_dwordx4 v236, s[16:19], s32 offen lds
s_add_u32 m0, s47, 0x10000
s_add_u32 s32, s30, 0xfffc4200
buffer_load_dwordx4 v236, s[16:19], s32 offen lds
s_add_u32 m0, s47, 0x11000
s_add_u32 s32, s30, 0xfffc4280
buffer_load_dwordx4 v236, s[16:19], s32 offen lds
s_add_u32 m0, s47, 0x12000
s_add_u32 s32, s30, 0xfffc4300
buffer_load_dwordx4 v236, s[16:19], s32 offen lds
s_add_u32 m0, s47, 0x13000
s_add_u32 s32, s30, 0xfffc4380
buffer_load_dwordx4 v236, s[16:19], s32 offen lds
s_add_u32 m0, s47, 0x14000
s_add_u32 s32, s30, 0xfffc4400
buffer_load_dwordx4 v236, s[16:19], s32 offen lds
s_add_u32 m0, s47, 0x15000
s_add_u32 s32, s30, 0xfffc4480
buffer_load_dwordx4 v236, s[16:19], s32 offen lds
s_add_u32 m0, s47, 0x16000
s_add_u32 s32, s30, 0xfffce000
buffer_load_dwordx4 v236, s[16:19], s32 offen lds
s_add_u32 m0, s47, 0x17000
s_add_u32 s32, s30, 0xfffce080
buffer_load_dwordx4 v236, s[16:19], s32 offen lds
s_waitcnt vmcnt(18)
s_barrier
s_waitcnt vmcnt(12)
s_barrier
s_add_u32 m0, s47, 0x18000
s_add_u32 s32, s30, 0xfffce100
buffer_load_dwordx4 v236, s[16:19], s32 offen lds
s_add_u32 m0, s47, 0x19000
s_add_u32 s32, s30, 0xfffce180
buffer_load_dwordx4 v236, s[16:19], s32 offen lds
s_add_u32 m0, s47, 0x1a000
s_add_u32 s32, s30, 0xfffce200
buffer_load_dwordx4 v236, s[16:19], s32 offen lds
s_add_u32 m0, s47, 0x0
s_add_u32 s32, s28, 0xc000
buffer_load_dwordx4 v232, s[4:7], s32 offen nt lds
s_add_u32 m0, s47, 0x2000
s_add_u32 s32, s28, 0xc080
buffer_load_dwordx4 v232, s[4:7], s32 offen nt lds
s_add_u32 m0, s47, 0x4000
s_add_u32 s32, s28, 0xc100
buffer_load_dwordx4 v232, s[4:7], s32 offen nt lds
s_add_u32 m0, s47, 0x1000
s_add_u32 s32, s28, 0x12000
buffer_load_dwordx4 v232, s[4:7], s32 offen nt lds
s_add_u32 m0, s47, 0x3000
s_add_u32 s32, s28, 0x12080
buffer_load_dwordx4 v232, s[4:7], s32 offen nt lds
s_add_u32 m0, s47, 0x5000
s_add_u32 s32, s28, 0x12100
buffer_load_dwordx4 v232, s[4:7], s32 offen nt lds
s_waitcnt vmcnt(9)
s_barrier
ds_read_b64_tr_b16 v[220:221], v238 offset:0
ds_read_b64_tr_b16 v[222:223], v238 offset:2048
ds_read_b128 v[200:203], v239 offset:0
ds_read_b128 v[204:207], v239 offset:1024
ds_read_b128 v[208:211], v239 offset:2048
ds_read_b128 v[212:215], v239 offset:3072
ds_read_b128 v[216:219], v239 offset:4096
ds_read_b64_tr_b16 v[224:225], v238 offset:4096
ds_read_b64_tr_b16 v[226:227], v238 offset:6144
ds_read_b64_tr_b16 v[228:229], v238 offset:8192
ds_read_b64_tr_b16 v[230:231], v238 offset:10240
s_add_u32 m0, s47, 0x6000
s_add_u32 s32, s28, 0xd800
buffer_load_dwordx4 v232, s[4:7], s32 offen nt lds
s_waitcnt lgkmcnt(8)
v_mfma_f32_16x16x32_bf16 v[0:3], v[220:223], v[200:203], v[0:3]
s_waitcnt lgkmcnt(7)
v_mfma_f32_16x16x32_bf16 v[4:7], v[220:223], v[204:207], v[4:7]
s_waitcnt lgkmcnt(6)
v_mfma_f32_16x16x32_bf16 v[8:11], v[220:223], v[208:211], v[8:11]
s_waitcnt lgkmcnt(5)
v_mfma_f32_16x16x32_bf16 v[12:15], v[220:223], v[212:215], v[12:15]
s_waitcnt lgkmcnt(4)
v_mfma_f32_16x16x32_bf16 v[16:19], v[220:223], v[216:219], v[16:19]
ds_read_b64_tr_b16 v[220:221], v238 offset:12288
ds_read_b64_tr_b16 v[222:223], v238 offset:14336
s_add_u32 m0, s47, 0x8000
s_add_u32 s32, s28, 0xd880
buffer_load_dwordx4 v232, s[4:7], s32 offen nt lds
s_waitcnt lgkmcnt(4)
v_mfma_f32_16x16x32_bf16 v[20:23], v[224:227], v[200:203], v[20:23]
v_mfma_f32_16x16x32_bf16 v[24:27], v[224:227], v[204:207], v[24:27]
v_mfma_f32_16x16x32_bf16 v[28:31], v[224:227], v[208:211], v[28:31]
v_mfma_f32_16x16x32_bf16 v[32:35], v[224:227], v[212:215], v[32:35]
v_mfma_f32_16x16x32_bf16 v[36:39], v[224:227], v[216:219], v[36:39]
ds_read_b64_tr_b16 v[224:225], v238 offset:16384
ds_read_b64_tr_b16 v[226:227], v238 offset:18432
s_add_u32 m0, s47, 0xa000
s_add_u32 s32, s28, 0xd900
buffer_load_dwordx4 v232, s[4:7], s32 offen nt lds
s_waitcnt lgkmcnt(4)
v_mfma_f32_16x16x32_bf16 v[40:43], v[228:231], v[200:203], v[40:43]
v_mfma_f32_16x16x32_bf16 v[44:47], v[228:231], v[204:207], v[44:47]
v_mfma_f32_16x16x32_bf16 v[48:51], v[228:231], v[208:211], v[48:51]
v_mfma_f32_16x16x32_bf16 v[52:55], v[228:231], v[212:215], v[52:55]
v_mfma_f32_16x16x32_bf16 v[56:59], v[228:231], v[216:219], v[56:59]
ds_read_b64_tr_b16 v[228:229], v238 offset:20480
ds_read_b64_tr_b16 v[230:231], v238 offset:22528
s_add_u32 m0, s47, 0x7000
s_add_u32 s32, s28, 0x13800
buffer_load_dwordx4 v232, s[4:7], s32 offen nt lds
s_waitcnt lgkmcnt(4)
v_mfma_f32_16x16x32_bf16 v[60:63], v[220:223], v[200:203], v[60:63]
v_mfma_f32_16x16x32_bf16 v[64:67], v[220:223], v[204:207], v[64:67]
v_mfma_f32_16x16x32_bf16 v[68:71], v[220:223], v[208:211], v[68:71]
v_mfma_f32_16x16x32_bf16 v[72:75], v[220:223], v[212:215], v[72:75]
v_mfma_f32_16x16x32_bf16 v[76:79], v[220:223], v[216:219], v[76:79]
ds_read_b64_tr_b16 v[220:221], v238 offset:24576
ds_read_b64_tr_b16 v[222:223], v238 offset:26624
s_add_u32 m0, s47, 0x9000
s_add_u32 s32, s28, 0x13880
buffer_load_dwordx4 v232, s[4:7], s32 offen nt lds
s_waitcnt lgkmcnt(4)
v_mfma_f32_16x16x32_bf16 v[80:83], v[224:227], v[200:203], v[80:83]
v_mfma_f32_16x16x32_bf16 v[84:87], v[224:227], v[204:207], v[84:87]
v_mfma_f32_16x16x32_bf16 v[88:91], v[224:227], v[208:211], v[88:91]
v_mfma_f32_16x16x32_bf16 v[92:95], v[224:227], v[212:215], v[92:95]
v_mfma_f32_16x16x32_bf16 v[96:99], v[224:227], v[216:219], v[96:99]
ds_read_b64_tr_b16 v[224:225], v238 offset:28672
ds_read_b64_tr_b16 v[226:227], v238 offset:30720
s_add_u32 m0, s47, 0xb000
s_add_u32 s32, s28, 0x13900
buffer_load_dwordx4 v232, s[4:7], s32 offen nt lds
s_waitcnt lgkmcnt(4)
v_mfma_f32_16x16x32_bf16 v[100:103], v[228:231], v[200:203], v[100:103]
v_mfma_f32_16x16x32_bf16 v[104:107], v[228:231], v[204:207], v[104:107]
v_mfma_f32_16x16x32_bf16 v[108:111], v[228:231], v[208:211], v[108:111]
v_mfma_f32_16x16x32_bf16 v[112:115], v[228:231], v[212:215], v[112:115]
v_mfma_f32_16x16x32_bf16 v[116:119], v[228:231], v[216:219], v[116:119]
ds_read_b64_tr_b16 v[228:229], v238 offset:32768
ds_read_b64_tr_b16 v[230:231], v238 offset:34816
s_waitcnt lgkmcnt(4)
v_mfma_f32_16x16x32_bf16 v[120:123], v[220:223], v[200:203], v[120:123]
v_mfma_f32_16x16x32_bf16 v[124:127], v[220:223], v[204:207], v[124:127]
v_mfma_f32_16x16x32_bf16 v[128:131], v[220:223], v[208:211], v[128:131]
v_mfma_f32_16x16x32_bf16 v[132:135], v[220:223], v[212:215], v[132:135]
v_mfma_f32_16x16x32_bf16 v[136:139], v[220:223], v[216:219], v[136:139]
ds_read_b64_tr_b16 v[220:221], v238 offset:36864
ds_read_b64_tr_b16 v[222:223], v238 offset:38912
s_waitcnt lgkmcnt(4)
v_mfma_f32_16x16x32_bf16 v[140:143], v[224:227], v[200:203], v[140:143]
v_mfma_f32_16x16x32_bf16 v[144:147], v[224:227], v[204:207], v[144:147]
v_mfma_f32_16x16x32_bf16 v[148:151], v[224:227], v[208:211], v[148:151]
v_mfma_f32_16x16x32_bf16 v[152:155], v[224:227], v[212:215], v[152:155]
v_mfma_f32_16x16x32_bf16 v[156:159], v[224:227], v[216:219], v[156:159]
ds_read_b64_tr_b16 v[224:225], v238 offset:40960
ds_read_b64_tr_b16 v[226:227], v238 offset:43008
s_waitcnt lgkmcnt(4)
v_mfma_f32_16x16x32_bf16 v[160:163], v[228:231], v[200:203], v[160:163]
v_mfma_f32_16x16x32_bf16 v[164:167], v[228:231], v[204:207], v[164:167]
v_mfma_f32_16x16x32_bf16 v[168:171], v[228:231], v[208:211], v[168:171]
v_mfma_f32_16x16x32_bf16 v[172:175], v[228:231], v[212:215], v[172:175]
v_mfma_f32_16x16x32_bf16 v[176:179], v[228:231], v[216:219], v[176:179]
ds_read_b64_tr_b16 v[228:229], v238 offset:45056
ds_read_b64_tr_b16 v[230:231], v238 offset:47104
s_waitcnt vmcnt(12)
s_barrier
s_waitcnt lgkmcnt(4)
v_mfma_f32_16x16x32_bf16 v[180:183], v[220:223], v[200:203], v[180:183]
ds_read_b128 v[200:203], v239 offset:5120
v_mfma_f32_16x16x32_bf16 v[184:187], v[220:223], v[204:207], v[184:187]
ds_read_b128 v[204:207], v239 offset:6144
v_mfma_f32_16x16x32_bf16 v[188:191], v[220:223], v[208:211], v[188:191]
ds_read_b128 v[208:211], v239 offset:7168
v_mfma_f32_16x16x32_bf16 v[192:195], v[220:223], v[212:215], v[192:195]
ds_read_b128 v[212:215], v239 offset:8192
v_mfma_f32_16x16x32_bf16 v[196:199], v[220:223], v[216:219], v[196:199]
ds_read_b128 v[216:219], v239 offset:9216
ds_read_b64_tr_b16 v[220:221], v238 offset:49152
ds_read_b64_tr_b16 v[222:223], v238 offset:51200
s_waitcnt lgkmcnt(6)
v_mfma_f32_16x16x32_bf16 v[0:3], v[224:227], v[200:203], v[0:3]
s_waitcnt lgkmcnt(5)
v_mfma_f32_16x16x32_bf16 v[4:7], v[224:227], v[204:207], v[4:7]
s_waitcnt lgkmcnt(4)
v_mfma_f32_16x16x32_bf16 v[8:11], v[224:227], v[208:211], v[8:11]
s_waitcnt lgkmcnt(3)
v_mfma_f32_16x16x32_bf16 v[12:15], v[224:227], v[212:215], v[12:15]
s_waitcnt lgkmcnt(2)
v_mfma_f32_16x16x32_bf16 v[16:19], v[224:227], v[216:219], v[16:19]
ds_read_b64_tr_b16 v[224:225], v238 offset:53248
ds_read_b64_tr_b16 v[226:227], v238 offset:55296
v_mfma_f32_16x16x32_bf16 v[20:23], v[228:231], v[200:203], v[20:23]
v_mfma_f32_16x16x32_bf16 v[24:27], v[228:231], v[204:207], v[24:27]
v_mfma_f32_16x16x32_bf16 v[28:31], v[228:231], v[208:211], v[28:31]
v_mfma_f32_16x16x32_bf16 v[32:35], v[228:231], v[212:215], v[32:35]
v_mfma_f32_16x16x32_bf16 v[36:39], v[228:231], v[216:219], v[36:39]
ds_read_b64_tr_b16 v[228:229], v238 offset:57344
ds_read_b64_tr_b16 v[230:231], v238 offset:59392
s_waitcnt lgkmcnt(4)
v_mfma_f32_16x16x32_bf16 v[40:43], v[220:223], v[200:203], v[40:43]
v_mfma_f32_16x16x32_bf16 v[44:47], v[220:223], v[204:207], v[44:47]
v_mfma_f32_16x16x32_bf16 v[48:51], v[220:223], v[208:211], v[48:51]
v_mfma_f32_16x16x32_bf16 v[52:55], v[220:223], v[212:215], v[52:55]
v_mfma_f32_16x16x32_bf16 v[56:59], v[220:223], v[216:219], v[56:59]
s_waitcnt lgkmcnt(2)
v_mfma_f32_16x16x32_bf16 v[60:63], v[224:227], v[200:203], v[60:63]
v_mfma_f32_16x16x32_bf16 v[64:67], v[224:227], v[204:207], v[64:67]
v_mfma_f32_16x16x32_bf16 v[68:71], v[224:227], v[208:211], v[68:71]
v_mfma_f32_16x16x32_bf16 v[72:75], v[224:227], v[212:215], v[72:75]
v_mfma_f32_16x16x32_bf16 v[76:79], v[224:227], v[216:219], v[76:79]
s_waitcnt lgkmcnt(0)
v_mfma_f32_16x16x32_bf16 v[80:83], v[228:231], v[200:203], v[80:83]
v_mfma_f32_16x16x32_bf16 v[84:87], v[228:231], v[204:207], v[84:87]
v_mfma_f32_16x16x32_bf16 v[88:91], v[228:231], v[208:211], v[88:91]
v_mfma_f32_16x16x32_bf16 v[92:95], v[228:231], v[212:215], v[92:95]
v_mfma_f32_16x16x32_bf16 v[96:99], v[228:231], v[216:219], v[96:99]
s_add_u32 m0, s47, 0xc000
s_add_u32 s32, s30, 0xfffce280
buffer_load_dwordx4 v236, s[16:19], s32 offen lds
s_add_u32 m0, s47, 0xd000
s_add_u32 s32, s30, 0xfffce300
buffer_load_dwordx4 v236, s[16:19], s32 offen lds
s_add_u32 m0, s47, 0xe000
s_add_u32 s32, s30, 0xfffce380
buffer_load_dwordx4 v236, s[16:19], s32 offen lds
s_waitcnt vmcnt(9)
s_barrier
s_add_u32 m0, s47, 0xf000
s_add_u32 s32, s30, 0xfffce400
buffer_load_dwordx4 v236, s[16:19], s32 offen lds
s_add_u32 m0, s47, 0x10000
s_add_u32 s32, s30, 0xfffce480
buffer_load_dwordx4 v236, s[16:19], s32 offen lds
s_add_u32 m0, s47, 0x11000
s_add_u32 s32, s30, 0xfffd8000
buffer_load_dwordx4 v236, s[16:19], s32 offen lds
s_add_u32 m0, s47, 0x12000
s_add_u32 s32, s30, 0xfffd8080
buffer_load_dwordx4 v236, s[16:19], s32 offen lds
s_add_u32 m0, s47, 0x13000
s_add_u32 s32, s30, 0xfffd8100
buffer_load_dwordx4 v236, s[16:19], s32 offen lds
s_add_u32 m0, s47, 0x14000
s_add_u32 s32, s30, 0xfffd8180
buffer_load_dwordx4 v236, s[16:19], s32 offen lds
s_add_u32 m0, s47, 0x15000
s_add_u32 s32, s30, 0xfffd8200
buffer_load_dwordx4 v236, s[16:19], s32 offen lds
s_add_u32 m0, s47, 0x16000
s_add_u32 s32, s30, 0xfffd8280
buffer_load_dwordx4 v236, s[16:19], s32 offen lds
s_add_u32 m0, s47, 0x17000
s_add_u32 s32, s30, 0xfffd8300
buffer_load_dwordx4 v236, s[16:19], s32 offen lds
s_add_u32 m0, s47, 0x18000
s_add_u32 s32, s30, 0xfffd8380
buffer_load_dwordx4 v236, s[16:19], s32 offen lds
s_add_u32 m0, s47, 0x19000
s_add_u32 s32, s30, 0xfffd8400
buffer_load_dwordx4 v236, s[16:19], s32 offen lds
s_add_u32 m0, s47, 0x1a000
s_add_u32 s32, s30, 0xfffd8480
buffer_load_dwordx4 v236, s[16:19], s32 offen lds
s_waitcnt vmcnt(15)
s_barrier
s_add_u32 m0, s47, 0x0
s_add_u32 s32, s28, 0x18000
buffer_load_dwordx4 v232, s[4:7], s32 offen nt lds
s_add_u32 m0, s47, 0x2000
s_add_u32 s32, s28, 0x18080
buffer_load_dwordx4 v232, s[4:7], s32 offen nt lds
s_add_u32 m0, s47, 0x4000
s_add_u32 s32, s28, 0x18100
buffer_load_dwordx4 v232, s[4:7], s32 offen nt lds
s_add_u32 m0, s47, 0x1000
s_add_u32 s32, s28, 0x1e000
buffer_load_dwordx4 v232, s[4:7], s32 offen nt lds
s_add_u32 m0, s47, 0x3000
s_add_u32 s32, s28, 0x1e080
buffer_load_dwordx4 v232, s[4:7], s32 offen nt lds
s_add_u32 m0, s47, 0x5000
s_add_u32 s32, s28, 0x1e100
buffer_load_dwordx4 v232, s[4:7], s32 offen nt lds
s_waitcnt vmcnt(9)
s_barrier
ds_read_b64_tr_b16 v[220:221], v238 offset:0
ds_read_b64_tr_b16 v[222:223], v238 offset:2048
ds_read_b64_tr_b16 v[224:225], v238 offset:4096
ds_read_b64_tr_b16 v[226:227], v238 offset:6144
ds_read_b64_tr_b16 v[228:229], v238 offset:8192
ds_read_b64_tr_b16 v[230:231], v238 offset:10240
s_add_u32 m0, s47, 0x6000
s_add_u32 s32, s28, 0x19800
buffer_load_dwordx4 v232, s[4:7], s32 offen nt lds
s_waitcnt lgkmcnt(4)
v_mfma_f32_16x16x32_bf16 v[100:103], v[220:223], v[200:203], v[100:103]
v_mfma_f32_16x16x32_bf16 v[104:107], v[220:223], v[204:207], v[104:107]
v_mfma_f32_16x16x32_bf16 v[108:111], v[220:223], v[208:211], v[108:111]
v_mfma_f32_16x16x32_bf16 v[112:115], v[220:223], v[212:215], v[112:115]
v_mfma_f32_16x16x32_bf16 v[116:119], v[220:223], v[216:219], v[116:119]
ds_read_b64_tr_b16 v[220:221], v238 offset:12288
ds_read_b64_tr_b16 v[222:223], v238 offset:14336
s_add_u32 m0, s47, 0x8000
s_add_u32 s32, s28, 0x19880
buffer_load_dwordx4 v232, s[4:7], s32 offen nt lds
s_waitcnt lgkmcnt(4)
v_mfma_f32_16x16x32_bf16 v[120:123], v[224:227], v[200:203], v[120:123]
v_mfma_f32_16x16x32_bf16 v[124:127], v[224:227], v[204:207], v[124:127]
v_mfma_f32_16x16x32_bf16 v[128:131], v[224:227], v[208:211], v[128:131]
v_mfma_f32_16x16x32_bf16 v[132:135], v[224:227], v[212:215], v[132:135]
v_mfma_f32_16x16x32_bf16 v[136:139], v[224:227], v[216:219], v[136:139]
ds_read_b64_tr_b16 v[224:225], v238 offset:16384
ds_read_b64_tr_b16 v[226:227], v238 offset:18432
s_add_u32 m0, s47, 0xa000
s_add_u32 s32, s28, 0x19900
buffer_load_dwordx4 v232, s[4:7], s32 offen nt lds
s_waitcnt lgkmcnt(4)
v_mfma_f32_16x16x32_bf16 v[140:143], v[228:231], v[200:203], v[140:143]
v_mfma_f32_16x16x32_bf16 v[144:147], v[228:231], v[204:207], v[144:147]
v_mfma_f32_16x16x32_bf16 v[148:151], v[228:231], v[208:211], v[148:151]
v_mfma_f32_16x16x32_bf16 v[152:155], v[228:231], v[212:215], v[152:155]
v_mfma_f32_16x16x32_bf16 v[156:159], v[228:231], v[216:219], v[156:159]
ds_read_b64_tr_b16 v[228:229], v238 offset:20480
ds_read_b64_tr_b16 v[230:231], v238 offset:22528
s_add_u32 m0, s47, 0x7000
s_add_u32 s32, s28, 0x1f800
buffer_load_dwordx4 v232, s[4:7], s32 offen nt lds
s_waitcnt lgkmcnt(4)
v_mfma_f32_16x16x32_bf16 v[160:163], v[220:223], v[200:203], v[160:163]
v_mfma_f32_16x16x32_bf16 v[164:167], v[220:223], v[204:207], v[164:167]
v_mfma_f32_16x16x32_bf16 v[168:171], v[220:223], v[208:211], v[168:171]
v_mfma_f32_16x16x32_bf16 v[172:175], v[220:223], v[212:215], v[172:175]
v_mfma_f32_16x16x32_bf16 v[176:179], v[220:223], v[216:219], v[176:179]
ds_read_b64_tr_b16 v[220:221], v238 offset:24576
ds_read_b64_tr_b16 v[222:223], v238 offset:26624
s_add_u32 m0, s47, 0x9000
s_add_u32 s32, s28, 0x1f880
buffer_load_dwordx4 v232, s[4:7], s32 offen nt lds
s_waitcnt lgkmcnt(4)
v_mfma_f32_16x16x32_bf16 v[180:183], v[224:227], v[200:203], v[180:183]
ds_read_b128 v[200:203], v239 offset:10240
v_mfma_f32_16x16x32_bf16 v[184:187], v[224:227], v[204:207], v[184:187]
ds_read_b128 v[204:207], v239 offset:11264
v_mfma_f32_16x16x32_bf16 v[188:191], v[224:227], v[208:211], v[188:191]
ds_read_b128 v[208:211], v239 offset:12288
v_mfma_f32_16x16x32_bf16 v[192:195], v[224:227], v[212:215], v[192:195]
ds_read_b128 v[212:215], v239 offset:13312
v_mfma_f32_16x16x32_bf16 v[196:199], v[224:227], v[216:219], v[196:199]
ds_read_b128 v[216:219], v239 offset:14336
ds_read_b64_tr_b16 v[224:225], v238 offset:28672
ds_read_b64_tr_b16 v[226:227], v238 offset:30720
s_add_u32 m0, s47, 0xb000
s_add_u32 s32, s28, 0x1f900
buffer_load_dwordx4 v232, s[4:7], s32 offen nt lds
s_waitcnt lgkmcnt(6)
v_mfma_f32_16x16x32_bf16 v[0:3], v[228:231], v[200:203], v[0:3]
s_waitcnt lgkmcnt(5)
v_mfma_f32_16x16x32_bf16 v[4:7], v[228:231], v[204:207], v[4:7]
s_waitcnt lgkmcnt(4)
v_mfma_f32_16x16x32_bf16 v[8:11], v[228:231], v[208:211], v[8:11]
s_waitcnt lgkmcnt(3)
v_mfma_f32_16x16x32_bf16 v[12:15], v[228:231], v[212:215], v[12:15]
s_waitcnt lgkmcnt(2)
v_mfma_f32_16x16x32_bf16 v[16:19], v[228:231], v[216:219], v[16:19]
ds_read_b64_tr_b16 v[228:229], v238 offset:32768
ds_read_b64_tr_b16 v[230:231], v238 offset:34816
s_add_u32 s32, s29, 0x180
buffer_load_dword v244, v242, s[12:15], s32 offen
v_mfma_f32_16x16x32_bf16 v[20:23], v[220:223], v[200:203], v[20:23]
v_mfma_f32_16x16x32_bf16 v[24:27], v[220:223], v[204:207], v[24:27]
v_mfma_f32_16x16x32_bf16 v[28:31], v[220:223], v[208:211], v[28:31]
v_mfma_f32_16x16x32_bf16 v[32:35], v[220:223], v[212:215], v[32:35]
v_mfma_f32_16x16x32_bf16 v[36:39], v[220:223], v[216:219], v[36:39]
ds_read_b64_tr_b16 v[220:221], v238 offset:36864
ds_read_b64_tr_b16 v[222:223], v238 offset:38912
s_waitcnt lgkmcnt(4)
v_mfma_f32_16x16x32_bf16 v[40:43], v[224:227], v[200:203], v[40:43]
v_mfma_f32_16x16x32_bf16 v[44:47], v[224:227], v[204:207], v[44:47]
v_mfma_f32_16x16x32_bf16 v[48:51], v[224:227], v[208:211], v[48:51]
v_mfma_f32_16x16x32_bf16 v[52:55], v[224:227], v[212:215], v[52:55]
v_mfma_f32_16x16x32_bf16 v[56:59], v[224:227], v[216:219], v[56:59]
ds_read_b64_tr_b16 v[224:225], v238 offset:40960
ds_read_b64_tr_b16 v[226:227], v238 offset:43008
s_waitcnt lgkmcnt(4)
v_mfma_f32_16x16x32_bf16 v[60:63], v[228:231], v[200:203], v[60:63]
v_mfma_f32_16x16x32_bf16 v[64:67], v[228:231], v[204:207], v[64:67]
v_mfma_f32_16x16x32_bf16 v[68:71], v[228:231], v[208:211], v[68:71]
v_mfma_f32_16x16x32_bf16 v[72:75], v[228:231], v[212:215], v[72:75]
v_mfma_f32_16x16x32_bf16 v[76:79], v[228:231], v[216:219], v[76:79]
ds_read_b64_tr_b16 v[228:229], v238 offset:45056
ds_read_b64_tr_b16 v[230:231], v238 offset:47104
s_waitcnt vmcnt(13)
s_barrier
s_waitcnt lgkmcnt(4)
v_mfma_f32_16x16x32_bf16 v[80:83], v[220:223], v[200:203], v[80:83]
v_mfma_f32_16x16x32_bf16 v[84:87], v[220:223], v[204:207], v[84:87]
v_mfma_f32_16x16x32_bf16 v[88:91], v[220:223], v[208:211], v[88:91]
v_mfma_f32_16x16x32_bf16 v[92:95], v[220:223], v[212:215], v[92:95]
v_mfma_f32_16x16x32_bf16 v[96:99], v[220:223], v[216:219], v[96:99]
ds_read_b64_tr_b16 v[220:221], v238 offset:49152
ds_read_b64_tr_b16 v[222:223], v238 offset:51200
s_waitcnt lgkmcnt(4)
v_mfma_f32_16x16x32_bf16 v[100:103], v[224:227], v[200:203], v[100:103]
v_mfma_f32_16x16x32_bf16 v[104:107], v[224:227], v[204:207], v[104:107]
v_mfma_f32_16x16x32_bf16 v[108:111], v[224:227], v[208:211], v[108:111]
v_mfma_f32_16x16x32_bf16 v[112:115], v[224:227], v[212:215], v[112:115]
v_mfma_f32_16x16x32_bf16 v[116:119], v[224:227], v[216:219], v[116:119]
ds_read_b64_tr_b16 v[224:225], v238 offset:53248
ds_read_b64_tr_b16 v[226:227], v238 offset:55296
s_waitcnt lgkmcnt(4)
v_mfma_f32_16x16x32_bf16 v[120:123], v[228:231], v[200:203], v[120:123]
v_mfma_f32_16x16x32_bf16 v[124:127], v[228:231], v[204:207], v[124:127]
v_mfma_f32_16x16x32_bf16 v[128:131], v[228:231], v[208:211], v[128:131]
v_mfma_f32_16x16x32_bf16 v[132:135], v[228:231], v[212:215], v[132:135]
v_mfma_f32_16x16x32_bf16 v[136:139], v[228:231], v[216:219], v[136:139]
ds_read_b64_tr_b16 v[228:229], v238 offset:57344
ds_read_b64_tr_b16 v[230:231], v238 offset:59392
s_waitcnt lgkmcnt(4)
v_mfma_f32_16x16x32_bf16 v[140:143], v[220:223], v[200:203], v[140:143]
v_mfma_f32_16x16x32_bf16 v[144:147], v[220:223], v[204:207], v[144:147]
v_mfma_f32_16x16x32_bf16 v[148:151], v[220:223], v[208:211], v[148:151]
v_mfma_f32_16x16x32_bf16 v[152:155], v[220:223], v[212:215], v[152:155]
v_mfma_f32_16x16x32_bf16 v[156:159], v[220:223], v[216:219], v[156:159]
s_waitcnt lgkmcnt(2)
v_mfma_f32_16x16x32_bf16 v[160:163], v[224:227], v[200:203], v[160:163]
v_mfma_f32_16x16x32_bf16 v[164:167], v[224:227], v[204:207], v[164:167]
v_mfma_f32_16x16x32_bf16 v[168:171], v[224:227], v[208:211], v[168:171]
v_mfma_f32_16x16x32_bf16 v[172:175], v[224:227], v[212:215], v[172:175]
v_mfma_f32_16x16x32_bf16 v[176:179], v[224:227], v[216:219], v[176:179]
s_waitcnt lgkmcnt(0)
v_mfma_f32_16x16x32_bf16 v[180:183], v[228:231], v[200:203], v[180:183]
ds_read_b128 v[200:203], v239 offset:15360
v_mfma_f32_16x16x32_bf16 v[184:187], v[228:231], v[204:207], v[184:187]
ds_read_b128 v[204:207], v239 offset:16384
v_mfma_f32_16x16x32_bf16 v[188:191], v[228:231], v[208:211], v[188:191]
ds_read_b128 v[208:211], v239 offset:17408
v_mfma_f32_16x16x32_bf16 v[192:195], v[228:231], v[212:215], v[192:195]
ds_read_b128 v[212:215], v239 offset:18432
v_mfma_f32_16x16x32_bf16 v[196:199], v[228:231], v[216:219], v[196:199]
ds_read_b128 v[216:219], v239 offset:19456
s_add_u32 m0, s47, 0xc000
s_add_u32 s32, s30, 0xfffe2000
buffer_load_dwordx4 v236, s[16:19], s32 offen lds
s_add_u32 m0, s47, 0xd000
s_add_u32 s32, s30, 0xfffe2080
buffer_load_dwordx4 v236, s[16:19], s32 offen lds
s_add_u32 m0, s47, 0xe000
s_add_u32 s32, s30, 0xfffe2100
buffer_load_dwordx4 v236, s[16:19], s32 offen lds
s_waitcnt vmcnt(10)
s_barrier
s_add_u32 m0, s47, 0xf000
s_add_u32 s32, s30, 0xfffe2180
buffer_load_dwordx4 v236, s[16:19], s32 offen lds
s_add_u32 m0, s47, 0x10000
s_add_u32 s32, s30, 0xfffe2200
buffer_load_dwordx4 v236, s[16:19], s32 offen lds
s_add_u32 m0, s47, 0x11000
s_add_u32 s32, s30, 0xfffe2280
buffer_load_dwordx4 v236, s[16:19], s32 offen lds
s_add_u32 m0, s47, 0x12000
s_add_u32 s32, s30, 0xfffe2300
buffer_load_dwordx4 v236, s[16:19], s32 offen lds
s_add_u32 m0, s47, 0x13000
s_add_u32 s32, s30, 0xfffe2380
buffer_load_dwordx4 v236, s[16:19], s32 offen lds
s_add_u32 m0, s47, 0x14000
s_add_u32 s32, s30, 0xfffe2400
buffer_load_dwordx4 v236, s[16:19], s32 offen lds
s_add_u32 m0, s47, 0x15000
s_add_u32 s32, s30, 0xfffe2480
buffer_load_dwordx4 v236, s[16:19], s32 offen lds
s_add_u32 m0, s47, 0x16000
s_add_u32 s32, s30, 0xfffec000
buffer_load_dwordx4 v236, s[16:19], s32 offen lds
s_add_u32 m0, s47, 0x17000
s_add_u32 s32, s30, 0xfffec080
buffer_load_dwordx4 v236, s[16:19], s32 offen lds
s_add_u32 m0, s47, 0x18000
s_add_u32 s32, s30, 0xfffec100
buffer_load_dwordx4 v236, s[16:19], s32 offen lds
s_add_u32 m0, s47, 0x19000
s_add_u32 s32, s30, 0xfffec180
buffer_load_dwordx4 v236, s[16:19], s32 offen lds
s_add_u32 m0, s47, 0x1a000
s_add_u32 s32, s30, 0xfffec200
buffer_load_dwordx4 v236, s[16:19], s32 offen lds
s_waitcnt vmcnt(16)
s_barrier
s_add_u32 m0, s47, 0x0
s_add_u32 s32, s28, 0x24000
buffer_load_dwordx4 v232, s[4:7], s32 offen nt lds
s_add_u32 m0, s47, 0x2000
s_add_u32 s32, s28, 0x24080
buffer_load_dwordx4 v232, s[4:7], s32 offen nt lds
s_add_u32 m0, s47, 0x4000
s_add_u32 s32, s28, 0x24100
buffer_load_dwordx4 v232, s[4:7], s32 offen nt lds
s_add_u32 m0, s47, 0x1000
s_add_u32 s32, s28, 0x2a000
buffer_load_dwordx4 v232, s[4:7], s32 offen nt lds
s_add_u32 m0, s47, 0x3000
s_add_u32 s32, s28, 0x2a080
buffer_load_dwordx4 v232, s[4:7], s32 offen nt lds
s_add_u32 m0, s47, 0x5000
s_add_u32 s32, s28, 0x2a100
buffer_load_dwordx4 v232, s[4:7], s32 offen nt lds
s_waitcnt vmcnt(9)
s_barrier
ds_read_b64_tr_b16 v[220:221], v238 offset:0
ds_read_b64_tr_b16 v[222:223], v238 offset:2048
ds_read_b64_tr_b16 v[224:225], v238 offset:4096
ds_read_b64_tr_b16 v[226:227], v238 offset:6144
ds_read_b64_tr_b16 v[228:229], v238 offset:8192
ds_read_b64_tr_b16 v[230:231], v238 offset:10240
s_add_u32 m0, s47, 0x6000
s_add_u32 s32, s28, 0x25800
buffer_load_dwordx4 v232, s[4:7], s32 offen nt lds
s_waitcnt lgkmcnt(4)
v_mfma_f32_16x16x32_bf16 v[0:3], v[220:223], v[200:203], v[0:3]
v_mfma_f32_16x16x32_bf16 v[4:7], v[220:223], v[204:207], v[4:7]
v_mfma_f32_16x16x32_bf16 v[8:11], v[220:223], v[208:211], v[8:11]
v_mfma_f32_16x16x32_bf16 v[12:15], v[220:223], v[212:215], v[12:15]
v_mfma_f32_16x16x32_bf16 v[16:19], v[220:223], v[216:219], v[16:19]
ds_read_b64_tr_b16 v[220:221], v238 offset:12288
ds_read_b64_tr_b16 v[222:223], v238 offset:14336
s_add_u32 m0, s47, 0x8000
s_add_u32 s32, s28, 0x25880
buffer_load_dwordx4 v232, s[4:7], s32 offen nt lds
s_waitcnt lgkmcnt(4)
v_mfma_f32_16x16x32_bf16 v[20:23], v[224:227], v[200:203], v[20:23]
v_mfma_f32_16x16x32_bf16 v[24:27], v[224:227], v[204:207], v[24:27]
v_mfma_f32_16x16x32_bf16 v[28:31], v[224:227], v[208:211], v[28:31]
v_mfma_f32_16x16x32_bf16 v[32:35], v[224:227], v[212:215], v[32:35]
v_mfma_f32_16x16x32_bf16 v[36:39], v[224:227], v[216:219], v[36:39]
ds_read_b64_tr_b16 v[224:225], v238 offset:16384
ds_read_b64_tr_b16 v[226:227], v238 offset:18432
s_add_u32 m0, s47, 0xa000
s_add_u32 s32, s28, 0x25900
buffer_load_dwordx4 v232, s[4:7], s32 offen nt lds
s_waitcnt lgkmcnt(4)
v_mfma_f32_16x16x32_bf16 v[40:43], v[228:231], v[200:203], v[40:43]
v_mfma_f32_16x16x32_bf16 v[44:47], v[228:231], v[204:207], v[44:47]
v_mfma_f32_16x16x32_bf16 v[48:51], v[228:231], v[208:211], v[48:51]
v_mfma_f32_16x16x32_bf16 v[52:55], v[228:231], v[212:215], v[52:55]
v_mfma_f32_16x16x32_bf16 v[56:59], v[228:231], v[216:219], v[56:59]
ds_read_b64_tr_b16 v[228:229], v238 offset:20480
ds_read_b64_tr_b16 v[230:231], v238 offset:22528
s_add_u32 m0, s47, 0x7000
s_add_u32 s32, s28, 0x2b800
buffer_load_dwordx4 v232, s[4:7], s32 offen nt lds
s_waitcnt lgkmcnt(4)
v_mfma_f32_16x16x32_bf16 v[60:63], v[220:223], v[200:203], v[60:63]
v_mfma_f32_16x16x32_bf16 v[64:67], v[220:223], v[204:207], v[64:67]
v_mfma_f32_16x16x32_bf16 v[68:71], v[220:223], v[208:211], v[68:71]
v_mfma_f32_16x16x32_bf16 v[72:75], v[220:223], v[212:215], v[72:75]
v_mfma_f32_16x16x32_bf16 v[76:79], v[220:223], v[216:219], v[76:79]
ds_read_b64_tr_b16 v[220:221], v238 offset:24576
ds_read_b64_tr_b16 v[222:223], v238 offset:26624
s_add_u32 m0, s47, 0x9000
s_add_u32 s32, s28, 0x2b880
buffer_load_dwordx4 v232, s[4:7], s32 offen nt lds
s_waitcnt lgkmcnt(4)
v_mfma_f32_16x16x32_bf16 v[80:83], v[224:227], v[200:203], v[80:83]
v_mfma_f32_16x16x32_bf16 v[84:87], v[224:227], v[204:207], v[84:87]
v_mfma_f32_16x16x32_bf16 v[88:91], v[224:227], v[208:211], v[88:91]
v_mfma_f32_16x16x32_bf16 v[92:95], v[224:227], v[212:215], v[92:95]
v_mfma_f32_16x16x32_bf16 v[96:99], v[224:227], v[216:219], v[96:99]
ds_read_b64_tr_b16 v[224:225], v238 offset:28672
ds_read_b64_tr_b16 v[226:227], v238 offset:30720
s_add_u32 m0, s47, 0xb000
s_add_u32 s32, s28, 0x2b900
buffer_load_dwordx4 v232, s[4:7], s32 offen nt lds
s_waitcnt lgkmcnt(4)
v_mfma_f32_16x16x32_bf16 v[100:103], v[228:231], v[200:203], v[100:103]
v_mfma_f32_16x16x32_bf16 v[104:107], v[228:231], v[204:207], v[104:107]
v_mfma_f32_16x16x32_bf16 v[108:111], v[228:231], v[208:211], v[108:111]
v_mfma_f32_16x16x32_bf16 v[112:115], v[228:231], v[212:215], v[112:115]
v_mfma_f32_16x16x32_bf16 v[116:119], v[228:231], v[216:219], v[116:119]
ds_read_b64_tr_b16 v[228:229], v238 offset:32768
ds_read_b64_tr_b16 v[230:231], v238 offset:34816
s_waitcnt lgkmcnt(4)
v_mfma_f32_16x16x32_bf16 v[120:123], v[220:223], v[200:203], v[120:123]
v_mfma_f32_16x16x32_bf16 v[124:127], v[220:223], v[204:207], v[124:127]
v_mfma_f32_16x16x32_bf16 v[128:131], v[220:223], v[208:211], v[128:131]
v_mfma_f32_16x16x32_bf16 v[132:135], v[220:223], v[212:215], v[132:135]
v_mfma_f32_16x16x32_bf16 v[136:139], v[220:223], v[216:219], v[136:139]
ds_read_b64_tr_b16 v[220:221], v238 offset:36864
ds_read_b64_tr_b16 v[222:223], v238 offset:38912
s_waitcnt lgkmcnt(4)
v_mfma_f32_16x16x32_bf16 v[140:143], v[224:227], v[200:203], v[140:143]
v_mfma_f32_16x16x32_bf16 v[144:147], v[224:227], v[204:207], v[144:147]
v_mfma_f32_16x16x32_bf16 v[148:151], v[224:227], v[208:211], v[148:151]
v_mfma_f32_16x16x32_bf16 v[152:155], v[224:227], v[212:215], v[152:155]
v_mfma_f32_16x16x32_bf16 v[156:159], v[224:227], v[216:219], v[156:159]
ds_read_b64_tr_b16 v[224:225], v238 offset:40960
ds_read_b64_tr_b16 v[226:227], v238 offset:43008
s_waitcnt lgkmcnt(4)
v_mfma_f32_16x16x32_bf16 v[160:163], v[228:231], v[200:203], v[160:163]
v_mfma_f32_16x16x32_bf16 v[164:167], v[228:231], v[204:207], v[164:167]
v_mfma_f32_16x16x32_bf16 v[168:171], v[228:231], v[208:211], v[168:171]
v_mfma_f32_16x16x32_bf16 v[172:175], v[228:231], v[212:215], v[172:175]
v_mfma_f32_16x16x32_bf16 v[176:179], v[228:231], v[216:219], v[176:179]
ds_read_b64_tr_b16 v[228:229], v238 offset:45056
ds_read_b64_tr_b16 v[230:231], v238 offset:47104
s_waitcnt vmcnt(12)
s_barrier
s_waitcnt lgkmcnt(4)
v_mfma_f32_16x16x32_bf16 v[180:183], v[220:223], v[200:203], v[180:183]
ds_read_b128 v[200:203], v239 offset:20480
v_mfma_f32_16x16x32_bf16 v[184:187], v[220:223], v[204:207], v[184:187]
ds_read_b128 v[204:207], v239 offset:21504
v_mfma_f32_16x16x32_bf16 v[188:191], v[220:223], v[208:211], v[188:191]
ds_read_b128 v[208:211], v239 offset:22528
v_mfma_f32_16x16x32_bf16 v[192:195], v[220:223], v[212:215], v[192:195]
ds_read_b128 v[212:215], v239 offset:23552
v_mfma_f32_16x16x32_bf16 v[196:199], v[220:223], v[216:219], v[196:199]
ds_read_b128 v[216:219], v239 offset:24576
ds_read_b64_tr_b16 v[220:221], v238 offset:49152
ds_read_b64_tr_b16 v[222:223], v238 offset:51200
s_waitcnt lgkmcnt(6)
v_mfma_f32_16x16x32_bf16 v[0:3], v[224:227], v[200:203], v[0:3]
s_waitcnt lgkmcnt(5)
v_mfma_f32_16x16x32_bf16 v[4:7], v[224:227], v[204:207], v[4:7]
s_waitcnt lgkmcnt(4)
v_mfma_f32_16x16x32_bf16 v[8:11], v[224:227], v[208:211], v[8:11]
s_waitcnt lgkmcnt(3)
v_mfma_f32_16x16x32_bf16 v[12:15], v[224:227], v[212:215], v[12:15]
s_waitcnt lgkmcnt(2)
v_mfma_f32_16x16x32_bf16 v[16:19], v[224:227], v[216:219], v[16:19]
ds_read_b64_tr_b16 v[224:225], v238 offset:53248
ds_read_b64_tr_b16 v[226:227], v238 offset:55296
v_mfma_f32_16x16x32_bf16 v[20:23], v[228:231], v[200:203], v[20:23]
v_mfma_f32_16x16x32_bf16 v[24:27], v[228:231], v[204:207], v[24:27]
v_mfma_f32_16x16x32_bf16 v[28:31], v[228:231], v[208:211], v[28:31]
v_mfma_f32_16x16x32_bf16 v[32:35], v[228:231], v[212:215], v[32:35]
v_mfma_f32_16x16x32_bf16 v[36:39], v[228:231], v[216:219], v[36:39]
ds_read_b64_tr_b16 v[228:229], v238 offset:57344
ds_read_b64_tr_b16 v[230:231], v238 offset:59392
s_waitcnt lgkmcnt(4)
v_mfma_f32_16x16x32_bf16 v[40:43], v[220:223], v[200:203], v[40:43]
v_mfma_f32_16x16x32_bf16 v[44:47], v[220:223], v[204:207], v[44:47]
v_mfma_f32_16x16x32_bf16 v[48:51], v[220:223], v[208:211], v[48:51]
v_mfma_f32_16x16x32_bf16 v[52:55], v[220:223], v[212:215], v[52:55]
v_mfma_f32_16x16x32_bf16 v[56:59], v[220:223], v[216:219], v[56:59]
s_waitcnt lgkmcnt(2)
v_mfma_f32_16x16x32_bf16 v[60:63], v[224:227], v[200:203], v[60:63]
v_mfma_f32_16x16x32_bf16 v[64:67], v[224:227], v[204:207], v[64:67]
v_mfma_f32_16x16x32_bf16 v[68:71], v[224:227], v[208:211], v[68:71]
v_mfma_f32_16x16x32_bf16 v[72:75], v[224:227], v[212:215], v[72:75]
v_mfma_f32_16x16x32_bf16 v[76:79], v[224:227], v[216:219], v[76:79]
s_waitcnt lgkmcnt(0)
v_mfma_f32_16x16x32_bf16 v[80:83], v[228:231], v[200:203], v[80:83]
v_mfma_f32_16x16x32_bf16 v[84:87], v[228:231], v[204:207], v[84:87]
v_mfma_f32_16x16x32_bf16 v[88:91], v[228:231], v[208:211], v[88:91]
v_mfma_f32_16x16x32_bf16 v[92:95], v[228:231], v[212:215], v[92:95]
v_mfma_f32_16x16x32_bf16 v[96:99], v[228:231], v[216:219], v[96:99]
s_add_u32 m0, s47, 0xc000
s_add_u32 s32, s30, 0xfffec280
buffer_load_dwordx4 v236, s[16:19], s32 offen lds
s_add_u32 m0, s47, 0xd000
s_add_u32 s32, s30, 0xfffec300
buffer_load_dwordx4 v236, s[16:19], s32 offen lds
s_add_u32 m0, s47, 0xe000
s_add_u32 s32, s30, 0xfffec380
buffer_load_dwordx4 v236, s[16:19], s32 offen lds
s_waitcnt vmcnt(9)
s_barrier
s_add_u32 m0, s47, 0xf000
s_add_u32 s32, s30, 0xfffec400
buffer_load_dwordx4 v236, s[16:19], s32 offen lds
s_add_u32 m0, s47, 0x10000
s_add_u32 s32, s30, 0xfffec480
buffer_load_dwordx4 v236, s[16:19], s32 offen lds
s_add_u32 m0, s47, 0x11000
s_add_u32 s32, s30, 0xffff6000
buffer_load_dwordx4 v236, s[16:19], s32 offen lds
s_add_u32 m0, s47, 0x12000
s_add_u32 s32, s30, 0xffff6080
buffer_load_dwordx4 v236, s[16:19], s32 offen lds
s_add_u32 m0, s47, 0x13000
s_add_u32 s32, s30, 0xffff6100
buffer_load_dwordx4 v236, s[16:19], s32 offen lds
s_add_u32 m0, s47, 0x14000
s_add_u32 s32, s30, 0xffff6180
buffer_load_dwordx4 v236, s[16:19], s32 offen lds
s_add_u32 m0, s47, 0x15000
s_add_u32 s32, s30, 0xffff6200
buffer_load_dwordx4 v236, s[16:19], s32 offen lds
s_add_u32 m0, s47, 0x16000
s_add_u32 s32, s30, 0xffff6280
buffer_load_dwordx4 v236, s[16:19], s32 offen lds
s_add_u32 m0, s47, 0x17000
s_add_u32 s32, s30, 0xffff6300
buffer_load_dwordx4 v236, s[16:19], s32 offen lds
s_add_u32 m0, s47, 0x18000
s_add_u32 s32, s30, 0xffff6380
buffer_load_dwordx4 v236, s[16:19], s32 offen lds
s_add_u32 m0, s47, 0x19000
s_add_u32 s32, s30, 0xffff6400
buffer_load_dwordx4 v236, s[16:19], s32 offen lds
s_add_u32 m0, s47, 0x1a000
s_add_u32 s32, s30, 0xffff6480
buffer_load_dwordx4 v236, s[16:19], s32 offen lds
s_waitcnt vmcnt(15)
s_barrier
s_add_u32 m0, s47, 0x0
s_add_u32 s32, s28, 0x0
buffer_load_dwordx4 v233, s[8:11], s32 offen nt lds
s_add_u32 m0, s47, 0x1000
s_add_u32 s32, s28, 0x80
buffer_load_dwordx4 v233, s[8:11], s32 offen nt lds
s_add_u32 m0, s47, 0x2000
s_add_u32 s32, s28, 0x100
buffer_load_dwordx4 v233, s[8:11], s32 offen nt lds
s_add_u32 m0, s47, 0x3000
s_add_u32 s32, s28, 0x3000
buffer_load_dwordx4 v233, s[8:11], s32 offen nt lds
s_add_u32 m0, s47, 0x4000
s_add_u32 s32, s28, 0x3080
buffer_load_dwordx4 v233, s[8:11], s32 offen nt lds
s_add_u32 m0, s47, 0x5000
s_add_u32 s32, s28, 0x3100
buffer_load_dwordx4 v233, s[8:11], s32 offen nt lds
s_waitcnt vmcnt(18)
s_barrier
ds_read_b64_tr_b16 v[220:221], v238 offset:0
ds_read_b64_tr_b16 v[222:223], v238 offset:2048
ds_read_b64_tr_b16 v[224:225], v238 offset:4096
ds_read_b64_tr_b16 v[226:227], v238 offset:6144
ds_read_b64_tr_b16 v[228:229], v238 offset:8192
ds_read_b64_tr_b16 v[230:231], v238 offset:10240
s_add_u32 m0, s47, 0x6000
s_add_u32 s32, s28, 0x6000
buffer_load_dwordx4 v233, s[8:11], s32 offen nt lds
s_waitcnt lgkmcnt(4)
v_mfma_f32_16x16x32_bf16 v[100:103], v[220:223], v[200:203], v[100:103]
v_mfma_f32_16x16x32_bf16 v[104:107], v[220:223], v[204:207], v[104:107]
s_add_u32 m0, s47, 0x7000
s_add_u32 s32, s28, 0x6080
buffer_load_dwordx4 v233, s[8:11], s32 offen nt lds
v_mfma_f32_16x16x32_bf16 v[108:111], v[220:223], v[208:211], v[108:111]
v_mfma_f32_16x16x32_bf16 v[112:115], v[220:223], v[212:215], v[112:115]
v_mfma_f32_16x16x32_bf16 v[116:119], v[220:223], v[216:219], v[116:119]
s_add_u32 m0, s47, 0x8000
s_add_u32 s32, s28, 0x6100
buffer_load_dwordx4 v233, s[8:11], s32 offen nt lds
s_waitcnt lgkmcnt(2)
v_mfma_f32_16x16x32_bf16 v[120:123], v[224:227], v[200:203], v[120:123]
v_mfma_f32_16x16x32_bf16 v[124:127], v[224:227], v[204:207], v[124:127]
s_add_u32 m0, s47, 0x9000
s_add_u32 s32, s28, 0x9000
buffer_load_dwordx4 v233, s[8:11], s32 offen nt lds
v_mfma_f32_16x16x32_bf16 v[128:131], v[224:227], v[208:211], v[128:131]
v_mfma_f32_16x16x32_bf16 v[132:135], v[224:227], v[212:215], v[132:135]
v_mfma_f32_16x16x32_bf16 v[136:139], v[224:227], v[216:219], v[136:139]
s_add_u32 m0, s47, 0xa000
s_add_u32 s32, s28, 0x9080
buffer_load_dwordx4 v233, s[8:11], s32 offen nt lds
s_waitcnt lgkmcnt(0)
v_mfma_f32_16x16x32_bf16 v[140:143], v[228:231], v[200:203], v[140:143]
v_mfma_f32_16x16x32_bf16 v[144:147], v[228:231], v[204:207], v[144:147]
s_add_u32 m0, s47, 0xb000
s_add_u32 s32, s28, 0x9100
buffer_load_dwordx4 v233, s[8:11], s32 offen nt lds
v_mfma_f32_16x16x32_bf16 v[148:151], v[228:231], v[208:211], v[148:151]
v_mfma_f32_16x16x32_bf16 v[152:155], v[228:231], v[212:215], v[152:155]
v_mfma_f32_16x16x32_bf16 v[156:159], v[228:231], v[216:219], v[156:159]
s_waitcnt vmcnt(15)
s_barrier
ds_read_b64_tr_b16 v[220:221], v238 offset:12288
ds_read_b64_tr_b16 v[222:223], v238 offset:14336
ds_read_b64_tr_b16 v[224:225], v238 offset:16384
ds_read_b64_tr_b16 v[226:227], v238 offset:18432
ds_read_b64_tr_b16 v[228:229], v238 offset:20480
ds_read_b64_tr_b16 v[230:231], v238 offset:22528
s_waitcnt lgkmcnt(4)
v_mfma_f32_16x16x32_bf16 v[160:163], v[220:223], v[200:203], v[160:163]
v_mfma_f32_16x16x32_bf16 v[164:167], v[220:223], v[204:207], v[164:167]
v_mfma_f32_16x16x32_bf16 v[168:171], v[220:223], v[208:211], v[168:171]
v_mfma_f32_16x16x32_bf16 v[172:175], v[220:223], v[212:215], v[172:175]
v_mfma_f32_16x16x32_bf16 v[176:179], v[220:223], v[216:219], v[176:179]
ds_read_b64_tr_b16 v[220:221], v238 offset:24576
ds_read_b64_tr_b16 v[222:223], v238 offset:26624
s_waitcnt lgkmcnt(4)
v_mfma_f32_16x16x32_bf16 v[180:183], v[224:227], v[200:203], v[180:183]
ds_read_b128 v[200:203], v239 offset:25600
v_mfma_f32_16x16x32_bf16 v[184:187], v[224:227], v[204:207], v[184:187]
ds_read_b128 v[204:207], v239 offset:26624
v_mfma_f32_16x16x32_bf16 v[188:191], v[224:227], v[208:211], v[188:191]
ds_read_b128 v[208:211], v239 offset:27648
v_mfma_f32_16x16x32_bf16 v[192:195], v[224:227], v[212:215], v[192:195]
ds_read_b128 v[212:215], v239 offset:28672
v_mfma_f32_16x16x32_bf16 v[196:199], v[224:227], v[216:219], v[196:199]
ds_read_b128 v[216:219], v239 offset:29696
ds_read_b64_tr_b16 v[224:225], v238 offset:28672
ds_read_b64_tr_b16 v[226:227], v238 offset:30720
s_waitcnt lgkmcnt(6)
v_mfma_f32_16x16x32_bf16 v[0:3], v[228:231], v[200:203], v[0:3]
s_waitcnt lgkmcnt(5)
v_mfma_f32_16x16x32_bf16 v[4:7], v[228:231], v[204:207], v[4:7]
s_waitcnt lgkmcnt(4)
v_mfma_f32_16x16x32_bf16 v[8:11], v[228:231], v[208:211], v[8:11]
s_waitcnt lgkmcnt(3)
v_mfma_f32_16x16x32_bf16 v[12:15], v[228:231], v[212:215], v[12:15]
s_waitcnt lgkmcnt(2)
v_mfma_f32_16x16x32_bf16 v[16:19], v[228:231], v[216:219], v[16:19]
ds_read_b64_tr_b16 v[228:229], v238 offset:32768
ds_read_b64_tr_b16 v[230:231], v238 offset:34816
v_mfma_f32_16x16x32_bf16 v[20:23], v[220:223], v[200:203], v[20:23]
v_mfma_f32_16x16x32_bf16 v[24:27], v[220:223], v[204:207], v[24:27]
v_mfma_f32_16x16x32_bf16 v[28:31], v[220:223], v[208:211], v[28:31]
v_mfma_f32_16x16x32_bf16 v[32:35], v[220:223], v[212:215], v[32:35]
v_mfma_f32_16x16x32_bf16 v[36:39], v[220:223], v[216:219], v[36:39]
ds_read_b64_tr_b16 v[220:221], v238 offset:36864
ds_read_b64_tr_b16 v[222:223], v238 offset:38912
s_waitcnt lgkmcnt(4)
v_mfma_f32_16x16x32_bf16 v[40:43], v[224:227], v[200:203], v[40:43]
v_mfma_f32_16x16x32_bf16 v[44:47], v[224:227], v[204:207], v[44:47]
v_mfma_f32_16x16x32_bf16 v[48:51], v[224:227], v[208:211], v[48:51]
v_mfma_f32_16x16x32_bf16 v[52:55], v[224:227], v[212:215], v[52:55]
v_mfma_f32_16x16x32_bf16 v[56:59], v[224:227], v[216:219], v[56:59]
ds_read_b64_tr_b16 v[224:225], v238 offset:40960
ds_read_b64_tr_b16 v[226:227], v238 offset:43008
s_waitcnt lgkmcnt(4)
v_mfma_f32_16x16x32_bf16 v[60:63], v[228:231], v[200:203], v[60:63]
v_mfma_f32_16x16x32_bf16 v[64:67], v[228:231], v[204:207], v[64:67]
v_mfma_f32_16x16x32_bf16 v[68:71], v[228:231], v[208:211], v[68:71]
v_mfma_f32_16x16x32_bf16 v[72:75], v[228:231], v[212:215], v[72:75]
v_mfma_f32_16x16x32_bf16 v[76:79], v[228:231], v[216:219], v[76:79]
ds_read_b64_tr_b16 v[228:229], v238 offset:45056
ds_read_b64_tr_b16 v[230:231], v238 offset:47104
s_waitcnt vmcnt(12)
s_barrier
s_waitcnt lgkmcnt(4)
v_mfma_f32_16x16x32_bf16 v[80:83], v[220:223], v[200:203], v[80:83]
v_mfma_f32_16x16x32_bf16 v[84:87], v[220:223], v[204:207], v[84:87]
v_mfma_f32_16x16x32_bf16 v[88:91], v[220:223], v[208:211], v[88:91]
v_mfma_f32_16x16x32_bf16 v[92:95], v[220:223], v[212:215], v[92:95]
v_mfma_f32_16x16x32_bf16 v[96:99], v[220:223], v[216:219], v[96:99]
ds_read_b64_tr_b16 v[220:221], v238 offset:49152
ds_read_b64_tr_b16 v[222:223], v238 offset:51200
s_waitcnt lgkmcnt(4)
v_mfma_f32_16x16x32_bf16 v[100:103], v[224:227], v[200:203], v[100:103]
v_mfma_f32_16x16x32_bf16 v[104:107], v[224:227], v[204:207], v[104:107]
v_mfma_f32_16x16x32_bf16 v[108:111], v[224:227], v[208:211], v[108:111]
v_mfma_f32_16x16x32_bf16 v[112:115], v[224:227], v[212:215], v[112:115]
v_mfma_f32_16x16x32_bf16 v[116:119], v[224:227], v[216:219], v[116:119]
ds_read_b64_tr_b16 v[224:225], v238 offset:53248
ds_read_b64_tr_b16 v[226:227], v238 offset:55296
s_waitcnt lgkmcnt(4)
v_mfma_f32_16x16x32_bf16 v[120:123], v[228:231], v[200:203], v[120:123]
v_mfma_f32_16x16x32_bf16 v[124:127], v[228:231], v[204:207], v[124:127]
v_mfma_f32_16x16x32_bf16 v[128:131], v[228:231], v[208:211], v[128:131]
v_mfma_f32_16x16x32_bf16 v[132:135], v[228:231], v[212:215], v[132:135]
v_mfma_f32_16x16x32_bf16 v[136:139], v[228:231], v[216:219], v[136:139]
ds_read_b64_tr_b16 v[228:229], v238 offset:57344
ds_read_b64_tr_b16 v[230:231], v238 offset:59392
s_waitcnt lgkmcnt(4)
v_mfma_f32_16x16x32_bf16 v[140:143], v[220:223], v[200:203], v[140:143]
v_mfma_f32_16x16x32_bf16 v[144:147], v[220:223], v[204:207], v[144:147]
v_mfma_f32_16x16x32_bf16 v[148:151], v[220:223], v[208:211], v[148:151]
v_mfma_f32_16x16x32_bf16 v[152:155], v[220:223], v[212:215], v[152:155]
v_mfma_f32_16x16x32_bf16 v[156:159], v[220:223], v[216:219], v[156:159]
s_waitcnt lgkmcnt(2)
v_mfma_f32_16x16x32_bf16 v[160:163], v[224:227], v[200:203], v[160:163]
v_mfma_f32_16x16x32_bf16 v[164:167], v[224:227], v[204:207], v[164:167]
v_mfma_f32_16x16x32_bf16 v[168:171], v[224:227], v[208:211], v[168:171]
v_mfma_f32_16x16x32_bf16 v[172:175], v[224:227], v[212:215], v[172:175]
v_mfma_f32_16x16x32_bf16 v[176:179], v[224:227], v[216:219], v[176:179]
s_waitcnt lgkmcnt(0)
v_mfma_f32_16x16x32_bf16 v[180:183], v[228:231], v[200:203], v[180:183]
v_mfma_f32_16x16x32_bf16 v[184:187], v[228:231], v[204:207], v[184:187]
v_mfma_f32_16x16x32_bf16 v[188:191], v[228:231], v[208:211], v[188:191]
v_mfma_f32_16x16x32_bf16 v[192:195], v[228:231], v[212:215], v[192:195]
v_mfma_f32_16x16x32_bf16 v[196:199], v[228:231], v[216:219], v[196:199]
s_add_u32 m0, s47, 0xc000
s_add_u32 s32, s29, 0x180
buffer_load_dwordx4 v234, s[12:15], s32 offen lds
s_add_u32 m0, s47, 0xd000
s_add_u32 s32, s29, 0x200
buffer_load_dwordx4 v234, s[12:15], s32 offen lds
s_add_u32 m0, s47, 0xe000
s_add_u32 s32, s29, 0x280
buffer_load_dwordx4 v234, s[12:15], s32 offen lds
s_add_u32 m0, s47, 0x1b000
s_add_u32 s32, s31, 0x0
buffer_load_dwordx4 v235, s[20:23], s32 offen lds
s_add_u32 m0, s47, 0x1c000
s_add_u32 s32, s31, 0xa000
buffer_load_dwordx4 v235, s[20:23], s32 offen lds
s_mov_b32 exec_hi, 0
s_add_u32 m0, s46, 0x1d000
s_add_u32 s32, s31, 0x0
buffer_load_dwordx4 v237, s[20:23], s32 offen lds
s_mov_b32 exec_hi, -1
s_add_u32 s28, s28, 196608
s_add_u32 s29, s29, 384
s_add_u32 s30, s30, 245760
s_add_u32 s38, s38, 245760
s_sub_u32 s33, s33, 1
s_cmp_lg_u32 s33, 0
s_cbranch_scc1 L_ld_loop
s_waitcnt vmcnt(12)
s_barrier
s_add_u32 m0, s47, 0xc000
s_add_u32 s32, s28, 0xfffdc000
buffer_load_dwordx4 v233, s[8:11], s32 offen nt lds
s_add_u32 m0, s47, 0xd000
s_add_u32 s32, s28, 0xfffdc080
buffer_load_dwordx4 v233, s[8:11], s32 offen nt lds
s_add_u32 m0, s47, 0xe000
s_add_u32 s32, s28, 0xfffdc100
buffer_load_dwordx4 v233, s[8:11], s32 offen nt lds
s_add_u32 m0, s47, 0xf000
s_add_u32 s32, s28, 0xfffdf000
buffer_load_dwordx4 v233, s[8:11], s32 offen nt lds
s_add_u32 m0, s47, 0x10000
s_add_u32 s32, s28, 0xfffdf080
buffer_load_dwordx4 v233, s[8:11], s32 offen nt lds
s_add_u32 m0, s47, 0x11000
s_add_u32 s32, s28, 0xfffdf100
buffer_load_dwordx4 v233, s[8:11], s32 offen nt lds
s_waitcnt vmcnt(12)
s_barrier
s_add_u32 m0, s47, 0x12000
s_add_u32 s32, s28, 0xfffe2000
buffer_load_dwordx4 v233, s[8:11], s32 offen nt lds
s_add_u32 m0, s47, 0x13000
s_add_u32 s32, s28, 0xfffe2080
buffer_load_dwordx4 v233, s[8:11], s32 offen nt lds
s_add_u32 m0, s47, 0x14000
s_add_u32 s32, s28, 0xfffe2100
buffer_load_dwordx4 v233, s[8:11], s32 offen nt lds
s_add_u32 m0, s47, 0x15000
s_add_u32 s32, s28, 0xfffe5000
buffer_load_dwordx4 v233, s[8:11], s32 offen nt lds
s_add_u32 m0, s47, 0x16000
s_add_u32 s32, s28, 0xfffe5080
buffer_load_dwordx4 v233, s[8:11], s32 offen nt lds
s_add_u32 m0, s47, 0x17000
s_add_u32 s32, s28, 0xfffe5100
buffer_load_dwordx4 v233, s[8:11], s32 offen nt lds
s_add_u32 s32, s38, 0xfffc4000
buffer_load_dword v244, v241, s[16:19], s32 offen
s_waitcnt vmcnt(13)
s_barrier
s_add_u32 m0, s47, 0x18000
s_add_u32 s32, s28, 0xfffe8000
buffer_load_dwordx4 v233, s[8:11], s32 offen nt lds
s_add_u32 m0, s47, 0x19000
s_add_u32 s32, s28, 0xfffe8080
buffer_load_dwordx4 v233, s[8:11], s32 offen nt lds
s_add_u32 m0, s47, 0x1a000
s_add_u32 s32, s28, 0xfffe8100
buffer_load_dwordx4 v233, s[8:11], s32 offen nt lds
s_add_u32 m0, s47, 0x0
s_add_u32 s32, s28, 0xfffeb000
buffer_load_dwordx4 v233, s[8:11], s32 offen nt lds
s_add_u32 m0, s47, 0x1000
s_add_u32 s32, s28, 0xfffeb080
buffer_load_dwordx4 v233, s[8:11], s32 offen nt lds
s_add_u32 m0, s47, 0x2000
s_add_u32 s32, s28, 0xfffeb100
buffer_load_dwordx4 v233, s[8:11], s32 offen nt lds
s_waitcnt vmcnt(13)
s_barrier
s_add_u32 m0, s47, 0x3000
s_add_u32 s32, s28, 0xfffee000
buffer_load_dwordx4 v233, s[8:11], s32 offen nt lds
s_add_u32 m0, s47, 0x4000
s_add_u32 s32, s28, 0xfffee080
buffer_load_dwordx4 v233, s[8:11], s32 offen nt lds
s_add_u32 m0, s47, 0x5000
s_add_u32 s32, s28, 0xfffee100
buffer_load_dwordx4 v233, s[8:11], s32 offen nt lds
s_add_u32 m0, s47, 0x6000
s_add_u32 s32, s28, 0xffff1000
buffer_load_dwordx4 v233, s[8:11], s32 offen nt lds
s_add_u32 m0, s47, 0x7000
s_add_u32 s32, s28, 0xffff1080
buffer_load_dwordx4 v233, s[8:11], s32 offen nt lds
s_add_u32 m0, s47, 0x8000
s_add_u32 s32, s28, 0xffff1100
buffer_load_dwordx4 v233, s[8:11], s32 offen nt lds
s_waitcnt vmcnt(13)
s_barrier
s_add_u32 m0, s47, 0x9000
s_add_u32 s32, s28, 0xffff4000
buffer_load_dwordx4 v233, s[8:11], s32 offen nt lds
s_add_u32 m0, s47, 0xa000
s_add_u32 s32, s28, 0xffff4080
buffer_load_dwordx4 v233, s[8:11], s32 offen nt lds
s_add_u32 m0, s47, 0xb000
s_add_u32 s32, s28, 0xffff4100
buffer_load_dwordx4 v233, s[8:11], s32 offen nt lds
s_add_u32 m0, s47, 0xc000
s_add_u32 s32, s28, 0xffff7000
buffer_load_dwordx4 v233, s[8:11], s32 offen nt lds
s_add_u32 m0, s47, 0xd000
s_add_u32 s32, s28, 0xffff7080
buffer_load_dwordx4 v233, s[8:11], s32 offen nt lds
s_add_u32 m0, s47, 0xe000
s_add_u32 s32, s28, 0xffff7100
buffer_load_dwordx4 v233, s[8:11], s32 offen nt lds
s_barrier
s_add_u32 m0, s47, 0xf000
s_add_u32 s32, s28, 0xffffa000
buffer_load_dwordx4 v233, s[8:11], s32 offen nt lds
s_add_u32 m0, s47, 0x10000
s_add_u32 s32, s28, 0xffffa080
buffer_load_dwordx4 v233, s[8:11], s32 offen nt lds
s_add_u32 m0, s47, 0x11000
s_add_u32 s32, s28, 0xffffa100
buffer_load_dwordx4 v233, s[8:11], s32 offen nt lds
s_add_u32 m0, s47, 0x12000
s_add_u32 s32, s28, 0xffffd000
buffer_load_dwordx4 v233, s[8:11], s32 offen nt lds
s_add_u32 m0, s47, 0x13000
s_add_u32 s32, s28, 0xffffd080
buffer_load_dwordx4 v233, s[8:11], s32 offen nt lds
s_add_u32 m0, s47, 0x14000
s_add_u32 s32, s28, 0xffffd100
buffer_load_dwordx4 v233, s[8:11], s32 offen nt lds
s_add_u32 m0, s47, 0x15000
s_add_u32 s32, s30, 0xfffc4000
buffer_load_dwordx4 v236, s[16:19], s32 offen lds
s_add_u32 m0, s47, 0x16000
s_add_u32 s32, s30, 0xfffc4080
buffer_load_dwordx4 v236, s[16:19], s32 offen lds
s_add_u32 m0, s47, 0x17000
s_add_u32 s32, s30, 0xfffce000
buffer_load_dwordx4 v236, s[16:19], s32 offen lds
s_waitcnt vmcnt(21)
s_barrier
s_waitcnt vmcnt(15)
s_barrier
s_add_u32 m0, s47, 0x18000
s_add_u32 s32, s30, 0xfffce080
buffer_load_dwordx4 v236, s[16:19], s32 offen lds
s_add_u32 m0, s47, 0x19000
s_add_u32 s32, s30, 0xfffd8000
buffer_load_dwordx4 v236, s[16:19], s32 offen lds
s_add_u32 m0, s47, 0x1a000
s_add_u32 s32, s30, 0xfffd8080
buffer_load_dwordx4 v236, s[16:19], s32 offen lds
s_add_u32 m0, s47, 0x0
s_add_u32 s32, s30, 0xfffe2000
buffer_load_dwordx4 v236, s[16:19], s32 offen lds
s_add_u32 m0, s47, 0x1000
s_add_u32 s32, s30, 0xfffe2080
buffer_load_dwordx4 v236, s[16:19], s32 offen lds
s_add_u32 m0, s47, 0x2000
s_add_u32 s32, s30, 0xfffec000
buffer_load_dwordx4 v236, s[16:19], s32 offen lds
s_barrier
s_add_u32 m0, s47, 0x3000
s_add_u32 s32, s30, 0xfffec080
buffer_load_dwordx4 v236, s[16:19], s32 offen lds
s_add_u32 m0, s47, 0x4000
s_add_u32 s32, s30, 0xffff6000
buffer_load_dwordx4 v236, s[16:19], s32 offen lds
s_add_u32 m0, s47, 0x5000
s_add_u32 s32, s30, 0xffff6080
buffer_load_dwordx4 v236, s[16:19], s32 offen lds
s_add_u32 m0, s47, 0x6000
s_add_u32 s32, s30, 0xfffc4100
buffer_load_dwordx4 v236, s[16:19], s32 offen lds
s_add_u32 m0, s47, 0x7000
s_add_u32 s32, s30, 0xfffc4180
buffer_load_dwordx4 v236, s[16:19], s32 offen lds
s_add_u32 m0, s47, 0x8000
s_add_u32 s32, s30, 0xfffce100
buffer_load_dwordx4 v236, s[16:19], s32 offen lds
s_waitcnt vmcnt(21)
s_barrier
s_waitcnt vmcnt(15)
s_barrier
s_add_u32 m0, s47, 0x9000
s_add_u32 s32, s30, 0xfffce180
buffer_load_dwordx4 v236, s[16:19], s32 offen lds
s_add_u32 m0, s47, 0xa000
s_add_u32 s32, s30, 0xfffd8100
buffer_load_dwordx4 v236, s[16:19], s32 offen lds
s_add_u32 m0, s47, 0xb000
s_add_u32 s32, s30, 0xfffd8180
buffer_load_dwordx4 v236, s[16:19], s32 offen lds
s_add_u32 m0, s47, 0xc000
s_add_u32 s32, s30, 0xfffe2100
buffer_load_dwordx4 v236, s[16:19], s32 offen lds
s_add_u32 m0, s47, 0xd000
s_add_u32 s32, s30, 0xfffe2180
buffer_load_dwordx4 v236, s[16:19], s32 offen lds
s_add_u32 m0, s47, 0xe000
s_add_u32 s32, s30, 0xfffec100
buffer_load_dwordx4 v236, s[16:19], s32 offen lds
s_barrier
s_add_u32 m0, s47, 0xf000
s_add_u32 s32, s30, 0xfffec180
buffer_load_dwordx4 v236, s[16:19], s32 offen lds
s_add_u32 m0, s47, 0x10000
s_add_u32 s32, s30, 0xffff6100
buffer_load_dwordx4 v236, s[16:19], s32 offen lds
s_add_u32 m0, s47, 0x11000
s_add_u32 s32, s30, 0xffff6180
buffer_load_dwordx4 v236, s[16:19], s32 offen lds
s_add_u32 m0, s47, 0x12000
s_add_u32 s32, s30, 0xfffc4200
buffer_load_dwordx4 v236, s[16:19], s32 offen lds
s_add_u32 m0, s47, 0x13000
s_add_u32 s32, s30, 0xfffc4280
buffer_load_dwordx4 v236, s[16:19], s32 offen lds
s_add_u32 m0, s47, 0x14000
s_add_u32 s32, s30, 0xfffce200
buffer_load_dwordx4 v236, s[16:19], s32 offen lds
s_waitcnt vmcnt(18)
s_barrier
v_subrev_u32 v243, 49152, v238
ds_read_b64_tr_b16 v[220:221], v238 offset:36864
ds_read_b64_tr_b16 v[222:223], v238 offset:38912
ds_read_b128 v[200:203], v239 offset:0
ds_read_b128 v[204:207], v239 offset:1024
ds_read_b128 v[208:211], v239 offset:2048
ds_read_b128 v[212:215], v239 offset:3072
ds_read_b128 v[216:219], v239 offset:4096
ds_read_b64_tr_b16 v[224:225], v238 offset:40960
ds_read_b64_tr_b16 v[226:227], v238 offset:43008
ds_read_b64_tr_b16 v[228:229], v238 offset:45056
ds_read_b64_tr_b16 v[230:231], v238 offset:47104
ds_read_b64_tr_b16 v[232:233], v238 offset:49152
ds_read_b64_tr_b16 v[234:235], v238 offset:51200
s_waitcnt lgkmcnt(10)
v_mfma_f32_16x16x32_bf16 v[0:3], v[220:223], v[200:203], v[0:3]
s_waitcnt lgkmcnt(4)
v_mfma_f32_16x16x32_bf16 v[20:23], v[224:227], v[200:203], v[20:23]
ds_read_b128 v[200:203], v239 offset:5120
v_mfma_f32_16x16x32_bf16 v[4:7], v[220:223], v[204:207], v[4:7]
v_mfma_f32_16x16x32_bf16 v[24:27], v[224:227], v[204:207], v[24:27]
ds_read_b128 v[204:207], v239 offset:6144
v_mfma_f32_16x16x32_bf16 v[8:11], v[220:223], v[208:211], v[8:11]
v_mfma_f32_16x16x32_bf16 v[28:31], v[224:227], v[208:211], v[28:31]
ds_read_b128 v[208:211], v239 offset:7168
v_mfma_f32_16x16x32_bf16 v[12:15], v[220:223], v[212:215], v[12:15]
v_mfma_f32_16x16x32_bf16 v[32:35], v[224:227], v[212:215], v[32:35]
ds_read_b128 v[212:215], v239 offset:8192
v_mfma_f32_16x16x32_bf16 v[16:19], v[220:223], v[216:219], v[16:19]
v_mfma_f32_16x16x32_bf16 v[36:39], v[224:227], v[216:219], v[36:39]
ds_read_b128 v[216:219], v239 offset:9216
ds_read_b64_tr_b16 v[220:221], v238 offset:53248
ds_read_b64_tr_b16 v[222:223], v238 offset:55296
ds_read_b64_tr_b16 v[224:225], v238 offset:57344
ds_read_b64_tr_b16 v[226:227], v238 offset:59392
s_waitcnt lgkmcnt(8)
v_mfma_f32_16x16x32_bf16 v[0:3], v[228:231], v[200:203], v[0:3]
v_mfma_f32_16x16x32_bf16 v[20:23], v[232:235], v[200:203], v[20:23]
ds_read_b128 v[200:203], v239 offset:10240
s_waitcnt lgkmcnt(8)
v_mfma_f32_16x16x32_bf16 v[4:7], v[228:231], v[204:207], v[4:7]
v_mfma_f32_16x16x32_bf16 v[24:27], v[232:235], v[204:207], v[24:27]
ds_read_b128 v[204:207], v239 offset:11264
s_waitcnt lgkmcnt(8)
v_mfma_f32_16x16x32_bf16 v[8:11], v[228:231], v[208:211], v[8:11]
v_mfma_f32_16x16x32_bf16 v[28:31], v[232:235], v[208:211], v[28:31]
ds_read_b128 v[208:211], v239 offset:12288
s_waitcnt lgkmcnt(8)
v_mfma_f32_16x16x32_bf16 v[12:15], v[228:231], v[212:215], v[12:15]
v_mfma_f32_16x16x32_bf16 v[32:35], v[232:235], v[212:215], v[32:35]
ds_read_b128 v[212:215], v239 offset:13312
s_waitcnt lgkmcnt(8)
v_mfma_f32_16x16x32_bf16 v[16:19], v[228:231], v[216:219], v[16:19]
v_mfma_f32_16x16x32_bf16 v[36:39], v[232:235], v[216:219], v[36:39]
ds_read_b128 v[216:219], v239 offset:14336
ds_read_b64_tr_b16 v[228:229], v243 offset:0
ds_read_b64_tr_b16 v[230:231], v243 offset:2048
ds_read_b64_tr_b16 v[232:233], v243 offset:4096
ds_read_b64_tr_b16 v[234:235], v243 offset:6144
s_waitcnt lgkmcnt(8)
v_mfma_f32_16x16x32_bf16 v[0:3], v[220:223], v[200:203], v[0:3]
v_mfma_f32_16x16x32_bf16 v[20:23], v[224:227], v[200:203], v[20:23]
ds_read_b128 v[200:203], v239 offset:15360
s_waitcnt lgkmcnt(8)
v_mfma_f32_16x16x32_bf16 v[4:7], v[220:223], v[204:207], v[4:7]
v_mfma_f32_16x16x32_bf16 v[24:27], v[224:227], v[204:207], v[24:27]
ds_read_b128 v[204:207], v239 offset:16384
s_waitcnt lgkmcnt(8)
v_mfma_f32_16x16x32_bf16 v[8:11], v[220:223], v[208:211], v[8:11]
v_mfma_f32_16x16x32_bf16 v[28:31], v[224:227], v[208:211], v[28:31]
ds_read_b128 v[208:211], v239 offset:17408
s_waitcnt lgkmcnt(8)
v_mfma_f32_16x16x32_bf16 v[12:15], v[220:223], v[212:215], v[12:15]
v_mfma_f32_16x16x32_bf16 v[32:35], v[224:227], v[212:215], v[32:35]
ds_read_b128 v[212:215], v239 offset:18432
s_waitcnt lgkmcnt(8)
v_mfma_f32_16x16x32_bf16 v[16:19], v[220:223], v[216:219], v[16:19]
v_mfma_f32_16x16x32_bf16 v[36:39], v[224:227], v[216:219], v[36:39]
ds_read_b128 v[216:219], v239 offset:19456
s_waitcnt vmcnt(12)
s_barrier
ds_read_b64_tr_b16 v[220:221], v243 offset:8192
ds_read_b64_tr_b16 v[222:223], v243 offset:10240
ds_read_b64_tr_b16 v[224:225], v243 offset:12288
ds_read_b64_tr_b16 v[226:227], v243 offset:14336
s_waitcnt lgkmcnt(8)
v_mfma_f32_16x16x32_bf16 v[0:3], v[228:231], v[200:203], v[0:3]
v_mfma_f32_16x16x32_bf16 v[20:23], v[232:235], v[200:203], v[20:23]
ds_read_b128 v[200:203], v239 offset:20480
s_waitcnt lgkmcnt(8)
v_mfma_f32_16x16x32_bf16 v[4:7], v[228:231], v[204:207], v[4:7]
v_mfma_f32_16x16x32_bf16 v[24:27], v[232:235], v[204:207], v[24:27]
ds_read_b128 v[204:207], v239 offset:21504
s_waitcnt lgkmcnt(8)
v_mfma_f32_16x16x32_bf16 v[8:11], v[228:231], v[208:211], v[8:11]
v_mfma_f32_16x16x32_bf16 v[28:31], v[232:235], v[208:211], v[28:31]
ds_read_b128 v[208:211], v239 offset:22528
s_waitcnt lgkmcnt(8)
v_mfma_f32_16x16x32_bf16 v[12:15], v[228:231], v[212:215], v[12:15]
v_mfma_f32_16x16x32_bf16 v[32:35], v[232:235], v[212:215], v[32:35]
ds_read_b128 v[212:215], v239 offset:23552
s_waitcnt lgkmcnt(8)
v_mfma_f32_16x16x32_bf16 v[16:19], v[228:231], v[216:219], v[16:19]
v_mfma_f32_16x16x32_bf16 v[36:39], v[232:235], v[216:219], v[36:39]
ds_read_b128 v[216:219], v239 offset:24576
ds_read_b64_tr_b16 v[228:229], v243 offset:16384
ds_read_b64_tr_b16 v[230:231], v243 offset:18432
ds_read_b64_tr_b16 v[232:233], v243 offset:20480
ds_read_b64_tr_b16 v[234:235], v243 offset:22528
s_waitcnt lgkmcnt(8)
v_mfma_f32_16x16x32_bf16 v[0:3], v[220:223], v[200:203], v[0:3]
v_mfma_f32_16x16x32_bf16 v[20:23], v[224:227], v[200:203], v[20:23]
ds_read_b128 v[200:203], v239 offset:25600
s_waitcnt lgkmcnt(8)
v_mfma_f32_16x16x32_bf16 v[4:7], v[220:223], v[204:207], v[4:7]
v_mfma_f32_16x16x32_bf16 v[24:27], v[224:227], v[204:207], v[24:27]
ds_read_b128 v[204:207], v239 offset:26624
s_waitcnt lgkmcnt(8)
v_mfma_f32_16x16x32_bf16 v[8:11], v[220:223], v[208:211], v[8:11]
v_mfma_f32_16x16x32_bf16 v[28:31], v[224:227], v[208:211], v[28:31]
ds_read_b128 v[208:211], v239 offset:27648
s_waitcnt lgkmcnt(8)
v_mfma_f32_16x16x32_bf16 v[12:15], v[220:223], v[212:215], v[12:15]
v_mfma_f32_16x16x32_bf16 v[32:35], v[224:227], v[212:215], v[32:35]
ds_read_b128 v[212:215], v239 offset:28672
s_waitcnt lgkmcnt(8)
v_mfma_f32_16x16x32_bf16 v[16:19], v[220:223], v[216:219], v[16:19]
v_mfma_f32_16x16x32_bf16 v[36:39], v[224:227], v[216:219], v[36:39]
ds_read_b128 v[216:219], v239 offset:29696
ds_read_b64_tr_b16 v[220:221], v243 offset:24576
ds_read_b64_tr_b16 v[222:223], v243 offset:26624
ds_read_b64_tr_b16 v[224:225], v243 offset:28672
ds_read_b64_tr_b16 v[226:227], v243 offset:30720
s_waitcnt lgkmcnt(8)
v_mfma_f32_16x16x32_bf16 v[0:3], v[228:231], v[200:203], v[0:3]
v_mfma_f32_16x16x32_bf16 v[20:23], v[232:235], v[200:203], v[20:23]
ds_read_b128 v[200:203], v239 offset:0
s_waitcnt lgkmcnt(8)
v_mfma_f32_16x16x32_bf16 v[4:7], v[228:231], v[204:207], v[4:7]
v_mfma_f32_16x16x32_bf16 v[24:27], v[232:235], v[204:207], v[24:27]
ds_read_b128 v[204:207], v239 offset:1024
s_waitcnt lgkmcnt(8)
v_mfma_f32_16x16x32_bf16 v[8:11], v[228:231], v[208:211], v[8:11]
v_mfma_f32_16x16x32_bf16 v[28:31], v[232:235], v[208:211], v[28:31]
ds_read_b128 v[208:211], v239 offset:2048
s_waitcnt lgkmcnt(8)
v_mfma_f32_16x16x32_bf16 v[12:15], v[228:231], v[212:215], v[12:15]
v_mfma_f32_16x16x32_bf16 v[32:35], v[232:235], v[212:215], v[32:35]
ds_read_b128 v[212:215], v239 offset:3072
s_waitcnt lgkmcnt(8)
v_mfma_f32_16x16x32_bf16 v[16:19], v[228:231], v[216:219], v[16:19]
v_mfma_f32_16x16x32_bf16 v[36:39], v[232:235], v[216:219], v[36:39]
ds_read_b128 v[216:219], v239 offset:4096
s_waitcnt vmcnt(6)
s_barrier
ds_read_b64_tr_b16 v[228:229], v243 offset:32768
ds_read_b64_tr_b16 v[230:231], v243 offset:34816
ds_read_b64_tr_b16 v[232:233], v243 offset:36864
ds_read_b64_tr_b16 v[234:235], v243 offset:38912
s_waitcnt lgkmcnt(8)
v_mfma_f32_16x16x32_bf16 v[40:43], v[220:223], v[200:203], v[40:43]
v_mfma_f32_16x16x32_bf16 v[60:63], v[224:227], v[200:203], v[60:63]
ds_read_b128 v[200:203], v239 offset:5120
s_waitcnt lgkmcnt(8)
v_mfma_f32_16x16x32_bf16 v[44:47], v[220:223], v[204:207], v[44:47]
v_mfma_f32_16x16x32_bf16 v[64:67], v[224:227], v[204:207], v[64:67]
ds_read_b128 v[204:207], v239 offset:6144
s_waitcnt lgkmcnt(8)
v_mfma_f32_16x16x32_bf16 v[48:51], v[220:223], v[208:211], v[48:51]
v_mfma_f32_16x16x32_bf16 v[68:71], v[224:227], v[208:211], v[68:71]
ds_read_b128 v[208:211], v239 offset:7168
s_waitcnt lgkmcnt(8)
v_mfma_f32_16x16x32_bf16 v[52:55], v[220:223], v[212:215], v[52:55]
v_mfma_f32_16x16x32_bf16 v[72:75], v[224:227], v[212:215], v[72:75]
ds_read_b128 v[212:215], v239 offset:8192
s_waitcnt lgkmcnt(8)
v_mfma_f32_16x16x32_bf16 v[56:59], v[220:223], v[216:219], v[56:59]
v_mfma_f32_16x16x32_bf16 v[76:79], v[224:227], v[216:219], v[76:79]
ds_read_b128 v[216:219], v239 offset:9216
ds_read_b64_tr_b16 v[220:221], v243 offset:40960
ds_read_b64_tr_b16 v[222:223], v243 offset:43008
ds_read_b64_tr_b16 v[224:225], v243 offset:45056
ds_read_b64_tr_b16 v[226:227], v243 offset:47104
s_waitcnt lgkmcnt(8)
v_mfma_f32_16x16x32_bf16 v[40:43], v[228:231], v[200:203], v[40:43]
v_cvt_pk_bf16_f32 v0, v0, v1
v_mfma_f32_16x16x32_bf16 v[60:63], v[232:235], v[200:203], v[60:63]
v_cvt_pk_bf16_f32 v1, v2, v3
ds_read_b128 v[200:203], v239 offset:10240
s_waitcnt lgkmcnt(8)
v_mfma_f32_16x16x32_bf16 v[44:47], v[228:231], v[204:207], v[44:47]
v_cvt_pk_bf16_f32 v2, v20, v21
v_mfma_f32_16x16x32_bf16 v[64:67], v[232:235], v[204:207], v[64:67]
v_cvt_pk_bf16_f32 v3, v22, v23
ds_read_b128 v[204:207], v239 offset:11264
s_waitcnt lgkmcnt(8)
v_mfma_f32_16x16x32_bf16 v[48:51], v[228:231], v[208:211], v[48:51]
s_add_u32 s32, s37, 0
v_mfma_f32_16x16x32_bf16 v[68:71], v[232:235], v[208:211], v[68:71]
buffer_store_dwordx4 v[0:3], v240, s[24:27], s32 offen sc1
ds_read_b128 v[208:211], v239 offset:12288
s_waitcnt lgkmcnt(8)
v_mfma_f32_16x16x32_bf16 v[52:55], v[228:231], v[212:215], v[52:55]
v_mfma_f32_16x16x32_bf16 v[72:75], v[232:235], v[212:215], v[72:75]
ds_read_b128 v[212:215], v239 offset:13312
s_waitcnt lgkmcnt(8)
v_mfma_f32_16x16x32_bf16 v[56:59], v[228:231], v[216:219], v[56:59]
v_mfma_f32_16x16x32_bf16 v[76:79], v[232:235], v[216:219], v[76:79]
ds_read_b128 v[216:219], v239 offset:14336
ds_read_b64_tr_b16 v[228:229], v238 offset:0
ds_read_b64_tr_b16 v[230:231], v238 offset:2048
ds_read_b64_tr_b16 v[232:233], v238 offset:4096
ds_read_b64_tr_b16 v[234:235], v238 offset:6144
s_waitcnt lgkmcnt(8)
v_mfma_f32_16x16x32_bf16 v[40:43], v[220:223], v[200:203], v[40:43]
v_cvt_pk_bf16_f32 v4, v4, v5
v_mfma_f32_16x16x32_bf16 v[60:63], v[224:227], v[200:203], v[60:63]
v_cvt_pk_bf16_f32 v5, v6, v7
ds_read_b128 v[200:203], v239 offset:15360
s_waitcnt lgkmcnt(8)
v_mfma_f32_16x16x32_bf16 v[44:47], v[220:223], v[204:207], v[44:47]
v_cvt_pk_bf16_f32 v6, v24, v25
v_mfma_f32_16x16x32_bf16 v[64:67], v[224:227], v[204:207], v[64:67]
v_cvt_pk_bf16_f32 v7, v26, v27
ds_read_b128 v[204:207], v239 offset:16384
s_waitcnt lgkmcnt(8)
v_mfma_f32_16x16x32_bf16 v[48:51], v[220:223], v[208:211], v[48:51]
s_add_u32 s32, s37, 4096
v_mfma_f32_16x16x32_bf16 v[68:71], v[224:227], v[208:211], v[68:71]
buffer_store_dwordx4 v[4:7], v240, s[24:27], s32 offen sc1
ds_read_b128 v[208:211], v239 offset:17408
s_waitcnt lgkmcnt(8)
v_mfma_f32_16x16x32_bf16 v[52:55], v[220:223], v[212:215], v[52:55]
v_mfma_f32_16x16x32_bf16 v[72:75], v[224:227], v[212:215], v[72:75]
ds_read_b128 v[212:215], v239 offset:18432
s_waitcnt lgkmcnt(8)
v_mfma_f32_16x16x32_bf16 v[56:59], v[220:223], v[216:219], v[56:59]
v_mfma_f32_16x16x32_bf16 v[76:79], v[224:227], v[216:219], v[76:79]
ds_read_b128 v[216:219], v239 offset:19456
s_waitcnt vmcnt(2)
s_barrier
ds_read_b64_tr_b16 v[220:221], v238 offset:8192
ds_read_b64_tr_b16 v[222:223], v238 offset:10240
ds_read_b64_tr_b16 v[224:225], v238 offset:12288
ds_read_b64_tr_b16 v[226:227], v238 offset:14336
s_waitcnt lgkmcnt(8)
v_mfma_f32_16x16x32_bf16 v[40:43], v[228:231], v[200:203], v[40:43]
v_cvt_pk_bf16_f32 v8, v8, v9
v_mfma_f32_16x16x32_bf16 v[60:63], v[232:235], v[200:203], v[60:63]
v_cvt_pk_bf16_f32 v9, v10, v11
ds_read_b128 v[200:203], v239 offset:20480
s_waitcnt lgkmcnt(8)
v_mfma_f32_16x16x32_bf16 v[44:47], v[228:231], v[204:207], v[44:47]
v_cvt_pk_bf16_f32 v10, v28, v29
v_mfma_f32_16x16x32_bf16 v[64:67], v[232:235], v[204:207], v[64:67]
v_cvt_pk_bf16_f32 v11, v30, v31
ds_read_b128 v[204:207], v239 offset:21504
s_waitcnt lgkmcnt(8)
v_mfma_f32_16x16x32_bf16 v[48:51], v[228:231], v[208:211], v[48:51]
s_add_u32 s32, s37, 8192
v_mfma_f32_16x16x32_bf16 v[68:71], v[232:235], v[208:211], v[68:71]
buffer_store_dwordx4 v[8:11], v240, s[24:27], s32 offen sc1
ds_read_b128 v[208:211], v239 offset:22528
s_waitcnt lgkmcnt(8)
v_mfma_f32_16x16x32_bf16 v[52:55], v[228:231], v[212:215], v[52:55]
v_mfma_f32_16x16x32_bf16 v[72:75], v[232:235], v[212:215], v[72:75]
ds_read_b128 v[212:215], v239 offset:23552
s_waitcnt lgkmcnt(8)
v_mfma_f32_16x16x32_bf16 v[56:59], v[228:231], v[216:219], v[56:59]
v_mfma_f32_16x16x32_bf16 v[76:79], v[232:235], v[216:219], v[76:79]
ds_read_b128 v[216:219], v239 offset:24576
ds_read_b64_tr_b16 v[228:229], v238 offset:16384
ds_read_b64_tr_b16 v[230:231], v238 offset:18432
ds_read_b64_tr_b16 v[232:233], v238 offset:20480
ds_read_b64_tr_b16 v[234:235], v238 offset:22528
s_waitcnt lgkmcnt(8)
v_mfma_f32_16x16x32_bf16 v[40:43], v[220:223], v[200:203], v[40:43]
v_cvt_pk_bf16_f32 v12, v12, v13
v_mfma_f32_16x16x32_bf16 v[60:63], v[224:227], v[200:203], v[60:63]
v_cvt_pk_bf16_f32 v13, v14, v15
ds_read_b128 v[200:203], v239 offset:25600
s_waitcnt lgkmcnt(8)
v_mfma_f32_16x16x32_bf16 v[44:47], v[220:223], v[204:207], v[44:47]
v_cvt_pk_bf16_f32 v14, v32, v33
v_mfma_f32_16x16x32_bf16 v[64:67], v[224:227], v[204:207], v[64:67]
v_cvt_pk_bf16_f32 v15, v34, v35
ds_read_b128 v[204:207], v239 offset:26624
s_waitcnt lgkmcnt(8)
v_mfma_f32_16x16x32_bf16 v[48:51], v[220:223], v[208:211], v[48:51]
s_add_u32 s32, s37, 12288
v_mfma_f32_16x16x32_bf16 v[68:71], v[224:227], v[208:211], v[68:71]
buffer_store_dwordx4 v[12:15], v240, s[24:27], s32 offen sc1
ds_read_b128 v[208:211], v239 offset:27648
s_waitcnt lgkmcnt(8)
v_mfma_f32_16x16x32_bf16 v[52:55], v[220:223], v[212:215], v[52:55]
v_mfma_f32_16x16x32_bf16 v[72:75], v[224:227], v[212:215], v[72:75]
ds_read_b128 v[212:215], v239 offset:28672
s_waitcnt lgkmcnt(8)
v_mfma_f32_16x16x32_bf16 v[56:59], v[220:223], v[216:219], v[56:59]
v_mfma_f32_16x16x32_bf16 v[76:79], v[224:227], v[216:219], v[76:79]
ds_read_b128 v[216:219], v239 offset:29696
ds_read_b64_tr_b16 v[220:221], v238 offset:24576
ds_read_b64_tr_b16 v[222:223], v238 offset:26624
ds_read_b64_tr_b16 v[224:225], v238 offset:28672
ds_read_b64_tr_b16 v[226:227], v238 offset:30720
s_waitcnt lgkmcnt(8)
v_mfma_f32_16x16x32_bf16 v[40:43], v[228:231], v[200:203], v[40:43]
v_cvt_pk_bf16_f32 v16, v16, v17
v_mfma_f32_16x16x32_bf16 v[60:63], v[232:235], v[200:203], v[60:63]
v_cvt_pk_bf16_f32 v17, v18, v19
ds_read_b128 v[200:203], v239 offset:0
s_waitcnt lgkmcnt(8)
v_mfma_f32_16x16x32_bf16 v[44:47], v[228:231], v[204:207], v[44:47]
v_cvt_pk_bf16_f32 v18, v36, v37
v_mfma_f32_16x16x32_bf16 v[64:67], v[232:235], v[204:207], v[64:67]
v_cvt_pk_bf16_f32 v19, v38, v39
ds_read_b128 v[204:207], v239 offset:1024
s_waitcnt lgkmcnt(8)
v_mfma_f32_16x16x32_bf16 v[48:51], v[228:231], v[208:211], v[48:51]
s_add_u32 s32, s37, 16384
v_mfma_f32_16x16x32_bf16 v[68:71], v[232:235], v[208:211], v[68:71]
buffer_store_dwordx4 v[16:19], v240, s[24:27], s32 offen sc1
ds_read_b128 v[208:211], v239 offset:2048
s_waitcnt lgkmcnt(8)
v_mfma_f32_16x16x32_bf16 v[52:55], v[228:231], v[212:215], v[52:55]
v_mfma_f32_16x16x32_bf16 v[72:75], v[232:235], v[212:215], v[72:75]
ds_read_b128 v[212:215], v239 offset:3072
s_waitcnt lgkmcnt(8)
v_mfma_f32_16x16x32_bf16 v[56:59], v[228:231], v[216:219], v[56:59]
v_mfma_f32_16x16x32_bf16 v[76:79], v[232:235], v[216:219], v[76:79]
ds_read_b128 v[216:219], v239 offset:4096
s_barrier
ds_read_b64_tr_b16 v[228:229], v238 offset:32768
ds_read_b64_tr_b16 v[230:231], v238 offset:34816
ds_read_b64_tr_b16 v[232:233], v238 offset:36864
ds_read_b64_tr_b16 v[234:235], v238 offset:38912
s_waitcnt lgkmcnt(8)
v_mfma_f32_16x16x32_bf16 v[80:83], v[220:223], v[200:203], v[80:83]
v_mfma_f32_16x16x32_bf16 v[100:103], v[224:227], v[200:203], v[100:103]
ds_read_b128 v[200:203], v239 offset:5120
s_waitcnt lgkmcnt(8)
v_mfma_f32_16x16x32_bf16 v[84:87], v[220:223], v[204:207], v[84:87]
v_mfma_f32_16x16x32_bf16 v[104:107], v[224:227], v[204:207], v[104:107]
ds_read_b128 v[204:207], v239 offset:6144
s_waitcnt lgkmcnt(8)
v_mfma_f32_16x16x32_bf16 v[88:91], v[220:223], v[208:211], v[88:91]
v_mfma_f32_16x16x32_bf16 v[108:111], v[224:227], v[208:211], v[108:111]
ds_read_b128 v[208:211], v239 offset:7168
s_waitcnt lgkmcnt(8)
v_mfma_f32_16x16x32_bf16 v[92:95], v[220:223], v[212:215], v[92:95]
v_mfma_f32_16x16x32_bf16 v[112:115], v[224:227], v[212:215], v[112:115]
ds_read_b128 v[212:215], v239 offset:8192
s_waitcnt lgkmcnt(8)
v_mfma_f32_16x16x32_bf16 v[96:99], v[220:223], v[216:219], v[96:99]
v_mfma_f32_16x16x32_bf16 v[116:119], v[224:227], v[216:219], v[116:119]
ds_read_b128 v[216:219], v239 offset:9216
ds_read_b64_tr_b16 v[220:221], v238 offset:40960
ds_read_b64_tr_b16 v[222:223], v238 offset:43008
ds_read_b64_tr_b16 v[224:225], v238 offset:45056
ds_read_b64_tr_b16 v[226:227], v238 offset:47104
s_waitcnt lgkmcnt(8)
v_mfma_f32_16x16x32_bf16 v[80:83], v[228:231], v[200:203], v[80:83]
v_cvt_pk_bf16_f32 v40, v40, v41
v_mfma_f32_16x16x32_bf16 v[100:103], v[232:235], v[200:203], v[100:103]
v_cvt_pk_bf16_f32 v41, v42, v43
ds_read_b128 v[200:203], v239 offset:10240
s_waitcnt lgkmcnt(8)
v_mfma_f32_16x16x32_bf16 v[84:87], v[228:231], v[204:207], v[84:87]
v_cvt_pk_bf16_f32 v42, v60, v61
v_mfma_f32_16x16x32_bf16 v[104:107], v[232:235], v[204:207], v[104:107]
v_cvt_pk_bf16_f32 v43, v62, v63
ds_read_b128 v[204:207], v239 offset:11264
s_waitcnt lgkmcnt(8)
v_mfma_f32_16x16x32_bf16 v[88:91], v[228:231], v[208:211], v[88:91]
s_add_u32 s32, s37, 20480
v_mfma_f32_16x16x32_bf16 v[108:111], v[232:235], v[208:211], v[108:111]
buffer_store_dwordx4 v[40:43], v240, s[24:27], s32 offen sc1
ds_read_b128 v[208:211], v239 offset:12288
s_waitcnt lgkmcnt(8)
v_mfma_f32_16x16x32_bf16 v[92:95], v[228:231], v[212:215], v[92:95]
v_mfma_f32_16x16x32_bf16 v[112:115], v[232:235], v[212:215], v[112:115]
ds_read_b128 v[212:215], v239 offset:13312
s_waitcnt lgkmcnt(8)
v_mfma_f32_16x16x32_bf16 v[96:99], v[228:231], v[216:219], v[96:99]
v_mfma_f32_16x16x32_bf16 v[116:119], v[232:235], v[216:219], v[116:119]
ds_read_b128 v[216:219], v239 offset:14336
ds_read_b64_tr_b16 v[228:229], v238 offset:49152
ds_read_b64_tr_b16 v[230:231], v238 offset:51200
ds_read_b64_tr_b16 v[232:233], v238 offset:53248
ds_read_b64_tr_b16 v[234:235], v238 offset:55296
s_waitcnt lgkmcnt(8)
v_mfma_f32_16x16x32_bf16 v[80:83], v[220:223], v[200:203], v[80:83]
v_cvt_pk_bf16_f32 v44, v44, v45
v_mfma_f32_16x16x32_bf16 v[100:103], v[224:227], v[200:203], v[100:103]
v_cvt_pk_bf16_f32 v45, v46, v47
ds_read_b128 v[200:203], v239 offset:15360
s_waitcnt lgkmcnt(8)
v_mfma_f32_16x16x32_bf16 v[84:87], v[220:223], v[204:207], v[84:87]
v_cvt_pk_bf16_f32 v46, v64, v65
v_mfma_f32_16x16x32_bf16 v[104:107], v[224:227], v[204:207], v[104:107]
v_cvt_pk_bf16_f32 v47, v66, v67
ds_read_b128 v[204:207], v239 offset:16384
s_waitcnt lgkmcnt(8)
v_mfma_f32_16x16x32_bf16 v[88:91], v[220:223], v[208:211], v[88:91]
s_add_u32 s32, s37, 24576
v_mfma_f32_16x16x32_bf16 v[108:111], v[224:227], v[208:211], v[108:111]
buffer_store_dwordx4 v[44:47], v240, s[24:27], s32 offen sc1
ds_read_b128 v[208:211], v239 offset:17408
s_waitcnt lgkmcnt(8)
v_mfma_f32_16x16x32_bf16 v[92:95], v[220:223], v[212:215], v[92:95]
v_mfma_f32_16x16x32_bf16 v[112:115], v[224:227], v[212:215], v[112:115]
ds_read_b128 v[212:215], v239 offset:18432
s_waitcnt lgkmcnt(8)
v_mfma_f32_16x16x32_bf16 v[96:99], v[220:223], v[216:219], v[96:99]
v_mfma_f32_16x16x32_bf16 v[116:119], v[224:227], v[216:219], v[116:119]
ds_read_b128 v[216:219], v239 offset:19456
s_barrier
ds_read_b64_tr_b16 v[220:221], v238 offset:57344
ds_read_b64_tr_b16 v[222:223], v238 offset:59392
ds_read_b64_tr_b16 v[224:225], v243 offset:0
ds_read_b64_tr_b16 v[226:227], v243 offset:2048
s_waitcnt lgkmcnt(8)
v_mfma_f32_16x16x32_bf16 v[80:83], v[228:231], v[200:203], v[80:83]
v_cvt_pk_bf16_f32 v48, v48, v49
v_mfma_f32_16x16x32_bf16 v[100:103], v[232:235], v[200:203], v[100:103]
v_cvt_pk_bf16_f32 v49, v50, v51
ds_read_b128 v[200:203], v239 offset:20480
s_waitcnt lgkmcnt(8)
v_mfma_f32_16x16x32_bf16 v[84:87], v[228:231], v[204:207], v[84:87]
v_cvt_pk_bf16_f32 v50, v68, v69
v_mfma_f32_16x16x32_bf16 v[104:107], v[232:235], v[204:207], v[104:107]
v_cvt_pk_bf16_f32 v51, v70, v71
ds_read_b128 v[204:207], v239 offset:21504
s_waitcnt lgkmcnt(8)
v_mfma_f32_16x16x32_bf16 v[88:91], v[228:231], v[208:211], v[88:91]
s_add_u32 s32, s37, 28672
v_mfma_f32_16x16x32_bf16 v[108:111], v[232:235], v[208:211], v[108:111]
buffer_store_dwordx4 v[48:51], v240, s[24:27], s32 offen sc1
ds_read_b128 v[208:211], v239 offset:22528
s_waitcnt lgkmcnt(8)
v_mfma_f32_16x16x32_bf16 v[92:95], v[228:231], v[212:215], v[92:95]
v_mfma_f32_16x16x32_bf16 v[112:115], v[232:235], v[212:215], v[112:115]
ds_read_b128 v[212:215], v239 offset:23552
s_waitcnt lgkmcnt(8)
v_mfma_f32_16x16x32_bf16 v[96:99], v[228:231], v[216:219], v[96:99]
v_mfma_f32_16x16x32_bf16 v[116:119], v[232:235], v[216:219], v[116:119]
ds_read_b128 v[216:219], v239 offset:24576
ds_read_b64_tr_b16 v[228:229], v243 offset:4096
ds_read_b64_tr_b16 v[230:231], v243 offset:6144
ds_read_b64_tr_b16 v[232:233], v243 offset:8192
ds_read_b64_tr_b16 v[234:235], v243 offset:10240
s_waitcnt lgkmcnt(8)
v_mfma_f32_16x16x32_bf16 v[80:83], v[220:223], v[200:203], v[80:83]
v_cvt_pk_bf16_f32 v52, v52, v53
v_mfma_f32_16x16x32_bf16 v[100:103], v[224:227], v[200:203], v[100:103]
v_cvt_pk_bf16_f32 v53, v54, v55
ds_read_b128 v[200:203], v239 offset:25600
s_waitcnt lgkmcnt(8)
v_mfma_f32_16x16x32_bf16 v[84:87], v[220:223], v[204:207], v[84:87]
v_cvt_pk_bf16_f32 v54, v72, v73
v_mfma_f32_16x16x32_bf16 v[104:107], v[224:227], v[204:207], v[104:107]
v_cvt_pk_bf16_f32 v55, v74, v75
ds_read_b128 v[204:207], v239 offset:26624
s_waitcnt lgkmcnt(8)
v_mfma_f32_16x16x32_bf16 v[88:91], v[220:223], v[208:211], v[88:91]
s_add_u32 s32, s37, 32768
v_mfma_f32_16x16x32_bf16 v[108:111], v[224:227], v[208:211], v[108:111]
buffer_store_dwordx4 v[52:55], v240, s[24:27], s32 offen sc1
ds_read_b128 v[208:211], v239 offset:27648
s_waitcnt lgkmcnt(8)
v_mfma_f32_16x16x32_bf16 v[92:95], v[220:223], v[212:215], v[92:95]
v_mfma_f32_16x16x32_bf16 v[112:115], v[224:227], v[212:215], v[112:115]
ds_read_b128 v[212:215], v239 offset:28672
s_waitcnt lgkmcnt(8)
v_mfma_f32_16x16x32_bf16 v[96:99], v[220:223], v[216:219], v[96:99]
v_mfma_f32_16x16x32_bf16 v[116:119], v[224:227], v[216:219], v[116:119]
ds_read_b128 v[216:219], v239 offset:29696
ds_read_b64_tr_b16 v[220:221], v243 offset:12288
ds_read_b64_tr_b16 v[222:223], v243 offset:14336
ds_read_b64_tr_b16 v[224:225], v243 offset:16384
ds_read_b64_tr_b16 v[226:227], v243 offset:18432
s_waitcnt lgkmcnt(8)
v_mfma_f32_16x16x32_bf16 v[80:83], v[228:231], v[200:203], v[80:83]
v_cvt_pk_bf16_f32 v56, v56, v57
v_mfma_f32_16x16x32_bf16 v[100:103], v[232:235], v[200:203], v[100:103]
v_cvt_pk_bf16_f32 v57, v58, v59
ds_read_b128 v[200:203], v239 offset:0
s_waitcnt lgkmcnt(8)
v_mfma_f32_16x16x32_bf16 v[84:87], v[228:231], v[204:207], v[84:87]
v_cvt_pk_bf16_f32 v58, v76, v77
v_mfma_f32_16x16x32_bf16 v[104:107], v[232:235], v[204:207], v[104:107]
v_cvt_pk_bf16_f32 v59, v78, v79
ds_read_b128 v[204:207], v239 offset:1024
s_waitcnt lgkmcnt(8)
v_mfma_f32_16x16x32_bf16 v[88:91], v[228:231], v[208:211], v[88:91]
s_add_u32 s32, s37, 36864
v_mfma_f32_16x16x32_bf16 v[108:111], v[232:235], v[208:211], v[108:111]
buffer_store_dwordx4 v[56:59], v240, s[24:27], s32 offen sc1
ds_read_b128 v[208:211], v239 offset:2048
s_waitcnt lgkmcnt(8)
v_mfma_f32_16x16x32_bf16 v[92:95], v[228:231], v[212:215], v[92:95]
v_mfma_f32_16x16x32_bf16 v[112:115], v[232:235], v[212:215], v[112:115]
ds_read_b128 v[212:215], v239 offset:3072
s_waitcnt lgkmcnt(8)
v_mfma_f32_16x16x32_bf16 v[96:99], v[228:231], v[216:219], v[96:99]
v_mfma_f32_16x16x32_bf16 v[116:119], v[232:235], v[216:219], v[116:119]
ds_read_b128 v[216:219], v239 offset:4096
s_barrier
ds_read_b64_tr_b16 v[228:229], v243 offset:20480
ds_read_b64_tr_b16 v[230:231], v243 offset:22528
ds_read_b64_tr_b16 v[232:233], v243 offset:24576
ds_read_b64_tr_b16 v[234:235], v243 offset:26624
s_waitcnt lgkmcnt(8)
v_mfma_f32_16x16x32_bf16 v[120:123], v[220:223], v[200:203], v[120:123]
v_mfma_f32_16x16x32_bf16 v[140:143], v[224:227], v[200:203], v[140:143]
ds_read_b128 v[200:203], v239 offset:5120
s_waitcnt lgkmcnt(8)
v_mfma_f32_16x16x32_bf16 v[124:127], v[220:223], v[204:207], v[124:127]
v_mfma_f32_16x16x32_bf16 v[144:147], v[224:227], v[204:207], v[144:147]
ds_read_b128 v[204:207], v239 offset:6144
s_waitcnt lgkmcnt(8)
v_mfma_f32_16x16x32_bf16 v[128:131], v[220:223], v[208:211], v[128:131]
v_mfma_f32_16x16x32_bf16 v[148:151], v[224:227], v[208:211], v[148:151]
ds_read_b128 v[208:211], v239 offset:7168
s_waitcnt lgkmcnt(8)
v_mfma_f32_16x16x32_bf16 v[132:135], v[220:223], v[212:215], v[132:135]
v_mfma_f32_16x16x32_bf16 v[152:155], v[224:227], v[212:215], v[152:155]
ds_read_b128 v[212:215], v239 offset:8192
s_waitcnt lgkmcnt(8)
v_mfma_f32_16x16x32_bf16 v[136:139], v[220:223], v[216:219], v[136:139]
v_mfma_f32_16x16x32_bf16 v[156:159], v[224:227], v[216:219], v[156:159]
ds_read_b128 v[216:219], v239 offset:9216
ds_read_b64_tr_b16 v[220:221], v243 offset:28672
ds_read_b64_tr_b16 v[222:223], v243 offset:30720
ds_read_b64_tr_b16 v[224:225], v243 offset:32768
ds_read_b64_tr_b16 v[226:227], v243 offset:34816
s_waitcnt lgkmcnt(8)
v_mfma_f32_16x16x32_bf16 v[120:123], v[228:231], v[200:203], v[120:123]
v_cvt_pk_bf16_f32 v80, v80, v81
v_mfma_f32_16x16x32_bf16 v[140:143], v[232:235], v[200:203], v[140:143]
v_cvt_pk_bf16_f32 v81, v82, v83
ds_read_b128 v[200:203], v239 offset:10240
s_waitcnt lgkmcnt(8)
v_mfma_f32_16x16x32_bf16 v[124:127], v[228:231], v[204:207], v[124:127]
v_cvt_pk_bf16_f32 v82, v100, v101
v_mfma_f32_16x16x32_bf16 v[144:147], v[232:235], v[204:207], v[144:147]
v_cvt_pk_bf16_f32 v83, v102, v103
ds_read_b128 v[204:207], v239 offset:11264
s_waitcnt lgkmcnt(8)
v_mfma_f32_16x16x32_bf16 v[128:131], v[228:231], v[208:211], v[128:131]
s_add_u32 s32, s37, 40960
v_mfma_f32_16x16x32_bf16 v[148:151], v[232:235], v[208:211], v[148:151]
buffer_store_dwordx4 v[80:83], v240, s[24:27], s32 offen sc1
ds_read_b128 v[208:211], v239 offset:12288
s_waitcnt lgkmcnt(8)
v_mfma_f32_16x16x32_bf16 v[132:135], v[228:231], v[212:215], v[132:135]
v_mfma_f32_16x16x32_bf16 v[152:155], v[232:235], v[212:215], v[152:155]
ds_read_b128 v[212:215], v239 offset:13312
s_waitcnt lgkmcnt(8)
v_mfma_f32_16x16x32_bf16 v[136:139], v[228:231], v[216:219], v[136:139]
v_mfma_f32_16x16x32_bf16 v[156:159], v[232:235], v[216:219], v[156:159]
ds_read_b128 v[216:219], v239 offset:14336
ds_read_b64_tr_b16 v[228:229], v243 offset:36864
ds_read_b64_tr_b16 v[230:231], v243 offset:38912
ds_read_b64_tr_b16 v[232:233], v243 offset:40960
ds_read_b64_tr_b16 v[234:235], v243 offset:43008
s_waitcnt lgkmcnt(8)
v_mfma_f32_16x16x32_bf16 v[120:123], v[220:223], v[200:203], v[120:123]
v_cvt_pk_bf16_f32 v84, v84, v85
v_mfma_f32_16x16x32_bf16 v[140:143], v[224:227], v[200:203], v[140:143]
v_cvt_pk_bf16_f32 v85, v86, v87
ds_read_b128 v[200:203], v239 offset:15360
s_waitcnt lgkmcnt(8)
v_mfma_f32_16x16x32_bf16 v[124:127], v[220:223], v[204:207], v[124:127]
v_cvt_pk_bf16_f32 v86, v104, v105
v_mfma_f32_16x16x32_bf16 v[144:147], v[224:227], v[204:207], v[144:147]
v_cvt_pk_bf16_f32 v87, v106, v107
ds_read_b128 v[204:207], v239 offset:16384
s_waitcnt lgkmcnt(8)
v_mfma_f32_16x16x32_bf16 v[128:131], v[220:223], v[208:211], v[128:131]
s_add_u32 s32, s37, 45056
v_mfma_f32_16x16x32_bf16 v[148:151], v[224:227], v[208:211], v[148:151]
buffer_store_dwordx4 v[84:87], v240, s[24:27], s32 offen sc1
ds_read_b128 v[208:211], v239 offset:17408
s_waitcnt lgkmcnt(8)
v_mfma_f32_16x16x32_bf16 v[132:135], v[220:223], v[212:215], v[132:135]
v_mfma_f32_16x16x32_bf16 v[152:155], v[224:227], v[212:215], v[152:155]
ds_read_b128 v[212:215], v239 offset:18432
s_waitcnt lgkmcnt(8)
v_mfma_f32_16x16x32_bf16 v[136:139], v[220:223], v[216:219], v[136:139]
v_mfma_f32_16x16x32_bf16 v[156:159], v[224:227], v[216:219], v[156:159]
ds_read_b128 v[216:219], v239 offset:19456
s_barrier
ds_read_b64_tr_b16 v[220:221], v243 offset:45056
ds_read_b64_tr_b16 v[222:223], v243 offset:47104
ds_read_b64_tr_b16 v[224:225], v238 offset:0
ds_read_b64_tr_b16 v[226:227], v238 offset:2048
s_waitcnt lgkmcnt(8)
v_mfma_f32_16x16x32_bf16 v[120:123], v[228:231], v[200:203], v[120:123]
v_cvt_pk_bf16_f32 v88, v88, v89
v_mfma_f32_16x16x32_bf16 v[140:143], v[232:235], v[200:203], v[140:143]
v_cvt_pk_bf16_f32 v89, v90, v91
ds_read_b128 v[200:203], v239 offset:20480
s_waitcnt lgkmcnt(8)
v_mfma_f32_16x16x32_bf16 v[124:127], v[228:231], v[204:207], v[124:127]
v_cvt_pk_bf16_f32 v90, v108, v109
v_mfma_f32_16x16x32_bf16 v[144:147], v[232:235], v[204:207], v[144:147]
v_cvt_pk_bf16_f32 v91, v110, v111
ds_read_b128 v[204:207], v239 offset:21504
s_waitcnt lgkmcnt(8)
v_mfma_f32_16x16x32_bf16 v[128:131], v[228:231], v[208:211], v[128:131]
s_add_u32 s32, s37, 49152
v_mfma_f32_16x16x32_bf16 v[148:151], v[232:235], v[208:211], v[148:151]
buffer_store_dwordx4 v[88:91], v240, s[24:27], s32 offen sc1
ds_read_b128 v[208:211], v239 offset:22528
s_waitcnt lgkmcnt(8)
v_mfma_f32_16x16x32_bf16 v[132:135], v[228:231], v[212:215], v[132:135]
v_mfma_f32_16x16x32_bf16 v[152:155], v[232:235], v[212:215], v[152:155]
ds_read_b128 v[212:215], v239 offset:23552
s_waitcnt lgkmcnt(8)
v_mfma_f32_16x16x32_bf16 v[136:139], v[228:231], v[216:219], v[136:139]
v_mfma_f32_16x16x32_bf16 v[156:159], v[232:235], v[216:219], v[156:159]
ds_read_b128 v[216:219], v239 offset:24576
ds_read_b64_tr_b16 v[228:229], v238 offset:4096
ds_read_b64_tr_b16 v[230:231], v238 offset:6144
ds_read_b64_tr_b16 v[232:233], v238 offset:8192
ds_read_b64_tr_b16 v[234:235], v238 offset:10240
s_waitcnt lgkmcnt(8)
v_mfma_f32_16x16x32_bf16 v[120:123], v[220:223], v[200:203], v[120:123]
v_cvt_pk_bf16_f32 v92, v92, v93
v_mfma_f32_16x16x32_bf16 v[140:143], v[224:227], v[200:203], v[140:143]
v_cvt_pk_bf16_f32 v93, v94, v95
ds_read_b128 v[200:203], v239 offset:25600
s_waitcnt lgkmcnt(8)
v_mfma_f32_16x16x32_bf16 v[124:127], v[220:223], v[204:207], v[124:127]
v_cvt_pk_bf16_f32 v94, v112, v113
v_mfma_f32_16x16x32_bf16 v[144:147], v[224:227], v[204:207], v[144:147]
v_cvt_pk_bf16_f32 v95, v114, v115
ds_read_b128 v[204:207], v239 offset:26624
s_waitcnt lgkmcnt(8)
v_mfma_f32_16x16x32_bf16 v[128:131], v[220:223], v[208:211], v[128:131]
s_add_u32 s32, s37, 53248
v_mfma_f32_16x16x32_bf16 v[148:151], v[224:227], v[208:211], v[148:151]
buffer_store_dwordx4 v[92:95], v240, s[24:27], s32 offen sc1
ds_read_b128 v[208:211], v239 offset:27648
s_waitcnt lgkmcnt(8)
v_mfma_f32_16x16x32_bf16 v[132:135], v[220:223], v[212:215], v[132:135]
v_mfma_f32_16x16x32_bf16 v[152:155], v[224:227], v[212:215], v[152:155]
ds_read_b128 v[212:215], v239 offset:28672
s_waitcnt lgkmcnt(8)
v_mfma_f32_16x16x32_bf16 v[136:139], v[220:223], v[216:219], v[136:139]
v_mfma_f32_16x16x32_bf16 v[156:159], v[224:227], v[216:219], v[156:159]
ds_read_b128 v[216:219], v239 offset:29696
ds_read_b64_tr_b16 v[220:221], v238 offset:12288
ds_read_b64_tr_b16 v[222:223], v238 offset:14336
ds_read_b64_tr_b16 v[224:225], v238 offset:16384
ds_read_b64_tr_b16 v[226:227], v238 offset:18432
s_waitcnt lgkmcnt(8)
v_mfma_f32_16x16x32_bf16 v[120:123], v[228:231], v[200:203], v[120:123]
v_cvt_pk_bf16_f32 v96, v96, v97
v_mfma_f32_16x16x32_bf16 v[140:143], v[232:235], v[200:203], v[140:143]
v_cvt_pk_bf16_f32 v97, v98, v99
ds_read_b128 v[200:203], v239 offset:0
s_waitcnt lgkmcnt(8)
v_mfma_f32_16x16x32_bf16 v[124:127], v[228:231], v[204:207], v[124:127]
v_cvt_pk_bf16_f32 v98, v116, v117
v_mfma_f32_16x16x32_bf16 v[144:147], v[232:235], v[204:207], v[144:147]
v_cvt_pk_bf16_f32 v99, v118, v119
ds_read_b128 v[204:207], v239 offset:1024
s_waitcnt lgkmcnt(8)
v_mfma_f32_16x16x32_bf16 v[128:131], v[228:231], v[208:211], v[128:131]
s_add_u32 s32, s37, 57344
v_mfma_f32_16x16x32_bf16 v[148:151], v[232:235], v[208:211], v[148:151]
buffer_store_dwordx4 v[96:99], v240, s[24:27], s32 offen sc1
ds_read_b128 v[208:211], v239 offset:2048
s_waitcnt lgkmcnt(8)
v_mfma_f32_16x16x32_bf16 v[132:135], v[228:231], v[212:215], v[132:135]
v_mfma_f32_16x16x32_bf16 v[152:155], v[232:235], v[212:215], v[152:155]
ds_read_b128 v[212:215], v239 offset:3072
s_waitcnt lgkmcnt(8)
v_mfma_f32_16x16x32_bf16 v[136:139], v[228:231], v[216:219], v[136:139]
v_mfma_f32_16x16x32_bf16 v[156:159], v[232:235], v[216:219], v[156:159]
ds_read_b128 v[216:219], v239 offset:4096
s_barrier
ds_read_b64_tr_b16 v[228:229], v238 offset:20480
ds_read_b64_tr_b16 v[230:231], v238 offset:22528
ds_read_b64_tr_b16 v[232:233], v238 offset:24576
ds_read_b64_tr_b16 v[234:235], v238 offset:26624
s_waitcnt lgkmcnt(8)
v_mfma_f32_16x16x32_bf16 v[160:163], v[220:223], v[200:203], v[160:163]
v_mfma_f32_16x16x32_bf16 v[180:183], v[224:227], v[200:203], v[180:183]
ds_read_b128 v[200:203], v239 offset:5120
s_waitcnt lgkmcnt(8)
v_mfma_f32_16x16x32_bf16 v[164:167], v[220:223], v[204:207], v[164:167]
v_mfma_f32_16x16x32_bf16 v[184:187], v[224:227], v[204:207], v[184:187]
ds_read_b128 v[204:207], v239 offset:6144
s_waitcnt lgkmcnt(8)
v_mfma_f32_16x16x32_bf16 v[168:171], v[220:223], v[208:211], v[168:171]
v_mfma_f32_16x16x32_bf16 v[188:191], v[224:227], v[208:211], v[188:191]
ds_read_b128 v[208:211], v239 offset:7168
s_waitcnt lgkmcnt(8)
v_mfma_f32_16x16x32_bf16 v[172:175], v[220:223], v[212:215], v[172:175]
v_mfma_f32_16x16x32_bf16 v[192:195], v[224:227], v[212:215], v[192:195]
ds_read_b128 v[212:215], v239 offset:8192
s_waitcnt lgkmcnt(8)
v_mfma_f32_16x16x32_bf16 v[176:179], v[220:223], v[216:219], v[176:179]
v_mfma_f32_16x16x32_bf16 v[196:199], v[224:227], v[216:219], v[196:199]
ds_read_b128 v[216:219], v239 offset:9216
ds_read_b64_tr_b16 v[220:221], v238 offset:28672
ds_read_b64_tr_b16 v[222:223], v238 offset:30720
ds_read_b64_tr_b16 v[224:225], v238 offset:32768
ds_read_b64_tr_b16 v[226:227], v238 offset:34816
s_waitcnt lgkmcnt(8)
v_mfma_f32_16x16x32_bf16 v[160:163], v[228:231], v[200:203], v[160:163]
v_cvt_pk_bf16_f32 v120, v120, v121
v_mfma_f32_16x16x32_bf16 v[180:183], v[232:235], v[200:203], v[180:183]
v_cvt_pk_bf16_f32 v121, v122, v123
ds_read_b128 v[200:203], v239 offset:10240
s_waitcnt lgkmcnt(8)
v_mfma_f32_16x16x32_bf16 v[164:167], v[228:231], v[204:207], v[164:167]
v_cvt_pk_bf16_f32 v122, v140, v141
v_mfma_f32_16x16x32_bf16 v[184:187], v[232:235], v[204:207], v[184:187]
v_cvt_pk_bf16_f32 v123, v142, v143
ds_read_b128 v[204:207], v239 offset:11264
s_waitcnt lgkmcnt(8)
v_mfma_f32_16x16x32_bf16 v[168:171], v[228:231], v[208:211], v[168:171]
s_add_u32 s32, s37, 61440
v_mfma_f32_16x16x32_bf16 v[188:191], v[232:235], v[208:211], v[188:191]
buffer_store_dwordx4 v[120:123], v240, s[24:27], s32 offen sc1
ds_read_b128 v[208:211], v239 offset:12288
s_waitcnt lgkmcnt(8)
v_mfma_f32_16x16x32_bf16 v[172:175], v[228:231], v[212:215], v[172:175]
v_mfma_f32_16x16x32_bf16 v[192:195], v[232:235], v[212:215], v[192:195]
ds_read_b128 v[212:215], v239 offset:13312
s_waitcnt lgkmcnt(8)
v_mfma_f32_16x16x32_bf16 v[176:179], v[228:231], v[216:219], v[176:179]
v_mfma_f32_16x16x32_bf16 v[196:199], v[232:235], v[216:219], v[196:199]
ds_read_b128 v[216:219], v239 offset:14336
ds_read_b64_tr_b16 v[228:229], v238 offset:36864
ds_read_b64_tr_b16 v[230:231], v238 offset:38912
ds_read_b64_tr_b16 v[232:233], v238 offset:40960
ds_read_b64_tr_b16 v[234:235], v238 offset:43008
s_waitcnt lgkmcnt(8)
v_mfma_f32_16x16x32_bf16 v[160:163], v[220:223], v[200:203], v[160:163]
v_cvt_pk_bf16_f32 v124, v124, v125
v_mfma_f32_16x16x32_bf16 v[180:183], v[224:227], v[200:203], v[180:183]
v_cvt_pk_bf16_f32 v125, v126, v127
ds_read_b128 v[200:203], v239 offset:15360
s_waitcnt lgkmcnt(8)
v_mfma_f32_16x16x32_bf16 v[164:167], v[220:223], v[204:207], v[164:167]
v_cvt_pk_bf16_f32 v126, v144, v145
v_mfma_f32_16x16x32_bf16 v[184:187], v[224:227], v[204:207], v[184:187]
v_cvt_pk_bf16_f32 v127, v146, v147
ds_read_b128 v[204:207], v239 offset:16384
s_waitcnt lgkmcnt(8)
v_mfma_f32_16x16x32_bf16 v[168:171], v[220:223], v[208:211], v[168:171]
s_add_u32 s32, s37, 65536
v_mfma_f32_16x16x32_bf16 v[188:191], v[224:227], v[208:211], v[188:191]
buffer_store_dwordx4 v[124:127], v240, s[24:27], s32 offen sc1
ds_read_b128 v[208:211], v239 offset:17408
s_waitcnt lgkmcnt(8)
v_mfma_f32_16x16x32_bf16 v[172:175], v[220:223], v[212:215], v[172:175]
v_mfma_f32_16x16x32_bf16 v[192:195], v[224:227], v[212:215], v[192:195]
ds_read_b128 v[212:215], v239 offset:18432
s_waitcnt lgkmcnt(8)
v_mfma_f32_16x16x32_bf16 v[176:179], v[220:223], v[216:219], v[176:179]
v_mfma_f32_16x16x32_bf16 v[196:199], v[224:227], v[216:219], v[196:199]
ds_read_b128 v[216:219], v239 offset:19456
s_barrier
ds_read_b64_tr_b16 v[220:221], v238 offset:45056
ds_read_b64_tr_b16 v[222:223], v238 offset:47104
ds_read_b64_tr_b16 v[224:225], v238 offset:49152
ds_read_b64_tr_b16 v[226:227], v238 offset:51200
s_waitcnt lgkmcnt(8)
v_mfma_f32_16x16x32_bf16 v[160:163], v[228:231], v[200:203], v[160:163]
v_cvt_pk_bf16_f32 v128, v128, v129
v_mfma_f32_16x16x32_bf16 v[180:183], v[232:235], v[200:203], v[180:183]
v_cvt_pk_bf16_f32 v129, v130, v131
ds_read_b128 v[200:203], v239 offset:20480
s_waitcnt lgkmcnt(8)
v_mfma_f32_16x16x32_bf16 v[164:167], v[228:231], v[204:207], v[164:167]
v_cvt_pk_bf16_f32 v130, v148, v149
v_mfma_f32_16x16x32_bf16 v[184:187], v[232:235], v[204:207], v[184:187]
v_cvt_pk_bf16_f32 v131, v150, v151
ds_read_b128 v[204:207], v239 offset:21504
s_waitcnt lgkmcnt(8)
v_mfma_f32_16x16x32_bf16 v[168:171], v[228:231], v[208:211], v[168:171]
s_add_u32 s32, s37, 69632
v_mfma_f32_16x16x32_bf16 v[188:191], v[232:235], v[208:211], v[188:191]
buffer_store_dwordx4 v[128:131], v240, s[24:27], s32 offen sc1
ds_read_b128 v[208:211], v239 offset:22528
s_waitcnt lgkmcnt(8)
v_mfma_f32_16x16x32_bf16 v[172:175], v[228:231], v[212:215], v[172:175]
v_mfma_f32_16x16x32_bf16 v[192:195], v[232:235], v[212:215], v[192:195]
ds_read_b128 v[212:215], v239 offset:23552
s_waitcnt lgkmcnt(8)
v_mfma_f32_16x16x32_bf16 v[176:179], v[228:231], v[216:219], v[176:179]
v_mfma_f32_16x16x32_bf16 v[196:199], v[232:235], v[216:219], v[196:199]
ds_read_b128 v[216:219], v239 offset:24576
ds_read_b64_tr_b16 v[228:229], v238 offset:53248
ds_read_b64_tr_b16 v[230:231], v238 offset:55296
ds_read_b64_tr_b16 v[232:233], v238 offset:57344
ds_read_b64_tr_b16 v[234:235], v238 offset:59392
s_waitcnt lgkmcnt(8)
v_mfma_f32_16x16x32_bf16 v[160:163], v[220:223], v[200:203], v[160:163]
v_cvt_pk_bf16_f32 v132, v132, v133
v_mfma_f32_16x16x32_bf16 v[180:183], v[224:227], v[200:203], v[180:183]
v_cvt_pk_bf16_f32 v133, v134, v135
ds_read_b128 v[200:203], v239 offset:25600
s_waitcnt lgkmcnt(8)
v_mfma_f32_16x16x32_bf16 v[164:167], v[220:223], v[204:207], v[164:167]
v_cvt_pk_bf16_f32 v134, v152, v153
v_mfma_f32_16x16x32_bf16 v[184:187], v[224:227], v[204:207], v[184:187]
v_cvt_pk_bf16_f32 v135, v154, v155
ds_read_b128 v[204:207], v239 offset:26624
s_waitcnt lgkmcnt(8)
v_mfma_f32_16x16x32_bf16 v[168:171], v[220:223], v[208:211], v[168:171]
s_add_u32 s32, s37, 73728
v_mfma_f32_16x16x32_bf16 v[188:191], v[224:227], v[208:211], v[188:191]
buffer_store_dwordx4 v[132:135], v240, s[24:27], s32 offen sc1
ds_read_b128 v[208:211], v239 offset:27648
s_waitcnt lgkmcnt(8)
v_mfma_f32_16x16x32_bf16 v[172:175], v[220:223], v[212:215], v[172:175]
v_mfma_f32_16x16x32_bf16 v[192:195], v[224:227], v[212:215], v[192:195]
ds_read_b128 v[212:215], v239 offset:28672
s_waitcnt lgkmcnt(8)
v_mfma_f32_16x16x32_bf16 v[176:179], v[220:223], v[216:219], v[176:179]
v_mfma_f32_16x16x32_bf16 v[196:199], v[224:227], v[216:219], v[196:199]
ds_read_b128 v[216:219], v239 offset:29696
s_waitcnt lgkmcnt(4)
v_mfma_f32_16x16x32_bf16 v[160:163], v[228:231], v[200:203], v[160:163]
v_cvt_pk_bf16_f32 v136, v136, v137
v_mfma_f32_16x16x32_bf16 v[180:183], v[232:235], v[200:203], v[180:183]
v_cvt_pk_bf16_f32 v137, v138, v139
s_waitcnt lgkmcnt(3)
v_mfma_f32_16x16x32_bf16 v[164:167], v[228:231], v[204:207], v[164:167]
v_cvt_pk_bf16_f32 v138, v156, v157
v_mfma_f32_16x16x32_bf16 v[184:187], v[232:235], v[204:207], v[184:187]
v_cvt_pk_bf16_f32 v139, v158, v159
s_waitcnt lgkmcnt(2)
v_mfma_f32_16x16x32_bf16 v[168:171], v[228:231], v[208:211], v[168:171]
s_add_u32 s32, s37, 77824
v_mfma_f32_16x16x32_bf16 v[188:191], v[232:235], v[208:211], v[188:191]
buffer_store_dwordx4 v[136:139], v240, s[24:27], s32 offen sc1
s_waitcnt lgkmcnt(1)
v_mfma_f32_16x16x32_bf16 v[172:175], v[228:231], v[212:215], v[172:175]
v_mfma_f32_16x16x32_bf16 v[192:195], v[232:235], v[212:215], v[192:195]
s_waitcnt lgkmcnt(0)
v_mfma_f32_16x16x32_bf16 v[176:179], v[228:231], v[216:219], v[176:179]
v_mfma_f32_16x16x32_bf16 v[196:199], v[232:235], v[216:219], v[196:199]
s_nop 7
v_cvt_pk_bf16_f32 v160, v160, v161
v_cvt_pk_bf16_f32 v161, v162, v163
v_cvt_pk_bf16_f32 v162, v180, v181
v_cvt_pk_bf16_f32 v163, v182, v183
s_add_u32 s32, s37, 81920
buffer_store_dwordx4 v[160:163], v240, s[24:27], s32 offen sc1
v_cvt_pk_bf16_f32 v164, v164, v165
v_cvt_pk_bf16_f32 v165, v166, v167
v_cvt_pk_bf16_f32 v166, v184, v185
v_cvt_pk_bf16_f32 v167, v186, v187
s_add_u32 s32, s37, 86016
buffer_store_dwordx4 v[164:167], v240, s[24:27], s32 offen sc1
v_cvt_pk_bf16_f32 v168, v168, v169
v_cvt_pk_bf16_f32 v169, v170, v171
v_cvt_pk_bf16_f32 v170, v188, v189
v_cvt_pk_bf16_f32 v171, v190, v191
s_add_u32 s32, s37, 90112
buffer_store_dwordx4 v[168:171], v240, s[24:27], s32 offen sc1
v_cvt_pk_bf16_f32 v172, v172, v173
v_cvt_pk_bf16_f32 v173, v174, v175
v_cvt_pk_bf16_f32 v174, v192, v193
v_cvt_pk_bf16_f32 v175, v194, v195
s_add_u32 s32, s37, 94208
buffer_store_dwordx4 v[172:175], v240, s[24:27], s32 offen sc1
v_cvt_pk_bf16_f32 v176, v176, v177
v_cvt_pk_bf16_f32 v177, v178, v179
v_cvt_pk_bf16_f32 v178, v196, v197
v_cvt_pk_bf16_f32 v179, v198, v199
s_add_u32 s32, s37, 98304
buffer_store_dwordx4 v[176:179], v240, s[24:27], s32 offen sc1
s_waitcnt vmcnt(0)
L_fin:
s_load_dwordx4 s[48:51], s[0:1], 80
v_mbcnt_lo_u32_b32 v0, -1, 0
v_mbcnt_hi_u32_b32 v0, -1, v0
v_mov_b32 v7, 161792
s_lshl_b32 s73, s70, 4
s_add_u32 s73, s73, s71
s_waitcnt lgkmcnt(0)
s_mov_b32 s4, s50
s_mov_b32 s5, s51
s_mov_b32 s6, 0x100
s_mov_b32 s7, 0x00020000
s_mov_b32 s8, s48
s_mov_b32 s9, s49
s_mov_b32 s10, 0x320000
s_mov_b32 s11, 0x00020000
s_cmp_lg_u32 s34, 0
s_cbranch_scc0 L_finlead
s_barrier
s_branch L_finwait
L_finlead:
s_lshl_b32 s79, s73, 11
s_add_u32 s79, s79, 26214400
v_lshlrev_b32 v8, 8, v0
v_mov_b32 v9, 1
s_mov_b64 exec, 1
s_lshl_b32 s74, s72, 8
v_mov_b32 v6, s74
v_mov_b32 v1, 0
buffer_store_dword v1, v6, s[24:27], s79 offen sc1
s_waitcnt vmcnt(0)
s_barrier
s_lshl_b32 s74, s73, 3
v_mov_b32 v3, s74
v_mov_b32 v1, 1
s_lshl_b32 s76, 1, s72
buffer_atomic_add v1, v3, s[4:7], 0 offen sc0 sc1
s_waitcnt vmcnt(0)
v_readfirstlane_b32 s74, v1
s_and_b32 s77, s74, 255
s_cmp_eq_u32 s77, 7
s_cbranch_scc0 L_finpoll
s_lshr_b32 s74, s74, 8
s_or_b32 s76, s76, s74
s_mov_b64 exec, 255
buffer_store_dword v9, v8, s[24:27], s79 offen sc1
s_mov_b64 exec, 1
s_branch L_finpub
L_finpoll:
s_mov_b32 s78, 1024
L_finspin:
buffer_load_dword v1, v6, s[24:27], s79 offen sc1
s_waitcnt vmcnt(0)
v_readfirstlane_b32 s74, v1
s_cmp_eq_u32 s74, 1
s_cbranch_scc1 L_finpub
s_sleep 6
s_sub_u32 s78, s78, 1
s_cmp_lg_u32 s78, 0
s_cbranch_scc1 L_finspin
s_lshl_b32 s74, s76, 8
v_mov_b32 v1, s74
buffer_atomic_or v1, v3, s[4:7], 0 offen sc0 sc1
s_waitcnt vmcnt(0)
v_readfirstlane_b32 s74, v1
s_and_b32 s77, s74, 255
s_cmp_eq_u32 s77, 8
s_cselect_b32 s76, s76, 0
L_finpub:
v_mov_b32 v1, s76
ds_write_b32 v7, v1
s_mov_b64 exec, -1
s_waitcnt lgkmcnt(0)
L_finwait:
s_barrier
ds_read_b32 v4, v7
v_lshrrev_b32 v2, 4, v0
v_lshlrev_b32 v1, 6, v2
v_and_b32 v3, 12, v0
v_lshlrev_b32 v3, 8, v3
v_add_u32 v1, v1, v3
v_and_b32 v3, 3, v0
v_lshlrev_b32 v3, 4, v3
v_add_u32 v1, v1, v3
v_mul_u32_u24 v2, 2560, v2
v_and_b32 v3, 15, v0
v_lshlrev_b32 v3, 3, v3
v_add_u32 v2, v2, v3
s_mul_i32 s79, s73, 819200
s_mul_i32 s80, s71, 204800
s_mul_i32 s81, s70, 1280
s_add_u32 s80, s80, s81
s_waitcnt lgkmcnt(0)
v_readfirstlane_b32 s76, v4
s_and_b32 s76, s76, 255
L_finshare:
s_cmp_eq_u32 s76, 0
s_cbranch_scc1 L_exit
s_ff1_i32_b32 s74, s76
s_bitset0_b32 s76, s74
s_lshl_b32 s77, s34, 3
s_add_u32 s77, s77, s74
s_lshr_b32 s82, s77, 2
s_and_b32 s83, s77, 3
s_lshl_b32 s84, s82, 12
s_lshl_b32 s85, s83, 8
s_add_u32 s84, s84, s85
s_add_u32 s84, s84, s79
buffer_load_dwordx4 v[8:11], v1, s[24:27], s84 offen sc1
s_add_u32 s84, s84, 102400
buffer_load_dwordx4 v[12:15], v1, s[24:27], s84 offen sc1
s_add_u32 s84, s84, 102400
buffer_load_dwordx4 v[16:19], v1, s[24:27], s84 offen sc1
s_add_u32 s84, s84, 102400
buffer_load_dwordx4 v[20:23], v1, s[24:27], s84 offen sc1
s_add_u32 s84, s84, 102400
buffer_load_dwordx4 v[24:27], v1, s[24:27], s84 offen sc1
s_add_u32 s84, s84, 102400
buffer_load_dwordx4 v[28:31], v1, s[24:27], s84 offen sc1
s_add_u32 s84, s84, 102400
buffer_load_dwordx4 v[32:35], v1, s[24:27], s84 offen sc1
s_add_u32 s84, s84, 102400
buffer_load_dwordx4 v[36:39], v1, s[24:27], s84 offen sc1
s_add_u32 s84, s84, 102400
s_add_u32 s78, s77, 64
s_cmp_lt_u32 s78, 100
s_cbranch_scc1 L_fintwo
s_lshr_b32 s82, s77, 2
s_and_b32 s83, s77, 3
s_mul_i32 s84, s82, 52
s_lshr_b32 s84, s84, 8
s_mul_i32 s85, s84, 5
s_sub_u32 s85, s82, s85
s_lshl_b32 s84, s84, 8
s_mul_i32 s85, s85, 40960
s_mul_i32 s83, s83, 10240
s_add_u32 s84, s84, s85
s_add_u32 s84, s84, s83
s_add_u32 s84, s84, s80
s_waitcnt vmcnt(7)
v_lshlrev_b32 v80, 16, v8
v_and_b32 v81, s36, v8
v_lshlrev_b32 v82, 16, v9
v_and_b32 v83, s36, v9
v_lshlrev_b32 v84, 16, v10
v_and_b32 v85, s36, v10
v_lshlrev_b32 v86, 16, v11
v_and_b32 v87, s36, v11
s_waitcnt vmcnt(6)
v_lshlrev_b32 v4, 16, v12
v_and_b32 v5, s36, v12
v_add_f32 v80, v80, v4
v_add_f32 v81, v81, v5
v_lshlrev_b32 v4, 16, v13
v_and_b32 v5, s36, v13
v_add_f32 v82, v82, v4
v_add_f32 v83, v83, v5
v_lshlrev_b32 v4, 16, v14
v_and_b32 v5, s36, v14
v_add_f32 v84, v84, v4
v_add_f32 v85, v85, v5
v_lshlrev_b32 v4, 16, v15
v_and_b32 v5, s36, v15
v_add_f32 v86, v86, v4
v_add_f32 v87, v87, v5
s_waitcnt vmcnt(5)
v_lshlrev_b32 v4, 16, v16
v_and_b32 v5, s36, v16
v_add_f32 v80, v80, v4
v_add_f32 v81, v81, v5
v_lshlrev_b32 v4, 16, v17
v_and_b32 v5, s36, v17
v_add_f32 v82, v82, v4
v_add_f32 v83, v83, v5
v_lshlrev_b32 v4, 16, v18
v_and_b32 v5, s36, v18
v_add_f32 v84, v84, v4
v_add_f32 v85, v85, v5
v_lshlrev_b32 v4, 16, v19
v_and_b32 v5, s36, v19
v_add_f32 v86, v86, v4
v_add_f32 v87, v87, v5
s_waitcnt vmcnt(4)
v_lshlrev_b32 v4, 16, v20
v_and_b32 v5, s36, v20
v_add_f32 v80, v80, v4
v_add_f32 v81, v81, v5
v_lshlrev_b32 v4, 16, v21
v_and_b32 v5, s36, v21
v_add_f32 v82, v82, v4
v_add_f32 v83, v83, v5
v_lshlrev_b32 v4, 16, v22
v_and_b32 v5, s36, v22
v_add_f32 v84, v84, v4
v_add_f32 v85, v85, v5
v_lshlrev_b32 v4, 16, v23
v_and_b32 v5, s36, v23
v_add_f32 v86, v86, v4
v_add_f32 v87, v87, v5
s_waitcnt vmcnt(3)
v_lshlrev_b32 v4, 16, v24
v_and_b32 v5, s36, v24
v_add_f32 v80, v80, v4
v_add_f32 v81, v81, v5
v_lshlrev_b32 v4, 16, v25
v_and_b32 v5, s36, v25
v_add_f32 v82, v82, v4
v_add_f32 v83, v83, v5
v_lshlrev_b32 v4, 16, v26
v_and_b32 v5, s36, v26
v_add_f32 v84, v84, v4
v_add_f32 v85, v85, v5
v_lshlrev_b32 v4, 16, v27
v_and_b32 v5, s36, v27
v_add_f32 v86, v86, v4
v_add_f32 v87, v87, v5
s_waitcnt vmcnt(2)
v_lshlrev_b32 v4, 16, v28
v_and_b32 v5, s36, v28
v_add_f32 v80, v80, v4
v_add_f32 v81, v81, v5
v_lshlrev_b32 v4, 16, v29
v_and_b32 v5, s36, v29
v_add_f32 v82, v82, v4
v_add_f32 v83, v83, v5
v_lshlrev_b32 v4, 16, v30
v_and_b32 v5, s36, v30
v_add_f32 v84, v84, v4
v_add_f32 v85, v85, v5
v_lshlrev_b32 v4, 16, v31
v_and_b32 v5, s36, v31
v_add_f32 v86, v86, v4
v_add_f32 v87, v87, v5
s_waitcnt vmcnt(1)
v_lshlrev_b32 v4, 16, v32
v_and_b32 v5, s36, v32
v_add_f32 v80, v80, v4
v_add_f32 v81, v81, v5
v_lshlrev_b32 v4, 16, v33
v_and_b32 v5, s36, v33
v_add_f32 v82, v82, v4
v_add_f32 v83, v83, v5
v_lshlrev_b32 v4, 16, v34
v_and_b32 v5, s36, v34
v_add_f32 v84, v84, v4
v_add_f32 v85, v85, v5
v_lshlrev_b32 v4, 16, v35
v_and_b32 v5, s36, v35
v_add_f32 v86, v86, v4
v_add_f32 v87, v87, v5
s_waitcnt vmcnt(0)
v_lshlrev_b32 v4, 16, v36
v_and_b32 v5, s36, v36
v_add_f32 v80, v80, v4
v_add_f32 v81, v81, v5
v_lshlrev_b32 v4, 16, v37
v_and_b32 v5, s36, v37
v_add_f32 v82, v82, v4
v_add_f32 v83, v83, v5
v_lshlrev_b32 v4, 16, v38
v_and_b32 v5, s36, v38
v_add_f32 v84, v84, v4
v_add_f32 v85, v85, v5
v_lshlrev_b32 v4, 16, v39
v_and_b32 v5, s36, v39
v_add_f32 v86, v86, v4
v_add_f32 v87, v87, v5
v_cvt_pk_bf16_f32 v8, v80, v81
v_cvt_pk_bf16_f32 v9, v82, v83
v_cvt_pk_bf16_f32 v10, v84, v85
v_cvt_pk_bf16_f32 v11, v86, v87
buffer_store_dwordx2 v[8:9], v2, s[8:11], s84 offen
buffer_store_dwordx2 v[10:11], v2, s[8:11], s84 offen offset:128
s_waitcnt vmcnt(0)
s_branch L_finshare
L_fintwo:
s_lshr_b32 s82, s78, 2
s_and_b32 s83, s78, 3
s_lshl_b32 s84, s82, 12
s_lshl_b32 s85, s83, 8
s_add_u32 s84, s84, s85
s_add_u32 s84, s84, s79
buffer_load_dwordx4 v[40:43], v1, s[24:27], s84 offen sc1
s_add_u32 s84, s84, 102400
buffer_load_dwordx4 v[44:47], v1, s[24:27], s84 offen sc1
s_add_u32 s84, s84, 102400
buffer_load_dwordx4 v[48:51], v1, s[24:27], s84 offen sc1
s_add_u32 s84, s84, 102400
buffer_load_dwordx4 v[52:55], v1, s[24:27], s84 offen sc1
s_add_u32 s84, s84, 102400
buffer_load_dwordx4 v[56:59], v1, s[24:27], s84 offen sc1
s_add_u32 s84, s84, 102400
buffer_load_dwordx4 v[60:63], v1, s[24:27], s84 offen sc1
s_add_u32 s84, s84, 102400
buffer_load_dwordx4 v[64:67], v1, s[24:27], s84 offen sc1
s_add_u32 s84, s84, 102400
buffer_load_dwordx4 v[68:71], v1, s[24:27], s84 offen sc1
s_add_u32 s84, s84, 102400
s_lshr_b32 s82, s77, 2
s_and_b32 s83, s77, 3
s_mul_i32 s84, s82, 52
s_lshr_b32 s84, s84, 8
s_mul_i32 s85, s84, 5
s_sub_u32 s85, s82, s85
s_lshl_b32 s84, s84, 8
s_mul_i32 s85, s85, 40960
s_mul_i32 s83, s83, 10240
s_add_u32 s84, s84, s85
s_add_u32 s84, s84, s83
s_add_u32 s84, s84, s80
s_waitcnt vmcnt(15)
v_lshlrev_b32 v80, 16, v8
v_and_b32 v81, s36, v8
v_lshlrev_b32 v82, 16, v9
v_and_b32 v83, s36, v9
v_lshlrev_b32 v84, 16, v10
v_and_b32 v85, s36, v10
v_lshlrev_b32 v86, 16, v11
v_and_b32 v87, s36, v11
s_waitcnt vmcnt(14)
v_lshlrev_b32 v4, 16, v12
v_and_b32 v5, s36, v12
v_add_f32 v80, v80, v4
v_add_f32 v81, v81, v5
v_lshlrev_b32 v4, 16, v13
v_and_b32 v5, s36, v13
v_add_f32 v82, v82, v4
v_add_f32 v83, v83, v5
v_lshlrev_b32 v4, 16, v14
v_and_b32 v5, s36, v14
v_add_f32 v84, v84, v4
v_add_f32 v85, v85, v5
v_lshlrev_b32 v4, 16, v15
v_and_b32 v5, s36, v15
v_add_f32 v86, v86, v4
v_add_f32 v87, v87, v5
s_waitcnt vmcnt(13)
v_lshlrev_b32 v4, 16, v16
v_and_b32 v5, s36, v16
v_add_f32 v80, v80, v4
v_add_f32 v81, v81, v5
v_lshlrev_b32 v4, 16, v17
v_and_b32 v5, s36, v17
v_add_f32 v82, v82, v4
v_add_f32 v83, v83, v5
v_lshlrev_b32 v4, 16, v18
v_and_b32 v5, s36, v18
v_add_f32 v84, v84, v4
v_add_f32 v85, v85, v5
v_lshlrev_b32 v4, 16, v19
v_and_b32 v5, s36, v19
v_add_f32 v86, v86, v4
v_add_f32 v87, v87, v5
s_waitcnt vmcnt(12)
v_lshlrev_b32 v4, 16, v20
v_and_b32 v5, s36, v20
v_add_f32 v80, v80, v4
v_add_f32 v81, v81, v5
v_lshlrev_b32 v4, 16, v21
v_and_b32 v5, s36, v21
v_add_f32 v82, v82, v4
v_add_f32 v83, v83, v5
v_lshlrev_b32 v4, 16, v22
v_and_b32 v5, s36, v22
v_add_f32 v84, v84, v4
v_add_f32 v85, v85, v5
v_lshlrev_b32 v4, 16, v23
v_and_b32 v5, s36, v23
v_add_f32 v86, v86, v4
v_add_f32 v87, v87, v5
s_waitcnt vmcnt(11)
v_lshlrev_b32 v4, 16, v24
v_and_b32 v5, s36, v24
v_add_f32 v80, v80, v4
v_add_f32 v81, v81, v5
v_lshlrev_b32 v4, 16, v25
v_and_b32 v5, s36, v25
v_add_f32 v82, v82, v4
v_add_f32 v83, v83, v5
v_lshlrev_b32 v4, 16, v26
v_and_b32 v5, s36, v26
v_add_f32 v84, v84, v4
v_add_f32 v85, v85, v5
v_lshlrev_b32 v4, 16, v27
v_and_b32 v5, s36, v27
v_add_f32 v86, v86, v4
v_add_f32 v87, v87, v5
s_waitcnt vmcnt(10)
v_lshlrev_b32 v4, 16, v28
v_and_b32 v5, s36, v28
v_add_f32 v80, v80, v4
v_add_f32 v81, v81, v5
v_lshlrev_b32 v4, 16, v29
v_and_b32 v5, s36, v29
v_add_f32 v82, v82, v4
v_add_f32 v83, v83, v5
v_lshlrev_b32 v4, 16, v30
v_and_b32 v5, s36, v30
v_add_f32 v84, v84, v4
v_add_f32 v85, v85, v5
v_lshlrev_b32 v4, 16, v31
v_and_b32 v5, s36, v31
v_add_f32 v86, v86, v4
v_add_f32 v87, v87, v5
s_waitcnt vmcnt(9)
v_lshlrev_b32 v4, 16, v32
v_and_b32 v5, s36, v32
v_add_f32 v80, v80, v4
v_add_f32 v81, v81, v5
v_lshlrev_b32 v4, 16, v33
v_and_b32 v5, s36, v33
v_add_f32 v82, v82, v4
v_add_f32 v83, v83, v5
v_lshlrev_b32 v4, 16, v34
v_and_b32 v5, s36, v34
v_add_f32 v84, v84, v4
v_add_f32 v85, v85, v5
v_lshlrev_b32 v4, 16, v35
v_and_b32 v5, s36, v35
v_add_f32 v86, v86, v4
v_add_f32 v87, v87, v5
s_waitcnt vmcnt(8)
v_lshlrev_b32 v4, 16, v36
v_and_b32 v5, s36, v36
v_add_f32 v80, v80, v4
v_add_f32 v81, v81, v5
v_lshlrev_b32 v4, 16, v37
v_and_b32 v5, s36, v37
v_add_f32 v82, v82, v4
v_add_f32 v83, v83, v5
v_lshlrev_b32 v4, 16, v38
v_and_b32 v5, s36, v38
v_add_f32 v84, v84, v4
v_add_f32 v85, v85, v5
v_lshlrev_b32 v4, 16, v39
v_and_b32 v5, s36, v39
v_add_f32 v86, v86, v4
v_add_f32 v87, v87, v5
v_cvt_pk_bf16_f32 v8, v80, v81
v_cvt_pk_bf16_f32 v9, v82, v83
v_cvt_pk_bf16_f32 v10, v84, v85
v_cvt_pk_bf16_f32 v11, v86, v87
buffer_store_dwordx2 v[8:9], v2, s[8:11], s84 offen
buffer_store_dwordx2 v[10:11], v2, s[8:11], s84 offen offset:128
s_lshr_b32 s82, s78, 2
s_and_b32 s83, s78, 3
s_mul_i32 s84, s82, 52
s_lshr_b32 s84, s84, 8
s_mul_i32 s85, s84, 5
s_sub_u32 s85, s82, s85
s_lshl_b32 s84, s84, 8
s_mul_i32 s85, s85, 40960
s_mul_i32 s83, s83, 10240
s_add_u32 s84, s84, s85
s_add_u32 s84, s84, s83
s_add_u32 s84, s84, s80
s_waitcnt vmcnt(9)
v_lshlrev_b32 v80, 16, v40
v_and_b32 v81, s36, v40
v_lshlrev_b32 v82, 16, v41
v_and_b32 v83, s36, v41
v_lshlrev_b32 v84, 16, v42
v_and_b32 v85, s36, v42
v_lshlrev_b32 v86, 16, v43
v_and_b32 v87, s36, v43
s_waitcnt vmcnt(8)
v_lshlrev_b32 v4, 16, v44
v_and_b32 v5, s36, v44
v_add_f32 v80, v80, v4
v_add_f32 v81, v81, v5
v_lshlrev_b32 v4, 16, v45
v_and_b32 v5, s36, v45
v_add_f32 v82, v82, v4
v_add_f32 v83, v83, v5
v_lshlrev_b32 v4, 16, v46
v_and_b32 v5, s36, v46
v_add_f32 v84, v84, v4
v_add_f32 v85, v85, v5
v_lshlrev_b32 v4, 16, v47
v_and_b32 v5, s36, v47
v_add_f32 v86, v86, v4
v_add_f32 v87, v87, v5
s_waitcnt vmcnt(7)
v_lshlrev_b32 v4, 16, v48
v_and_b32 v5, s36, v48
v_add_f32 v80, v80, v4
v_add_f32 v81, v81, v5
v_lshlrev_b32 v4, 16, v49
v_and_b32 v5, s36, v49
v_add_f32 v82, v82, v4
v_add_f32 v83, v83, v5
v_lshlrev_b32 v4, 16, v50
v_and_b32 v5, s36, v50
v_add_f32 v84, v84, v4
v_add_f32 v85, v85, v5
v_lshlrev_b32 v4, 16, v51
v_and_b32 v5, s36, v51
v_add_f32 v86, v86, v4
v_add_f32 v87, v87, v5
s_waitcnt vmcnt(6)
v_lshlrev_b32 v4, 16, v52
v_and_b32 v5, s36, v52
v_add_f32 v80, v80, v4
v_add_f32 v81, v81, v5
v_lshlrev_b32 v4, 16, v53
v_and_b32 v5, s36, v53
v_add_f32 v82, v82, v4
v_add_f32 v83, v83, v5
v_lshlrev_b32 v4, 16, v54
v_and_b32 v5, s36, v54
v_add_f32 v84, v84, v4
v_add_f32 v85, v85, v5
v_lshlrev_b32 v4, 16, v55
v_and_b32 v5, s36, v55
v_add_f32 v86, v86, v4
v_add_f32 v87, v87, v5
s_waitcnt vmcnt(5)
v_lshlrev_b32 v4, 16, v56
v_and_b32 v5, s36, v56
v_add_f32 v80, v80, v4
v_add_f32 v81, v81, v5
v_lshlrev_b32 v4, 16, v57
v_and_b32 v5, s36, v57
v_add_f32 v82, v82, v4
v_add_f32 v83, v83, v5
v_lshlrev_b32 v4, 16, v58
v_and_b32 v5, s36, v58
v_add_f32 v84, v84, v4
v_add_f32 v85, v85, v5
v_lshlrev_b32 v4, 16, v59
v_and_b32 v5, s36, v59
v_add_f32 v86, v86, v4
v_add_f32 v87, v87, v5
s_waitcnt vmcnt(4)
v_lshlrev_b32 v4, 16, v60
v_and_b32 v5, s36, v60
v_add_f32 v80, v80, v4
v_add_f32 v81, v81, v5
v_lshlrev_b32 v4, 16, v61
v_and_b32 v5, s36, v61
v_add_f32 v82, v82, v4
v_add_f32 v83, v83, v5
v_lshlrev_b32 v4, 16, v62
v_and_b32 v5, s36, v62
v_add_f32 v84, v84, v4
v_add_f32 v85, v85, v5
v_lshlrev_b32 v4, 16, v63
v_and_b32 v5, s36, v63
v_add_f32 v86, v86, v4
v_add_f32 v87, v87, v5
s_waitcnt vmcnt(3)
v_lshlrev_b32 v4, 16, v64
v_and_b32 v5, s36, v64
v_add_f32 v80, v80, v4
v_add_f32 v81, v81, v5
v_lshlrev_b32 v4, 16, v65
v_and_b32 v5, s36, v65
v_add_f32 v82, v82, v4
v_add_f32 v83, v83, v5
v_lshlrev_b32 v4, 16, v66
v_and_b32 v5, s36, v66
v_add_f32 v84, v84, v4
v_add_f32 v85, v85, v5
v_lshlrev_b32 v4, 16, v67
v_and_b32 v5, s36, v67
v_add_f32 v86, v86, v4
v_add_f32 v87, v87, v5
s_waitcnt vmcnt(2)
v_lshlrev_b32 v4, 16, v68
v_and_b32 v5, s36, v68
v_add_f32 v80, v80, v4
v_add_f32 v81, v81, v5
v_lshlrev_b32 v4, 16, v69
v_and_b32 v5, s36, v69
v_add_f32 v82, v82, v4
v_add_f32 v83, v83, v5
v_lshlrev_b32 v4, 16, v70
v_and_b32 v5, s36, v70
v_add_f32 v84, v84, v4
v_add_f32 v85, v85, v5
v_lshlrev_b32 v4, 16, v71
v_and_b32 v5, s36, v71
v_add_f32 v86, v86, v4
v_add_f32 v87, v87, v5
v_cvt_pk_bf16_f32 v40, v80, v81
v_cvt_pk_bf16_f32 v41, v82, v83
v_cvt_pk_bf16_f32 v42, v84, v85
v_cvt_pk_bf16_f32 v43, v86, v87
buffer_store_dwordx2 v[40:41], v2, s[8:11], s84 offen
buffer_store_dwordx2 v[42:43], v2, s[8:11], s84 offen offset:128
s_waitcnt vmcnt(0)
s_branch L_finshare
L_exit:
s_endpgm
.section .rodata,"a"
.p2align 6
.amdhsa_kernel concat_heads__mha_block_cached__mha_block_cached__near_ridge_kernel
  .amdhsa_next_free_vgpr 256
  .amdhsa_next_free_sgpr 96
  .amdhsa_accum_offset 256
  .amdhsa_group_segment_fixed_size 0
  .amdhsa_kernarg_size 104
  .amdhsa_user_sgpr_count 2
  .amdhsa_user_sgpr_kernarg_segment_ptr 1
  .amdhsa_system_sgpr_workgroup_id_x 1
.end_amdhsa_kernel
```
